```python
import torch

def _softmax(x, axis=-1):
    return torch.softmax(x, dim=axis)
def _gelu(x):
    return torch.nn.functional.gelu(x, approximate="tanh")
def _silu(x):
    return torch.nn.functional.silu(x)
def _sigmoid(x):
    return torch.sigmoid(x)
def _layernorm(x, axis=-1, eps=1e-5):
    m = x.mean(dim=axis, keepdim=True)
    v = x.var(dim=axis, keepdim=True, unbiased=False)
    return (x - m) / torch.sqrt(v + eps)
def _scatter_add(tgt, idx, src, axis=0):
    return tgt.clone().index_add_(axis, idx, src)
def _segment_sum(src, seg, n):
    out = torch.zeros((n,) + src.shape[1:], dtype=src.dtype)
    return out.index_add_(0, seg, src)
def _pad(x, pw):
    flat = tuple(v for pair in reversed(pw) for v in pair)
    return torch.nn.functional.pad(x, flat)

kernel_name = 'standalone__modern_conv_block_slak__vision'

def setup_inputs():

    _w = (lambda a: (lambda t: t.to(torch.bfloat16) if t.is_floating_point() else t)(torch.as_tensor(a)))
    H = W = 224
    C = 192
    K = 3
    return {
        "x": _w((lambda *s: torch.randn(*s, dtype=torch.bfloat16) * 0.05)(1, H, W, C)),
        "dw": _w((lambda *s: torch.randn(*s, dtype=torch.bfloat16) * 0.05)(K, K, C)),
        "w1": _w((lambda *s: torch.randn(*s, dtype=torch.bfloat16) * 0.05)(C, 4 * C)),
        "w2": _w((lambda *s: torch.randn(*s, dtype=torch.bfloat16) * 0.05)(4 * C, C)),
        "grn_g": _w((lambda *s: torch.randn(*s, dtype=torch.bfloat16) * 0.05)(4 * C)),
        "grn_b": _w((lambda *s: torch.randn(*s, dtype=torch.bfloat16) * 0.05)(4 * C)),
    }

def reference(x, dw, w1, w2, grn_g, grn_b):
    B, H, W, C = x.shape
    K = dw.shape[0]
    pad = K // 2
    xp = _pad(x, ((0,0),(pad,pad),(pad,pad),(0,0)))
    out = torch.zeros_like(x)
    for i in range(K):
        for j in range(K):
            out = out + xp[:, i:i+H, j:j+W, :] * dw[i, j][None, None, None, :]
    h = _layernorm(out, axis=-1)
    h = _gelu(h @ w1)
    gx = torch.sqrt((h * h).sum(axis=(1, 2), keepdims=True) + 1e-6)
    nx = gx / (gx.mean(axis=-1, keepdims=True) + 1e-6)
    h = grn_g[None, None, None, :] * (h * nx) + grn_b[None, None, None, :] + h
    return x + h @ w2
```

```asm
; @launch grid=(224,1,1) block=(256,1,1) lds=163840
.amdgcn_target "amdgcn-amd-amdhsa--gfx950"
.text
.globl standalone__modern_conv_block_slak__vision_kernel
.p2align 8
.type standalone__modern_conv_block_slak__vision_kernel,@function
standalone__modern_conv_block_slak__vision_kernel:
  s_cmp_ge_u32 s2, 224
  s_cbranch_scc1 L_end
  s_load_dwordx4 s[4:7], s[0:1], 0
  s_load_dwordx4 s[8:11], s[0:1], 16
  s_load_dwordx4 s[12:15], s[0:1], 32
  s_load_dwordx4 s[16:19], s[0:1], 48
  s_load_dwordx2 s[20:21], s[0:1], 64
  s_getpc_b64 s[68:69]
L_pc:
  s_lshr_b32 s66, s2, 3
  s_lshl_b32 s66, s66, 12
  v_and_b32 v2, 31, v0
  v_lshl_add_u32 v2, v2, 7, s66
  v_min_u32 v2, (L_end-L_pc), v2
  global_load_dword a255, v2, s[68:69]
  v_lshrrev_b32 v1, 6, v0
  v_and_b32 v0, 63, v0
  v_readfirstlane_b32 s44, v1
  s_and_b32 s47, s2, 7
  s_mul_i32 s47, s47, 28
  s_lshr_b32 s48, s2, 3
  s_add_u32 s47, s47, s48
  s_mul_i32 s48, s47, 4682
  s_lshr_b32 s48, s48, 16
  s_mul_i32 s45, s48, 14
  s_sub_u32 s47, s47, s45
  s_lshl_b32 s46, s47, 4
  s_min_u32 s47, s2, 191
  s_lshl_b32 s47, s47, 1
  s_mul_i32 s48, s44, 192
  v_add_u32 v96, s48, v0
  v_mul_u32_u24 v97, 384, v96
  v_add_u32 v97, s47, v97
  v_lshlrev_b32 v96, 1, v96
  v_add_u32 v98, 24576, v97
  v_add_u32 v99, 49152, v97
  s_lshl_b32 s47, s44, 3
  v_lshrrev_b32 v73, 3, v0
  v_add_u32 v73, s47, v73
  v_and_b32 v74, 7, v0
  v_lshrrev_b32 v75, 1, v74
  v_and_b32 v74, 1, v74
  v_lshlrev_b32 v74, 4, v74
  s_sub_u32 s48, s45, 1
  s_sub_u32 s49, s46, 1
  s_movk_i32 s57, 224
  s_movk_i32 s61, 384
  v_mov_b32 v79, 0x80000000
  v_mov_b32 v80, v79
  v_mov_b32 v81, v79
  v_mov_b32 v82, v79
  v_mov_b32 v83, v79
  v_mov_b32 v84, v79
  v_mov_b32 v85, v79
  v_mov_b32 v86, v79
  v_mov_b32 v87, v79
  v_mov_b32 v88, v79
  s_lshl_b32 s62, s44, 10
  v_lshl_add_u32 v72, v0, 4, s62
  s_mov_b32 s47, 0
L_xaddr:
  v_mul_u32_u24 v77, 3641, v73
  v_lshrrev_b32 v77, 16, v77
  v_mul_u32_u24 v78, 18, v77
  v_sub_u32 v76, v73, v78
  v_bfe_u32 v78, v76, 1, 2
  v_xor_b32 v78, v78, v75
  v_lshl_add_u32 v78, v78, 5, v74
  v_add_u32 v77, s48, v77
  v_add_u32 v76, s49, v76
  v_max_u32 v70, v76, v77
  v_cmp_gt_u32 vcc, s57, v70
  v_mad_u32_u24 v71, v77, s57, v76
  v_mad_u32_u24 v71, v71, s61, v78
  v_add_u32 v73, 32, v73
  v_cndmask_b32 v71, v79, v71, vcc
  s_set_gpr_idx_on s47, gpr_idx(DST)
  v_mov_b32 v80, v71
  s_set_gpr_idx_off
  s_add_u32 s47, s47, 1
  s_cmp_lt_u32 s47, 9
  s_cbranch_scc1 L_xaddr
  s_waitcnt lgkmcnt(0)
  s_mov_b32 s24, s4
  s_and_b32 s25, s5, 0xffff
  s_mov_b32 s26, 19267584
  s_mov_b32 s27, 0x00020000
  s_mov_b32 m0, s62
  s_mov_b32 s40, s6
  s_and_b32 s41, s7, 0xffff
  s_mov_b32 s42, 3456
  s_mov_b32 s43, 0x00020000
  buffer_load_dwordx4 v80, s[24:27], 0 offen lds
  s_add_u32 m0, s62, 159744
  s_nop 0
  buffer_load_dwordx4 v72, s[40:43], 0 offen lds
  s_add_u32 m0, s62, 4096
  s_nop 0
  buffer_load_dwordx4 v81, s[24:27], 0 offen lds
  s_add_u32 m0, s62, 8192
  s_nop 0
  buffer_load_dwordx4 v82, s[24:27], 0 offen lds
  s_add_u32 m0, s62, 12288
  s_nop 0
  buffer_load_dwordx4 v83, s[24:27], 0 offen lds
  s_add_u32 m0, s62, 16384
  s_nop 0
  buffer_load_dwordx4 v84, s[24:27], 0 offen lds
  s_add_u32 m0, s62, 20480
  s_nop 0
  buffer_load_dwordx4 v85, s[24:27], 0 offen lds
  s_add_u32 m0, s62, 24576
  s_nop 0
  buffer_load_dwordx4 v86, s[24:27], 0 offen lds
  s_add_u32 m0, s62, 28672
  s_nop 0
  buffer_load_dwordx4 v87, s[24:27], 0 offen lds
  s_add_u32 m0, s62, 32768
  s_nop 0
  buffer_load_dwordx4 v88, s[24:27], 0 offen lds
  s_mov_b32 s50, 0xc09d30fc
  s_mov_b32 s51, 0xc09d30fc
  s_mov_b32 s52, 0xffff0000
  s_movk_i32 s53, 128
  s_movk_i32 s54, 256
  s_mov_b32 s66, 159744
  s_mul_i32 s56, s44, 12288
  s_add_u32 s56, s56, 110592
  s_and_b32 s60, s2, 7
  s_lshl_b32 s60, s60, 12
  s_mov_b32 s72, 0
  s_mov_b32 s84, 0
  s_mov_b32 s73, 23552
  s_mov_b32 s85, 5120
  s_mov_b32 s74, 47104
  s_mov_b32 s86, 10240
  s_mov_b32 s75, 70656
  s_mov_b32 s87, 15360
  s_mov_b32 s76, 98304
  s_mov_b32 s88, 24576
  s_mov_b32 s77, 121856
  s_mov_b32 s89, 29696
  s_mov_b32 s78, 145408
  s_mov_b32 s90, 34816
  s_mov_b32 s79, 168960
  s_mov_b32 s91, 39936
  s_mov_b32 s80, 196608
  s_mov_b32 s92, 49152
  s_mov_b32 s81, 220160
  s_mov_b32 s93, 54272
  s_mov_b32 s82, 243712
  s_mov_b32 s94, 59392
  s_mov_b32 s83, 267264
  s_mov_b32 s95, 64512
  s_mov_b32 s96, 343040
  s_mov_b32 s97, 686080
  s_mov_b32 s98, 1029120
  s_mov_b32 s28, s8
  s_and_b32 s29, s9, 0xffff
  s_mov_b32 s30, 294912
  s_mov_b32 s31, 0x00020000
  s_mov_b32 s32, s10
  s_and_b32 s33, s11, 0xffff
  s_mov_b32 s34, 294912
  s_mov_b32 s35, 0x00020000
  s_mov_b32 s36, s16
  s_and_b32 s37, s17, 0xffff
  s_mov_b32 s38, 19267584
  s_mov_b32 s39, 0x00020000
  s_mov_b32 s4, s20
  s_and_b32 s5, s21, 0xffff
  s_mov_b32 s6, 32768
  s_mov_b32 s7, 0x00020000
  s_cmp_ge_u32 s2, 8
  s_cbranch_scc1 L_nozero
  s_add_u32 s47, s62, s60
  v_lshl_add_u32 v64, v0, 4, s47
  v_mov_b32 v68, 0
  v_mov_b32 v69, 0
  v_mov_b32 v70, 0
  v_mov_b32 v71, 0
  buffer_store_dwordx4 v[68:71], v64, s[4:7], 0 offen sc0 sc1
L_nozero:
  s_lshl_b32 s47, s44, 2
  s_min_u32 s47, s47, 10
  s_mul_i32 s48, s47, 2304
  v_and_b32 v64, 15, v0
  v_lshrrev_b32 v65, 4, v0
  v_lshrrev_b32 v66, 1, v65
  v_and_b32 v67, 1, v65
  v_lshlrev_b32 v68, 4, v67
  v_add_u32 v68, s48, v68
  v_add_u32 v69, v64, v66
  v_lshl_add_u32 v70, v69, 7, v68
  v_bfe_u32 v71, v69, 1, 2
  v_xor_b32 v72, 0, v71
  v_lshl_add_u32 v1, v72, 5, v70
  v_xor_b32 v72, 1, v71
  v_lshl_add_u32 v2, v72, 5, v70
  v_xor_b32 v72, 2, v71
  v_lshl_add_u32 v3, v72, 5, v70
  v_xor_b32 v72, 3, v71
  v_lshl_add_u32 v4, v72, 5, v70
  v_add_u32 v69, 2, v64
  v_lshl_add_u32 v70, v69, 7, v68
  v_bfe_u32 v71, v69, 1, 2
  v_mul_u32_u24 v73, 2304, v66
  v_sub_u32 v70, v70, v73
  v_add_u32 v70, 2304, v70
  v_xor_b32 v72, 0, v71
  v_lshl_add_u32 v5, v72, 5, v70
  v_xor_b32 v72, 1, v71
  v_lshl_add_u32 v6, v72, 5, v70
  v_xor_b32 v72, 2, v71
  v_lshl_add_u32 v7, v72, 5, v70
  v_xor_b32 v72, 3, v71
  v_lshl_add_u32 v8, v72, 5, v70
  v_lshrrev_b32 v69, 1, v64
  v_lshlrev_b32 v69, 2, v69
  v_mul_u32_u24 v70, 384, v66
  v_add3_u32 v9, v69, v70, s66
  v_lshlrev_b32 v69, 1, v64
  v_add_u32 v69, s66, v69
  v_add_u32 v70, 3, v65
  v_cmp_eq_u32 vcc, 3, v65
  v_mov_b32 v71, 2
  s_nop 0
  v_cndmask_b32 v70, v70, v71, vcc
  v_mul_u32_u24 v70, 384, v70
  v_add_u32 v10, v69, v70
  v_mul_u32_u24 v70, 384, v65
  v_add_u32 v11, v69, v70
  v_lshrrev_b32 v69, 3, v64
  v_and_b32 v70, 1, v64
  v_mov_b32 v71, 0xffff
  v_mov_b32 v72, s52
  v_cmp_eq_u32 vcc, 1, v70
  s_nop 1
  v_cndmask_b32 v73, v71, v72, vcc
  v_cmp_eq_u32 vcc, v69, v67
  s_nop 1
  v_cndmask_b32 v73, 0, v73, vcc
  v_bfe_u32 v69, v64, 1, 2
  v_cmp_eq_u32 vcc, 0, v69
  s_nop 1
  v_cndmask_b32 v13, 0, v73, vcc
  v_cmp_eq_u32 vcc, 1, v69
  s_nop 1
  v_cndmask_b32 v14, 0, v73, vcc
  v_cmp_eq_u32 vcc, 2, v69
  s_nop 1
  v_cndmask_b32 v15, 0, v73, vcc
  v_cmp_eq_u32 vcc, 3, v69
  s_nop 1
  v_cndmask_b32 v16, 0, v73, vcc
  v_lshrrev_b32 v69, 2, v64
  v_cmp_eq_u32 vcc, 0, v69
  s_nop 1
  v_cndmask_b32 v17, 0, v71, vcc
  v_cmp_eq_u32 vcc, 1, v69
  s_nop 1
  v_cndmask_b32 v18, 0, v71, vcc
  v_cmp_eq_u32 vcc, 2, v69
  s_nop 1
  v_cndmask_b32 v19, 0, v71, vcc
  v_cmp_eq_u32 vcc, 3, v69
  s_nop 1
  v_cndmask_b32 v20, 0, v71, vcc
  v_and_b32 v69, 3, v64
  v_mul_u32_u24 v12, 0x5555, v69
  v_lshrrev_b32 v21, 2, v0
  v_mul_u32_u24 v21, 1536, v21
  v_and_b32 v64, 3, v0
  v_lshl_add_u32 v21, v64, 4, v21
  s_mul_i32 s47, s44, 384
  v_add_u32 v21, s47, v21
  s_waitcnt vmcnt(8)
  s_barrier
  ds_read_b32 v108, v9 offset:0
  ds_read_u16 v109, v10 offset:0
  ds_read_u16 v110, v11 offset:2304
  s_waitcnt lgkmcnt(2)
  v_and_b32 v28, v108, v13
  v_and_b32 v29, v108, v14
  v_and_b32 v30, v108, v15
  v_and_b32 v31, v108, v16
  s_waitcnt lgkmcnt(1)
  v_and_b32 v32, v109, v17
  v_and_b32 v33, v109, v18
  v_and_b32 v34, v109, v19
  v_and_b32 v35, v109, v20
  s_waitcnt lgkmcnt(0)
  v_and_b32 v36, v110, v17
  v_and_b32 v37, v110, v18
  v_and_b32 v38, v110, v19
  v_and_b32 v39, v110, v20
  ds_read_b32 v108, v9 offset:32
  ds_read_u16 v109, v10 offset:32
  ds_read_u16 v110, v11 offset:2336
  s_lshl_b32 s62, s44, 10
  s_add_u32 m0, s62, 36864
  s_nop 0
  buffer_load_dwordx4 v80, s[24:27], s53 offen lds
  s_add_u32 m0, s62, 40960
  s_nop 0
  buffer_load_dwordx4 v81, s[24:27], s53 offen lds
  s_add_u32 m0, s62, 45056
  s_nop 0
  buffer_load_dwordx4 v82, s[24:27], s53 offen lds
  s_add_u32 m0, s62, 49152
  s_nop 0
  buffer_load_dwordx4 v83, s[24:27], s53 offen lds
  s_add_u32 m0, s62, 53248
  s_nop 0
  buffer_load_dwordx4 v84, s[24:27], s53 offen lds
  s_add_u32 m0, s62, 57344
  s_nop 0
  buffer_load_dwordx4 v85, s[24:27], s53 offen lds
  s_add_u32 m0, s62, 61440
  s_nop 0
  buffer_load_dwordx4 v86, s[24:27], s53 offen lds
  s_add_u32 m0, s62, 65536
  s_nop 0
  buffer_load_dwordx4 v87, s[24:27], s53 offen lds
  s_add_u32 m0, s62, 69632
  s_nop 0
  buffer_load_dwordx4 v88, s[24:27], s53 offen lds
  global_load_ushort a105, v96, s[14:15] offset:0
  global_load_ushort a106, v96, s[14:15] offset:128
  global_load_ushort a107, v96, s[14:15] offset:256
  global_load_ushort a102, v97, s[10:11]
  global_load_ushort a103, v98, s[10:11]
  global_load_ushort a104, v99, s[10:11]
  s_waitcnt vmcnt(15)
  s_waitcnt vmcnt(15)
  s_barrier
  s_cmp_ge_u32 s2, 8
  s_cbranch_scc1 L_noflag
  s_cmp_lg_u32 s44, 0
  s_cbranch_scc1 L_noflag
  v_cmp_eq_u32 vcc, 0, v0
  s_nop 1
  s_and_saveexec_b64 s[58:59], vcc
  v_mov_b32 v66, 0
  v_mov_b32 v67, 1
  global_atomic_add v66, v67, s[18:19]
  s_mov_b64 exec, s[58:59]
L_noflag:
  ds_read_b128 a[0:3], v1 offset:0
  ds_read_b128 a[8:11], v1 offset:2304
  ds_read_b128 a[12:15], v5 offset:0
  ds_read_b128 a[16:19], v1 offset:4608
  ds_read_b128 a[20:23], v5 offset:2304
  ds_read_b128 a[24:27], v1 offset:6912
  ds_read_b128 a[28:31], v5 offset:4608
  ds_read_b128 a[32:35], v1 offset:9216
  ds_read_b128 a[36:39], v5 offset:6912
  ds_read_b128 a[40:43], v1 offset:11520
  ds_read_b128 a[44:47], v5 offset:9216
  s_waitcnt lgkmcnt(0)
  v_mfma_f32_16x16x32_bf16 v[64:67], v[28:31], a[0:3], 0
  ds_read_b128 a[48:51], v2 offset:0
  v_mfma_f32_16x16x32_bf16 v[112:115], v[28:31], a[8:11], 0
  ds_read_b128 a[56:59], v2 offset:2304
  v_and_b32 v40, v108, v13
  v_and_b32 v41, v108, v14
  v_mfma_f32_16x16x32_bf16 v[160:163], v[28:31], a[16:19], 0
  ds_read_b128 a[60:63], v6 offset:0
  v_and_b32 v42, v108, v15
  v_mfma_f32_16x16x32_bf16 v[208:211], v[28:31], a[24:27], 0
  ds_read_b128 a[64:67], v2 offset:4608
  v_and_b32 v43, v108, v16
  v_and_b32 v44, v109, v17
  v_smfmac_f32_16x16x64_bf16 v[64:67], v[32:35], a[8:15], v12
  ds_read_b128 a[68:71], v6 offset:2304
  v_and_b32 v45, v109, v18
  v_smfmac_f32_16x16x64_bf16 v[112:115], v[32:35], a[16:23], v12
  ds_read_b128 a[72:75], v2 offset:6912
  ds_read_b128 a[84:87], v6 offset:6912
  v_and_b32 v46, v109, v19
  v_and_b32 v47, v109, v20
  v_smfmac_f32_16x16x64_bf16 v[160:163], v[32:35], a[24:31], v12
  ds_read_b128 a[76:79], v6 offset:4608
  ds_read_b128 a[88:91], v2 offset:11520
  v_and_b32 v48, v110, v17
  v_smfmac_f32_16x16x64_bf16 v[208:211], v[32:35], a[32:39], v12
  ds_read_b128 a[80:83], v2 offset:9216
  ds_read_b128 a[92:95], v6 offset:9216
  v_and_b32 v49, v110, v18
  v_and_b32 v50, v110, v19
  s_add_u32 m0, s62, 73728
  v_smfmac_f32_16x16x64_bf16 v[64:67], v[36:39], a[16:23], v12
  buffer_load_dwordx4 v80, s[24:27], s54 offen lds
  v_and_b32 v51, v110, v20
  s_add_u32 m0, s62, 77824
  v_smfmac_f32_16x16x64_bf16 v[112:115], v[36:39], a[24:31], v12
  buffer_load_dwordx4 v81, s[24:27], s54 offen lds
  ds_read_b32 v108, v9 offset:64
  s_add_u32 m0, s62, 81920
  v_smfmac_f32_16x16x64_bf16 v[160:163], v[36:39], a[32:39], v12
  buffer_load_dwordx4 v82, s[24:27], s54 offen lds
  ds_read_u16 v109, v10 offset:64
  v_smfmac_f32_16x16x64_bf16 v[208:211], v[36:39], a[40:47], v12
  ds_read_u16 v110, v11 offset:2368
  s_waitcnt lgkmcnt(3)
  v_mfma_f32_16x16x32_bf16 v[68:71], v[40:43], a[48:51], 0
  ds_read_b128 a[0:3], v3 offset:0
  v_mfma_f32_16x16x32_bf16 v[116:119], v[40:43], a[56:59], 0
  ds_read_b128 a[8:11], v3 offset:2304
  s_waitcnt lgkmcnt(2)
  v_and_b32 v28, v108, v13
  v_and_b32 v29, v108, v14
  v_mfma_f32_16x16x32_bf16 v[164:167], v[40:43], a[64:67], 0
  ds_read_b128 a[12:15], v7 offset:0
  v_and_b32 v30, v108, v15
  v_mfma_f32_16x16x32_bf16 v[212:215], v[40:43], a[72:75], 0
  ds_read_b128 a[16:19], v3 offset:4608
  v_and_b32 v31, v108, v16
  v_and_b32 v32, v109, v17
  v_smfmac_f32_16x16x64_bf16 v[68:71], v[44:47], a[56:63], v12
  ds_read_b128 a[20:23], v7 offset:2304
  v_and_b32 v33, v109, v18
  v_smfmac_f32_16x16x64_bf16 v[116:119], v[44:47], a[64:71], v12
  ds_read_b128 a[24:27], v3 offset:6912
  ds_read_b128 a[36:39], v7 offset:6912
  v_and_b32 v34, v109, v19
  v_and_b32 v35, v109, v20
  v_smfmac_f32_16x16x64_bf16 v[164:167], v[44:47], a[72:79], v12
  ds_read_b128 a[28:31], v7 offset:4608
  ds_read_b128 a[40:43], v3 offset:11520
  v_and_b32 v36, v110, v17
  v_smfmac_f32_16x16x64_bf16 v[212:215], v[44:47], a[80:87], v12
  ds_read_b128 a[32:35], v3 offset:9216
  ds_read_b128 a[44:47], v7 offset:9216
  v_and_b32 v37, v110, v18
  v_and_b32 v38, v110, v19
  s_add_u32 m0, s62, 86016
  v_smfmac_f32_16x16x64_bf16 v[68:71], v[48:51], a[64:71], v12
  buffer_load_dwordx4 v83, s[24:27], s54 offen lds
  v_and_b32 v39, v110, v20
  s_add_u32 m0, s62, 90112
  v_smfmac_f32_16x16x64_bf16 v[116:119], v[48:51], a[72:79], v12
  buffer_load_dwordx4 v84, s[24:27], s54 offen lds
  ds_read_b32 v108, v9 offset:96
  s_add_u32 m0, s62, 94208
  v_smfmac_f32_16x16x64_bf16 v[164:167], v[48:51], a[80:87], v12
  buffer_load_dwordx4 v85, s[24:27], s54 offen lds
  ds_read_u16 v109, v10 offset:96
  v_smfmac_f32_16x16x64_bf16 v[212:215], v[48:51], a[88:95], v12
  ds_read_u16 v110, v11 offset:2400
  s_waitcnt lgkmcnt(3)
  v_mfma_f32_16x16x32_bf16 v[72:75], v[28:31], a[0:3], 0
  ds_read_b128 a[48:51], v4 offset:0
  v_mfma_f32_16x16x32_bf16 v[120:123], v[28:31], a[8:11], 0
  ds_read_b128 a[56:59], v4 offset:2304
  s_waitcnt lgkmcnt(2)
  v_and_b32 v40, v108, v13
  v_and_b32 v41, v108, v14
  v_mfma_f32_16x16x32_bf16 v[168:171], v[28:31], a[16:19], 0
  ds_read_b128 a[60:63], v8 offset:0
  v_and_b32 v42, v108, v15
  v_mfma_f32_16x16x32_bf16 v[216:219], v[28:31], a[24:27], 0
  ds_read_b128 a[64:67], v4 offset:4608
  v_and_b32 v43, v108, v16
  v_and_b32 v44, v109, v17
  v_smfmac_f32_16x16x64_bf16 v[72:75], v[32:35], a[8:15], v12
  ds_read_b128 a[68:71], v8 offset:2304
  v_and_b32 v45, v109, v18
  v_smfmac_f32_16x16x64_bf16 v[120:123], v[32:35], a[16:23], v12
  ds_read_b128 a[72:75], v4 offset:6912
  ds_read_b128 a[84:87], v8 offset:6912
  v_and_b32 v46, v109, v19
  v_and_b32 v47, v109, v20
  v_smfmac_f32_16x16x64_bf16 v[168:171], v[32:35], a[24:31], v12
  ds_read_b128 a[76:79], v8 offset:4608
  ds_read_b128 a[88:91], v4 offset:11520
  v_and_b32 v48, v110, v17
  v_smfmac_f32_16x16x64_bf16 v[216:219], v[32:35], a[32:39], v12
  ds_read_b128 a[80:83], v4 offset:9216
  ds_read_b128 a[92:95], v8 offset:9216
  v_and_b32 v49, v110, v18
  v_and_b32 v50, v110, v19
  s_add_u32 m0, s62, 98304
  v_smfmac_f32_16x16x64_bf16 v[72:75], v[36:39], a[16:23], v12
  buffer_load_dwordx4 v86, s[24:27], s54 offen lds
  v_and_b32_e64 v51, v110, v20
  s_add_u32 m0, s62, 102400
  v_smfmac_f32_16x16x64_bf16 v[120:123], v[36:39], a[24:31], v12
  buffer_load_dwordx4 v87, s[24:27], s54 offen lds
  ds_read_b32 v108, v9 offset:128
  s_add_u32 m0, s62, 106496
  v_smfmac_f32_16x16x64_bf16 v[168:171], v[36:39], a[32:39], v12
  buffer_load_dwordx4 v88, s[24:27], s54 offen lds
  ds_read_u16 v109, v10 offset:128
  v_smfmac_f32_16x16x64_bf16 v[216:219], v[36:39], a[40:47], v12
  ds_read_u16 v110, v11 offset:2432
  v_pk_mul_f32 v[60:61], v[64:65], v[64:65]
  v_pk_mul_f32 v[62:63], v[112:113], v[112:113]
  v_pk_mul_f32 v[24:25], v[160:161], v[160:161]
  v_pk_mul_f32 v[26:27], v[208:209], v[208:209]
  v_pk_fma_f32 v[60:61], v[66:67], v[66:67], v[60:61]
  v_pk_fma_f32 v[62:63], v[114:115], v[114:115], v[62:63]
  v_pk_fma_f32 v[24:25], v[162:163], v[162:163], v[24:25]
  v_pk_fma_f32 v[26:27], v[210:211], v[210:211], v[26:27]
  v_pk_add_f32 v[52:53], v[64:65], v[66:67]
  v_pk_add_f32 v[54:55], v[112:113], v[114:115]
  v_pk_add_f32 v[56:57], v[160:161], v[162:163]
  v_pk_add_f32 v[58:59], v[208:209], v[210:211]
  v_pk_fma_f32 v[60:61], v[68:69], v[68:69], v[60:61]
  v_pk_fma_f32 v[62:63], v[116:117], v[116:117], v[62:63]
  v_pk_fma_f32 v[24:25], v[164:165], v[164:165], v[24:25]
  v_pk_fma_f32 v[26:27], v[212:213], v[212:213], v[26:27]
  v_pk_add_f32 v[52:53], v[52:53], v[68:69]
  v_pk_add_f32 v[54:55], v[54:55], v[116:117]
  v_pk_add_f32 v[56:57], v[56:57], v[164:165]
  v_pk_add_f32 v[58:59], v[58:59], v[212:213]
  v_pk_fma_f32 v[60:61], v[70:71], v[70:71], v[60:61]
  v_pk_fma_f32 v[62:63], v[118:119], v[118:119], v[62:63]
  v_pk_fma_f32 v[24:25], v[166:167], v[166:167], v[24:25]
  v_pk_fma_f32 v[26:27], v[214:215], v[214:215], v[26:27]
  v_pk_add_f32 v[52:53], v[52:53], v[70:71]
  v_pk_add_f32 v[54:55], v[54:55], v[118:119]
  v_pk_add_f32 v[56:57], v[56:57], v[166:167]
  v_pk_add_f32 v[58:59], v[58:59], v[214:215]
  v_pk_fma_f32 v[60:61], v[72:73], v[72:73], v[60:61]
  v_pk_fma_f32 v[62:63], v[120:121], v[120:121], v[62:63]
  v_pk_fma_f32 v[24:25], v[168:169], v[168:169], v[24:25]
  v_pk_fma_f32 v[26:27], v[216:217], v[216:217], v[26:27]
  v_pk_add_f32 v[52:53], v[52:53], v[72:73]
  v_pk_add_f32 v[54:55], v[54:55], v[120:121]
  v_pk_add_f32 v[56:57], v[56:57], v[168:169]
  v_pk_add_f32 v[58:59], v[58:59], v[216:217]
  v_pk_fma_f32 v[60:61], v[74:75], v[74:75], v[60:61]
  v_pk_fma_f32 v[62:63], v[122:123], v[122:123], v[62:63]
  v_pk_fma_f32 v[24:25], v[170:171], v[170:171], v[24:25]
  v_pk_fma_f32 v[26:27], v[218:219], v[218:219], v[26:27]
  v_pk_add_f32 v[52:53], v[52:53], v[74:75]
  v_pk_add_f32 v[54:55], v[54:55], v[122:123]
  v_pk_add_f32 v[56:57], v[56:57], v[170:171]
  v_pk_add_f32 v[58:59], v[58:59], v[218:219]
  v_add_u32 v1, 36864, v1
  v_add_u32 v2, 36864, v2
  v_add_u32 v3, 36864, v3
  v_add_u32 v4, 36864, v4
  v_add_u32 v5, 36864, v5
  v_add_u32 v6, 36864, v6
  v_add_u32 v7, 36864, v7
  v_add_u32 v8, 36864, v8
  s_waitcnt vmcnt(15)
  s_barrier
  s_waitcnt lgkmcnt(3)
  v_mfma_f32_16x16x32_bf16 v[76:79], v[40:43], a[48:51], 0
  ds_read_b128 a[0:3], v1 offset:0
  v_mfma_f32_16x16x32_bf16 v[124:127], v[40:43], a[56:59], 0
  ds_read_b128 a[8:11], v1 offset:2304
  s_waitcnt lgkmcnt(2)
  v_and_b32 v28, v108, v13
  v_and_b32 v29, v108, v14
  v_mfma_f32_16x16x32_bf16 v[172:175], v[40:43], a[64:67], 0
  ds_read_b128 a[12:15], v5 offset:0
  v_and_b32 v30, v108, v15
  v_mfma_f32_16x16x32_bf16 v[220:223], v[40:43], a[72:75], 0
  ds_read_b128 a[16:19], v1 offset:4608
  v_and_b32 v31, v108, v16
  v_and_b32 v32, v109, v17
  v_smfmac_f32_16x16x64_bf16 v[76:79], v[44:47], a[56:63], v12
  ds_read_b128 a[20:23], v5 offset:2304
  v_and_b32 v33, v109, v18
  v_smfmac_f32_16x16x64_bf16 v[124:127], v[44:47], a[64:71], v12
  ds_read_b128 a[24:27], v1 offset:6912
  ds_read_b128 a[36:39], v5 offset:6912
  v_and_b32 v34, v109, v19
  v_and_b32 v35, v109, v20
  v_smfmac_f32_16x16x64_bf16 v[172:175], v[44:47], a[72:79], v12
  ds_read_b128 a[28:31], v5 offset:4608
  ds_read_b128 a[40:43], v1 offset:11520
  v_and_b32 v36, v110, v17
  v_smfmac_f32_16x16x64_bf16 v[220:223], v[44:47], a[80:87], v12
  ds_read_b128 a[32:35], v1 offset:9216
  ds_read_b128 a[44:47], v5 offset:9216
  v_and_b32 v37, v110, v18
  v_and_b32 v38, v110, v19
  v_smfmac_f32_16x16x64_bf16 v[76:79], v[48:51], a[64:71], v12
  v_and_b32 v39, v110, v20
  v_smfmac_f32_16x16x64_bf16 v[124:127], v[48:51], a[72:79], v12
  ds_read_b32 v108, v9 offset:160
  v_smfmac_f32_16x16x64_bf16 v[172:175], v[48:51], a[80:87], v12
  ds_read_u16 v109, v10 offset:160
  v_smfmac_f32_16x16x64_bf16 v[220:223], v[48:51], a[88:95], v12
  ds_read_u16 v110, v11 offset:2464
  s_waitcnt lgkmcnt(3)
  v_mfma_f32_16x16x32_bf16 v[80:83], v[28:31], a[0:3], 0
  ds_read_b128 a[48:51], v2 offset:0
  v_mfma_f32_16x16x32_bf16 v[128:131], v[28:31], a[8:11], 0
  ds_read_b128 a[56:59], v2 offset:2304
  s_waitcnt lgkmcnt(2)
  v_and_b32 v40, v108, v13
  v_and_b32 v41, v108, v14
  v_mfma_f32_16x16x32_bf16 v[176:179], v[28:31], a[16:19], 0
  ds_read_b128 a[60:63], v6 offset:0
  v_and_b32 v42, v108, v15
  v_mfma_f32_16x16x32_bf16 v[224:227], v[28:31], a[24:27], 0
  ds_read_b128 a[64:67], v2 offset:4608
  v_and_b32 v43, v108, v16
  v_and_b32 v44, v109, v17
  v_smfmac_f32_16x16x64_bf16 v[80:83], v[32:35], a[8:15], v12
  ds_read_b128 a[68:71], v6 offset:2304
  v_and_b32 v45, v109, v18
  v_smfmac_f32_16x16x64_bf16 v[128:131], v[32:35], a[16:23], v12
  ds_read_b128 a[72:75], v2 offset:6912
  ds_read_b128 a[84:87], v6 offset:6912
  v_and_b32 v46, v109, v19
  v_and_b32 v47, v109, v20
  v_smfmac_f32_16x16x64_bf16 v[176:179], v[32:35], a[24:31], v12
  ds_read_b128 a[76:79], v6 offset:4608
  ds_read_b128 a[88:91], v2 offset:11520
  v_and_b32 v48, v110, v17
  v_smfmac_f32_16x16x64_bf16 v[224:227], v[32:35], a[32:39], v12
  ds_read_b128 a[80:83], v2 offset:9216
  ds_read_b128 a[92:95], v6 offset:9216
  v_and_b32 v49, v110, v18
  v_and_b32 v50, v110, v19
  v_smfmac_f32_16x16x64_bf16 v[80:83], v[36:39], a[16:23], v12
  v_and_b32 v51, v110, v20
  v_smfmac_f32_16x16x64_bf16 v[128:131], v[36:39], a[24:31], v12
  ds_read_b32 v108, v9 offset:192
  v_smfmac_f32_16x16x64_bf16 v[176:179], v[36:39], a[32:39], v12
  ds_read_u16 v109, v10 offset:192
  v_smfmac_f32_16x16x64_bf16 v[224:227], v[36:39], a[40:47], v12
  ds_read_u16 v110, v11 offset:2496
  s_waitcnt lgkmcnt(3)
  v_mfma_f32_16x16x32_bf16 v[84:87], v[40:43], a[48:51], 0
  ds_read_b128 a[0:3], v3 offset:0
  v_mfma_f32_16x16x32_bf16 v[132:135], v[40:43], a[56:59], 0
  ds_read_b128 a[8:11], v3 offset:2304
  s_waitcnt lgkmcnt(2)
  v_and_b32 v28, v108, v13
  v_and_b32 v29, v108, v14
  v_mfma_f32_16x16x32_bf16 v[180:183], v[40:43], a[64:67], 0
  ds_read_b128 a[12:15], v7 offset:0
  v_and_b32 v30, v108, v15
  v_mfma_f32_16x16x32_bf16 v[228:231], v[40:43], a[72:75], 0
  ds_read_b128 a[16:19], v3 offset:4608
  v_and_b32 v31, v108, v16
  v_and_b32 v32, v109, v17
  v_smfmac_f32_16x16x64_bf16 v[84:87], v[44:47], a[56:63], v12
  ds_read_b128 a[20:23], v7 offset:2304
  v_and_b32 v33, v109, v18
  v_smfmac_f32_16x16x64_bf16 v[132:135], v[44:47], a[64:71], v12
  ds_read_b128 a[24:27], v3 offset:6912
  ds_read_b128 a[36:39], v7 offset:6912
  v_and_b32 v34, v109, v19
  v_and_b32 v35, v109, v20
  v_smfmac_f32_16x16x64_bf16 v[180:183], v[44:47], a[72:79], v12
  ds_read_b128 a[28:31], v7 offset:4608
  ds_read_b128 a[40:43], v3 offset:11520
  v_and_b32 v36, v110, v17
  v_smfmac_f32_16x16x64_bf16 v[228:231], v[44:47], a[80:87], v12
  ds_read_b128 a[32:35], v3 offset:9216
  ds_read_b128 a[44:47], v7 offset:9216
  v_and_b32 v37, v110, v18
  v_and_b32 v38, v110, v19
  v_smfmac_f32_16x16x64_bf16 v[84:87], v[48:51], a[64:71], v12
  v_and_b32 v39, v110, v20
  v_smfmac_f32_16x16x64_bf16 v[132:135], v[48:51], a[72:79], v12
  ds_read_b32 v108, v9 offset:224
  v_smfmac_f32_16x16x64_bf16 v[180:183], v[48:51], a[80:87], v12
  ds_read_u16 v109, v10 offset:224
  v_smfmac_f32_16x16x64_bf16 v[228:231], v[48:51], a[88:95], v12
  ds_read_u16 v110, v11 offset:2528
  s_waitcnt lgkmcnt(3)
  v_mfma_f32_16x16x32_bf16 v[88:91], v[28:31], a[0:3], 0
  ds_read_b128 a[48:51], v4 offset:0
  v_mfma_f32_16x16x32_bf16 v[136:139], v[28:31], a[8:11], 0
  ds_read_b128 a[56:59], v4 offset:2304
  s_waitcnt lgkmcnt(2)
  v_and_b32 v40, v108, v13
  v_and_b32 v41, v108, v14
  v_mfma_f32_16x16x32_bf16 v[184:187], v[28:31], a[16:19], 0
  ds_read_b128 a[60:63], v8 offset:0
  v_and_b32 v42, v108, v15
  v_mfma_f32_16x16x32_bf16 v[232:235], v[28:31], a[24:27], 0
  ds_read_b128 a[64:67], v4 offset:4608
  v_and_b32 v43, v108, v16
  v_and_b32 v44, v109, v17
  v_smfmac_f32_16x16x64_bf16 v[88:91], v[32:35], a[8:15], v12
  ds_read_b128 a[68:71], v8 offset:2304
  v_and_b32 v45, v109, v18
  v_smfmac_f32_16x16x64_bf16 v[136:139], v[32:35], a[16:23], v12
  ds_read_b128 a[72:75], v4 offset:6912
  ds_read_b128 a[84:87], v8 offset:6912
  v_and_b32 v46, v109, v19
  v_and_b32 v47, v109, v20
  v_smfmac_f32_16x16x64_bf16 v[184:187], v[32:35], a[24:31], v12
  ds_read_b128 a[76:79], v8 offset:4608
  ds_read_b128 a[88:91], v4 offset:11520
  v_and_b32 v48, v110, v17
  v_smfmac_f32_16x16x64_bf16 v[232:235], v[32:35], a[32:39], v12
  ds_read_b128 a[80:83], v4 offset:9216
  ds_read_b128 a[92:95], v8 offset:9216
  v_and_b32 v49, v110, v18
  v_and_b32 v50, v110, v19
  v_smfmac_f32_16x16x64_bf16 v[88:91], v[36:39], a[16:23], v12
  v_and_b32 v51, v110, v20
  v_smfmac_f32_16x16x64_bf16 v[136:139], v[36:39], a[24:31], v12
  ds_read_b32 v108, v9 offset:256
  v_smfmac_f32_16x16x64_bf16 v[184:187], v[36:39], a[32:39], v12
  ds_read_u16 v109, v10 offset:256
  v_smfmac_f32_16x16x64_bf16 v[232:235], v[36:39], a[40:47], v12
  ds_read_u16 v110, v11 offset:2560
  v_pk_fma_f32 v[60:61], v[76:77], v[76:77], v[60:61]
  v_pk_fma_f32 v[62:63], v[124:125], v[124:125], v[62:63]
  v_pk_fma_f32 v[24:25], v[172:173], v[172:173], v[24:25]
  v_pk_fma_f32 v[26:27], v[220:221], v[220:221], v[26:27]
  v_pk_add_f32 v[52:53], v[52:53], v[76:77]
  v_pk_add_f32 v[54:55], v[54:55], v[124:125]
  v_pk_add_f32 v[56:57], v[56:57], v[172:173]
  v_pk_add_f32 v[58:59], v[58:59], v[220:221]
  v_pk_fma_f32 v[60:61], v[78:79], v[78:79], v[60:61]
  v_pk_fma_f32 v[62:63], v[126:127], v[126:127], v[62:63]
  v_pk_fma_f32 v[24:25], v[174:175], v[174:175], v[24:25]
  v_pk_fma_f32 v[26:27], v[222:223], v[222:223], v[26:27]
  v_pk_add_f32 v[52:53], v[52:53], v[78:79]
  v_pk_add_f32 v[54:55], v[54:55], v[126:127]
  v_pk_add_f32 v[56:57], v[56:57], v[174:175]
  v_pk_add_f32 v[58:59], v[58:59], v[222:223]
  v_pk_fma_f32 v[60:61], v[80:81], v[80:81], v[60:61]
  v_pk_fma_f32 v[62:63], v[128:129], v[128:129], v[62:63]
  v_pk_fma_f32 v[24:25], v[176:177], v[176:177], v[24:25]
  v_pk_fma_f32 v[26:27], v[224:225], v[224:225], v[26:27]
  v_pk_add_f32 v[52:53], v[52:53], v[80:81]
  v_pk_add_f32 v[54:55], v[54:55], v[128:129]
  v_pk_add_f32 v[56:57], v[56:57], v[176:177]
  v_pk_add_f32 v[58:59], v[58:59], v[224:225]
  v_pk_fma_f32 v[60:61], v[82:83], v[82:83], v[60:61]
  v_pk_fma_f32 v[62:63], v[130:131], v[130:131], v[62:63]
  v_pk_fma_f32 v[24:25], v[178:179], v[178:179], v[24:25]
  v_pk_fma_f32 v[26:27], v[226:227], v[226:227], v[26:27]
  v_pk_add_f32 v[52:53], v[52:53], v[82:83]
  v_pk_add_f32 v[54:55], v[54:55], v[130:131]
  v_pk_add_f32 v[56:57], v[56:57], v[178:179]
  v_pk_add_f32 v[58:59], v[58:59], v[226:227]
  v_pk_fma_f32 v[60:61], v[84:85], v[84:85], v[60:61]
  v_pk_fma_f32 v[62:63], v[132:133], v[132:133], v[62:63]
  v_pk_fma_f32 v[24:25], v[180:181], v[180:181], v[24:25]
  v_pk_fma_f32 v[26:27], v[228:229], v[228:229], v[26:27]
  v_pk_add_f32 v[52:53], v[52:53], v[84:85]
  v_pk_add_f32 v[54:55], v[54:55], v[132:133]
  v_pk_add_f32 v[56:57], v[56:57], v[180:181]
  v_pk_add_f32 v[58:59], v[58:59], v[228:229]
  v_pk_fma_f32 v[60:61], v[86:87], v[86:87], v[60:61]
  v_pk_fma_f32 v[62:63], v[134:135], v[134:135], v[62:63]
  v_pk_fma_f32 v[24:25], v[182:183], v[182:183], v[24:25]
  v_pk_fma_f32 v[26:27], v[230:231], v[230:231], v[26:27]
  v_pk_add_f32 v[52:53], v[52:53], v[86:87]
  v_pk_add_f32 v[54:55], v[54:55], v[134:135]
  v_pk_add_f32 v[56:57], v[56:57], v[182:183]
  v_pk_add_f32 v[58:59], v[58:59], v[230:231]
  v_pk_fma_f32 v[60:61], v[88:89], v[88:89], v[60:61]
  v_pk_fma_f32 v[62:63], v[136:137], v[136:137], v[62:63]
  v_pk_fma_f32 v[24:25], v[184:185], v[184:185], v[24:25]
  v_pk_fma_f32 v[26:27], v[232:233], v[232:233], v[26:27]
  v_pk_add_f32 v[52:53], v[52:53], v[88:89]
  v_pk_add_f32 v[54:55], v[54:55], v[136:137]
  v_pk_add_f32 v[56:57], v[56:57], v[184:185]
  v_pk_add_f32 v[58:59], v[58:59], v[232:233]
  v_pk_fma_f32 v[60:61], v[90:91], v[90:91], v[60:61]
  v_pk_fma_f32 v[62:63], v[138:139], v[138:139], v[62:63]
  v_pk_fma_f32 v[24:25], v[186:187], v[186:187], v[24:25]
  v_pk_fma_f32 v[26:27], v[234:235], v[234:235], v[26:27]
  v_pk_add_f32 v[52:53], v[52:53], v[90:91]
  v_pk_add_f32 v[54:55], v[54:55], v[138:139]
  v_pk_add_f32 v[56:57], v[56:57], v[186:187]
  v_pk_add_f32 v[58:59], v[58:59], v[234:235]
  v_add_u32 v1, 36864, v1
  v_add_u32 v2, 36864, v2
  v_add_u32 v3, 36864, v3
  v_add_u32 v4, 36864, v4
  v_add_u32 v5, 36864, v5
  v_add_u32 v6, 36864, v6
  v_add_u32 v7, 36864, v7
  v_add_u32 v8, 36864, v8
  s_waitcnt vmcnt(0)
  s_barrier
  s_waitcnt lgkmcnt(3)
  v_mfma_f32_16x16x32_bf16 v[92:95], v[40:43], a[48:51], 0
  ds_read_b128 a[0:3], v1 offset:0
  v_mfma_f32_16x16x32_bf16 v[140:143], v[40:43], a[56:59], 0
  ds_read_b128 a[8:11], v1 offset:2304
  s_waitcnt lgkmcnt(2)
  v_and_b32 v28, v108, v13
  v_and_b32 v29, v108, v14
  v_mfma_f32_16x16x32_bf16 v[188:191], v[40:43], a[64:67], 0
  ds_read_b128 a[12:15], v5 offset:0
  v_and_b32 v30, v108, v15
  v_mfma_f32_16x16x32_bf16 v[236:239], v[40:43], a[72:75], 0
  ds_read_b128 a[16:19], v1 offset:4608
  v_and_b32 v31, v108, v16
  v_and_b32 v32, v109, v17
  v_smfmac_f32_16x16x64_bf16 v[92:95], v[44:47], a[56:63], v12
  ds_read_b128 a[20:23], v5 offset:2304
  v_and_b32 v33, v109, v18
  v_smfmac_f32_16x16x64_bf16 v[140:143], v[44:47], a[64:71], v12
  ds_read_b128 a[24:27], v1 offset:6912
  ds_read_b128 a[36:39], v5 offset:6912
  v_and_b32 v34, v109, v19
  v_and_b32 v35, v109, v20
  v_smfmac_f32_16x16x64_bf16 v[188:191], v[44:47], a[72:79], v12
  ds_read_b128 a[28:31], v5 offset:4608
  ds_read_b128 a[40:43], v1 offset:11520
  v_and_b32 v36, v110, v17
  v_smfmac_f32_16x16x64_bf16 v[236:239], v[44:47], a[80:87], v12
  ds_read_b128 a[32:35], v1 offset:9216
  ds_read_b128 a[44:47], v5 offset:9216
  v_and_b32 v37, v110, v18
  v_and_b32 v38, v110, v19
  v_smfmac_f32_16x16x64_bf16 v[92:95], v[48:51], a[64:71], v12
  v_and_b32 v39, v110, v20
  v_smfmac_f32_16x16x64_bf16 v[140:143], v[48:51], a[72:79], v12
  ds_read_b32 v108, v9 offset:288
  v_smfmac_f32_16x16x64_bf16 v[188:191], v[48:51], a[80:87], v12
  ds_read_u16 v109, v10 offset:288
  v_smfmac_f32_16x16x64_bf16 v[236:239], v[48:51], a[88:95], v12
  ds_read_u16 v110, v11 offset:2592
  s_waitcnt lgkmcnt(3)
  v_mfma_f32_16x16x32_bf16 v[96:99], v[28:31], a[0:3], 0
  ds_read_b128 a[48:51], v2 offset:0
  v_mfma_f32_16x16x32_bf16 v[144:147], v[28:31], a[8:11], 0
  ds_read_b128 a[56:59], v2 offset:2304
  s_waitcnt lgkmcnt(2)
  v_and_b32 v40, v108, v13
  v_and_b32 v41, v108, v14
  v_mfma_f32_16x16x32_bf16 v[192:195], v[28:31], a[16:19], 0
  ds_read_b128 a[60:63], v6 offset:0
  v_and_b32 v42, v108, v15
  v_mfma_f32_16x16x32_bf16 v[240:243], v[28:31], a[24:27], 0
  ds_read_b128 a[64:67], v2 offset:4608
  v_and_b32 v43, v108, v16
  v_and_b32 v44, v109, v17
  v_smfmac_f32_16x16x64_bf16 v[96:99], v[32:35], a[8:15], v12
  ds_read_b128 a[68:71], v6 offset:2304
  v_and_b32 v45, v109, v18
  v_smfmac_f32_16x16x64_bf16 v[144:147], v[32:35], a[16:23], v12
  ds_read_b128 a[72:75], v2 offset:6912
  ds_read_b128 a[84:87], v6 offset:6912
  v_and_b32 v46, v109, v19
  v_and_b32 v47, v109, v20
  v_smfmac_f32_16x16x64_bf16 v[192:195], v[32:35], a[24:31], v12
  ds_read_b128 a[76:79], v6 offset:4608
  ds_read_b128 a[88:91], v2 offset:11520
  v_and_b32 v48, v110, v17
  v_smfmac_f32_16x16x64_bf16 v[240:243], v[32:35], a[32:39], v12
  ds_read_b128 a[80:83], v2 offset:9216
  ds_read_b128 a[92:95], v6 offset:9216
  v_and_b32 v49, v110, v18
  v_and_b32 v50, v110, v19
  s_add_u32 m0, s56, 0
  v_smfmac_f32_16x16x64_bf16 v[96:99], v[36:39], a[16:23], v12
  buffer_load_dwordx4 v21, s[28:31], s72 offen offset:0 lds
  v_and_b32 v51, v110, v20
  v_smfmac_f32_16x16x64_bf16 v[144:147], v[36:39], a[24:31], v12
  buffer_load_dwordx4 v21, s[28:31], s73 offen offset:1024 lds
  ds_read_b32 v108, v9 offset:320
  v_smfmac_f32_16x16x64_bf16 v[192:195], v[36:39], a[32:39], v12
  buffer_load_dwordx4 v21, s[28:31], s74 offen offset:2048 lds
  ds_read_u16 v109, v10 offset:320
  v_smfmac_f32_16x16x64_bf16 v[240:243], v[36:39], a[40:47], v12
  ds_read_u16 v110, v11 offset:2624
  s_waitcnt lgkmcnt(3)
  v_mfma_f32_16x16x32_bf16 v[100:103], v[40:43], a[48:51], 0
  ds_read_b128 a[0:3], v3 offset:0
  v_mfma_f32_16x16x32_bf16 v[148:151], v[40:43], a[56:59], 0
  ds_read_b128 a[8:11], v3 offset:2304
  s_waitcnt lgkmcnt(2)
  v_and_b32 v28, v108, v13
  v_and_b32 v29, v108, v14
  v_mfma_f32_16x16x32_bf16 v[196:199], v[40:43], a[64:67], 0
  ds_read_b128 a[12:15], v7 offset:0
  v_and_b32 v30, v108, v15
  v_mfma_f32_16x16x32_bf16 v[244:247], v[40:43], a[72:75], 0
  ds_read_b128 a[16:19], v3 offset:4608
  v_and_b32 v31, v108, v16
  v_and_b32 v32, v109, v17
  v_smfmac_f32_16x16x64_bf16 v[100:103], v[44:47], a[56:63], v12
  ds_read_b128 a[20:23], v7 offset:2304
  v_and_b32 v33, v109, v18
  v_smfmac_f32_16x16x64_bf16 v[148:151], v[44:47], a[64:71], v12
  ds_read_b128 a[24:27], v3 offset:6912
  ds_read_b128 a[36:39], v7 offset:6912
  v_and_b32 v34, v109, v19
  v_and_b32 v35, v109, v20
  v_smfmac_f32_16x16x64_bf16 v[196:199], v[44:47], a[72:79], v12
  ds_read_b128 a[28:31], v7 offset:4608
  ds_read_b128 a[40:43], v3 offset:11520
  v_and_b32 v36, v110, v17
  v_smfmac_f32_16x16x64_bf16 v[244:247], v[44:47], a[80:87], v12
  ds_read_b128 a[32:35], v3 offset:9216
  ds_read_b128 a[44:47], v7 offset:9216
  v_and_b32 v37, v110, v18
  v_and_b32 v38, v110, v19
  v_smfmac_f32_16x16x64_bf16 v[100:103], v[48:51], a[64:71], v12
  buffer_load_dwordx4 v21, s[28:31], s75 offen offset:3072 lds
  v_and_b32 v39, v110, v20
  s_add_u32 m0, s56, 4096
  v_smfmac_f32_16x16x64_bf16 v[148:151], v[48:51], a[72:79], v12
  buffer_load_dwordx4 v21, s[28:31], s76 offen offset:0 lds
  ds_read_b32 v108, v9 offset:352
  v_smfmac_f32_16x16x64_bf16 v[196:199], v[48:51], a[80:87], v12
  buffer_load_dwordx4 v21, s[28:31], s77 offen offset:1024 lds
  ds_read_u16 v109, v10 offset:352
  v_smfmac_f32_16x16x64_bf16 v[244:247], v[48:51], a[88:95], v12
  ds_read_u16 v110, v11 offset:2656
  s_waitcnt lgkmcnt(3)
  v_mfma_f32_16x16x32_bf16 v[104:107], v[28:31], a[0:3], 0
  ds_read_b128 a[48:51], v4 offset:0
  v_mfma_f32_16x16x32_bf16 v[152:155], v[28:31], a[8:11], 0
  ds_read_b128 a[56:59], v4 offset:2304
  s_waitcnt lgkmcnt(2)
  v_and_b32 v40, v108, v13
  v_and_b32 v41, v108, v14
  v_mfma_f32_16x16x32_bf16 v[200:203], v[28:31], a[16:19], 0
  ds_read_b128 a[60:63], v8 offset:0
  v_and_b32 v42, v108, v15
  v_mfma_f32_16x16x32_bf16 v[248:251], v[28:31], a[24:27], 0
  ds_read_b128 a[64:67], v4 offset:4608
  v_and_b32 v43, v108, v16
  v_and_b32 v44, v109, v17
  v_smfmac_f32_16x16x64_bf16 v[104:107], v[32:35], a[8:15], v12
  ds_read_b128 a[68:71], v8 offset:2304
  v_and_b32 v45, v109, v18
  v_smfmac_f32_16x16x64_bf16 v[152:155], v[32:35], a[16:23], v12
  ds_read_b128 a[72:75], v4 offset:6912
  ds_read_b128 a[84:87], v8 offset:6912
  v_and_b32 v46, v109, v19
  v_and_b32 v47, v109, v20
  v_smfmac_f32_16x16x64_bf16 v[200:203], v[32:35], a[24:31], v12
  ds_read_b128 a[76:79], v8 offset:4608
  ds_read_b128 a[88:91], v4 offset:11520
  v_and_b32 v48, v110, v17
  v_smfmac_f32_16x16x64_bf16 v[248:251], v[32:35], a[32:39], v12
  ds_read_b128 a[80:83], v4 offset:9216
  ds_read_b128 a[92:95], v8 offset:9216
  v_and_b32 v49, v110, v18
  v_and_b32 v50, v110, v19
  v_smfmac_f32_16x16x64_bf16 v[104:107], v[36:39], a[16:23], v12
  buffer_load_dwordx4 v21, s[28:31], s78 offen offset:2048 lds
  v_and_b32 v51, v110, v20
  v_smfmac_f32_16x16x64_bf16 v[152:155], v[36:39], a[24:31], v12
  buffer_load_dwordx4 v21, s[28:31], s79 offen offset:3072 lds
  s_add_u32 m0, s56, 8192
  v_smfmac_f32_16x16x64_bf16 v[200:203], v[36:39], a[32:39], v12
  buffer_load_dwordx4 v21, s[28:31], s80 offen offset:0 lds
  v_smfmac_f32_16x16x64_bf16 v[248:251], v[36:39], a[40:47], v12
  s_waitcnt lgkmcnt(0)
  v_mfma_f32_16x16x32_bf16 v[108:111], v[40:43], a[48:51], 0
  v_mfma_f32_16x16x32_bf16 v[156:159], v[40:43], a[56:59], 0
  v_mfma_f32_16x16x32_bf16 v[204:207], v[40:43], a[64:67], 0
  v_mfma_f32_16x16x32_bf16 v[252:255], v[40:43], a[72:75], 0
  v_smfmac_f32_16x16x64_bf16 v[108:111], v[44:47], a[56:63], v12
  v_smfmac_f32_16x16x64_bf16 v[156:159], v[44:47], a[64:71], v12
  v_smfmac_f32_16x16x64_bf16 v[204:207], v[44:47], a[72:79], v12
  v_smfmac_f32_16x16x64_bf16 v[252:255], v[44:47], a[80:87], v12
  v_smfmac_f32_16x16x64_bf16 v[108:111], v[48:51], a[64:71], v12
  buffer_load_dwordx4 v21, s[28:31], s81 offen offset:1024 lds
  v_smfmac_f32_16x16x64_bf16 v[156:159], v[48:51], a[72:79], v12
  buffer_load_dwordx4 v21, s[28:31], s82 offen offset:2048 lds
  v_smfmac_f32_16x16x64_bf16 v[204:207], v[48:51], a[80:87], v12
  buffer_load_dwordx4 v21, s[28:31], s83 offen offset:3072 lds
  v_smfmac_f32_16x16x64_bf16 v[252:255], v[48:51], a[88:95], v12
  s_barrier
  v_mov_b32 v11, 0
  global_load_dword v12, v11, s[18:19] sc0 sc1
  v_pk_fma_f32 v[60:61], v[92:93], v[92:93], v[60:61]
  v_pk_fma_f32 v[62:63], v[140:141], v[140:141], v[62:63]
  v_pk_fma_f32 v[24:25], v[188:189], v[188:189], v[24:25]
  v_pk_fma_f32 v[26:27], v[236:237], v[236:237], v[26:27]
  v_pk_add_f32 v[52:53], v[52:53], v[92:93]
  v_pk_add_f32 v[54:55], v[54:55], v[140:141]
  v_pk_add_f32 v[56:57], v[56:57], v[188:189]
  v_pk_add_f32 v[58:59], v[58:59], v[236:237]
  v_pk_fma_f32 v[60:61], v[94:95], v[94:95], v[60:61]
  v_pk_fma_f32 v[62:63], v[142:143], v[142:143], v[62:63]
  v_pk_fma_f32 v[24:25], v[190:191], v[190:191], v[24:25]
  v_pk_fma_f32 v[26:27], v[238:239], v[238:239], v[26:27]
  v_pk_add_f32 v[52:53], v[52:53], v[94:95]
  v_pk_add_f32 v[54:55], v[54:55], v[142:143]
  v_pk_add_f32 v[56:57], v[56:57], v[190:191]
  v_pk_add_f32 v[58:59], v[58:59], v[238:239]
  v_pk_fma_f32 v[60:61], v[96:97], v[96:97], v[60:61]
  v_pk_fma_f32 v[62:63], v[144:145], v[144:145], v[62:63]
  v_pk_fma_f32 v[24:25], v[192:193], v[192:193], v[24:25]
  v_pk_fma_f32 v[26:27], v[240:241], v[240:241], v[26:27]
  v_pk_add_f32 v[52:53], v[52:53], v[96:97]
  v_pk_add_f32 v[54:55], v[54:55], v[144:145]
  v_pk_add_f32 v[56:57], v[56:57], v[192:193]
  v_pk_add_f32 v[58:59], v[58:59], v[240:241]
  v_pk_fma_f32 v[60:61], v[98:99], v[98:99], v[60:61]
  v_pk_fma_f32 v[62:63], v[146:147], v[146:147], v[62:63]
  v_pk_fma_f32 v[24:25], v[194:195], v[194:195], v[24:25]
  v_pk_fma_f32 v[26:27], v[242:243], v[242:243], v[26:27]
  v_pk_add_f32 v[52:53], v[52:53], v[98:99]
  v_pk_add_f32 v[54:55], v[54:55], v[146:147]
  v_pk_add_f32 v[56:57], v[56:57], v[194:195]
  v_pk_add_f32 v[58:59], v[58:59], v[242:243]
  v_pk_fma_f32 v[60:61], v[100:101], v[100:101], v[60:61]
  v_pk_fma_f32 v[62:63], v[148:149], v[148:149], v[62:63]
  v_pk_fma_f32 v[24:25], v[196:197], v[196:197], v[24:25]
  v_pk_fma_f32 v[26:27], v[244:245], v[244:245], v[26:27]
  v_pk_add_f32 v[52:53], v[52:53], v[100:101]
  v_pk_add_f32 v[54:55], v[54:55], v[148:149]
  v_pk_add_f32 v[56:57], v[56:57], v[196:197]
  v_pk_add_f32 v[58:59], v[58:59], v[244:245]
  v_pk_fma_f32 v[60:61], v[102:103], v[102:103], v[60:61]
  v_pk_fma_f32 v[62:63], v[150:151], v[150:151], v[62:63]
  v_pk_fma_f32 v[24:25], v[198:199], v[198:199], v[24:25]
  v_pk_fma_f32 v[26:27], v[246:247], v[246:247], v[26:27]
  v_pk_add_f32 v[52:53], v[52:53], v[102:103]
  v_pk_add_f32 v[54:55], v[54:55], v[150:151]
  v_pk_add_f32 v[56:57], v[56:57], v[198:199]
  v_pk_add_f32 v[58:59], v[58:59], v[246:247]
  v_pk_fma_f32 v[60:61], v[104:105], v[104:105], v[60:61]
  v_pk_fma_f32 v[62:63], v[152:153], v[152:153], v[62:63]
  v_pk_fma_f32 v[24:25], v[200:201], v[200:201], v[24:25]
  v_pk_fma_f32 v[26:27], v[248:249], v[248:249], v[26:27]
  v_pk_add_f32 v[52:53], v[52:53], v[104:105]
  v_pk_add_f32 v[54:55], v[54:55], v[152:153]
  v_pk_add_f32 v[56:57], v[56:57], v[200:201]
  v_pk_add_f32 v[58:59], v[58:59], v[248:249]
  v_pk_fma_f32 v[60:61], v[106:107], v[106:107], v[60:61]
  v_pk_fma_f32 v[62:63], v[154:155], v[154:155], v[62:63]
  v_pk_fma_f32 v[24:25], v[202:203], v[202:203], v[24:25]
  v_pk_fma_f32 v[26:27], v[250:251], v[250:251], v[26:27]
  v_pk_add_f32 v[52:53], v[52:53], v[106:107]
  v_pk_add_f32 v[54:55], v[54:55], v[154:155]
  v_pk_add_f32 v[56:57], v[56:57], v[202:203]
  v_pk_add_f32 v[58:59], v[58:59], v[250:251]
  v_pk_fma_f32 v[60:61], v[108:109], v[108:109], v[60:61]
  v_pk_fma_f32 v[62:63], v[156:157], v[156:157], v[62:63]
  v_pk_fma_f32 v[24:25], v[204:205], v[204:205], v[24:25]
  v_pk_fma_f32 v[26:27], v[252:253], v[252:253], v[26:27]
  v_pk_add_f32 v[52:53], v[52:53], v[108:109]
  v_pk_add_f32 v[54:55], v[54:55], v[156:157]
  v_pk_add_f32 v[56:57], v[56:57], v[204:205]
  v_pk_add_f32 v[58:59], v[58:59], v[252:253]
  v_pk_fma_f32 v[60:61], v[110:111], v[110:111], v[60:61]
  v_pk_fma_f32 v[62:63], v[158:159], v[158:159], v[62:63]
  v_pk_fma_f32 v[24:25], v[206:207], v[206:207], v[24:25]
  v_pk_fma_f32 v[26:27], v[254:255], v[254:255], v[26:27]
  v_pk_add_f32 v[52:53], v[52:53], v[110:111]
  v_pk_add_f32 v[54:55], v[54:55], v[158:159]
  v_pk_add_f32 v[56:57], v[56:57], v[206:207]
  v_pk_add_f32 v[58:59], v[58:59], v[254:255]
  v_add_f32 v40, v52, v53
  v_add_f32 v41, v54, v55
  v_add_f32 v42, v56, v57
  v_add_f32 v43, v58, v59
  v_add_f32 v44, v60, v61
  v_add_f32 v45, v62, v63
  v_add_f32 v46, v24, v25
  v_add_f32 v47, v26, v27
  v_permlane32_swap_b32 v40, v41
  v_permlane32_swap_b32 v42, v43
  v_permlane32_swap_b32 v44, v45
  v_permlane32_swap_b32 v46, v47
  v_add_f32 v40, v40, v41
  v_add_f32 v42, v42, v43
  v_add_f32 v44, v44, v45
  v_add_f32 v46, v46, v47
  v_permlane16_swap_b32 v40, v42
  s_nop 0
  v_permlane16_swap_b32 v44, v46
  v_add_f32 v22, v40, v42
  v_add_f32 v23, v44, v46
  v_mul_f32 v22, 0x3baaaaab, v22
  v_mul_f32 v23, 0x3baaaaab, v23
  v_fma_f32 v23, -v22, v22, v23
  v_max_f32 v23, 0, v23
  v_add_f32 v23, 0x3727c5ac, v23
  v_rsq_f32 v23, v23
  s_nop 0
  v_mul_f32 v23, 0x3eeff558, v23
  v_mul_f32 v22, v22, v23
  v_sub_f32 v22, 0, v22
  v_mov_b32 v24, v23
  v_mov_b32 v25, v22
  s_nop 0
  v_permlane16_swap_b32 v23, v24
  v_permlane16_swap_b32 v22, v25
  v_mov_b32 v28, v23
  v_mov_b32 v32, v24
  v_mov_b32 v36, v22
  v_mov_b32 v48, v25
  v_permlane32_swap_b32 v28, v23
  v_permlane32_swap_b32 v32, v24
  v_permlane32_swap_b32 v36, v22
  v_permlane32_swap_b32 v48, v25
  v_mov_b32 v30, v23
  v_mov_b32 v34, v24
  v_mov_b32 v38, v22
  v_mov_b32 v50, v25
  s_lshl_b32 s47, s44, 2
  s_min_u32 s47, s47, 10
  s_mul_i32 s47, s47, 6144
  v_and_b32 v14, 15, v0
  v_lshlrev_b32 v14, 4, v14
  v_lshrrev_b32 v15, 5, v0
  v_lshl_add_u32 v14, v15, 10, v14
  v_bfe_u32 v15, v0, 4, 1
  v_lshl_add_u32 v14, v15, 9, v14
  v_add_u32_e64 v13, s47, v14
  v_pk_fma_f32 v[160:161], v[160:161], v[32:33], v[48:49] op_sel_hi:[1,0,0]
  v_pk_fma_f32 v[162:163], v[162:163], v[32:33], v[48:49] op_sel_hi:[1,0,0]
  v_pk_fma_f32 v[164:165], v[164:165], v[32:33], v[48:49] op_sel_hi:[1,0,0]
  v_pk_fma_f32 v[166:167], v[166:167], v[32:33], v[48:49] op_sel_hi:[1,0,0]
  v_pk_fma_f32 v[208:209], v[208:209], v[34:35], v[50:51] op_sel_hi:[1,0,0]
  v_pk_fma_f32 v[210:211], v[210:211], v[34:35], v[50:51] op_sel_hi:[1,0,0]
  v_pk_fma_f32 v[212:213], v[212:213], v[34:35], v[50:51] op_sel_hi:[1,0,0]
  v_pk_fma_f32 v[214:215], v[214:215], v[34:35], v[50:51] op_sel_hi:[1,0,0]
  v_cvt_pk_bf16_f32 v160, v160, v161
  v_cvt_pk_bf16_f32 v161, v162, v163
  v_cvt_pk_bf16_f32 v162, v164, v165
  v_cvt_pk_bf16_f32 v163, v166, v167
  ds_write_b128 v13, v[160:163] offset:12288
  v_cvt_pk_bf16_f32 v208, v208, v209
  v_cvt_pk_bf16_f32 v209, v210, v211
  v_cvt_pk_bf16_f32 v210, v212, v213
  v_cvt_pk_bf16_f32 v211, v214, v215
  ds_write_b128 v13, v[208:211] offset:12544
  s_and_b32 s47, s44, 1
  s_mul_i32 s48, s47, 49152
  v_lshl_add_u32 v1, v0, 4, s48
  s_mul_i32 s48, s47, 36864
  s_sub_u32 s48, 36864, s48
  v_lshl_add_u32 v2, v0, 4, s48
  v_lshrrev_b32 v6, 5, v0
  v_pk_fma_f32 v[168:169], v[168:169], v[32:33], v[48:49] op_sel_hi:[1,0,0]
  v_pk_fma_f32 v[170:171], v[170:171], v[32:33], v[48:49] op_sel_hi:[1,0,0]
  v_pk_fma_f32 v[172:173], v[172:173], v[32:33], v[48:49] op_sel_hi:[1,0,0]
  v_pk_fma_f32 v[174:175], v[174:175], v[32:33], v[48:49] op_sel_hi:[1,0,0]
  v_pk_fma_f32 v[216:217], v[216:217], v[34:35], v[50:51] op_sel_hi:[1,0,0]
  v_pk_fma_f32 v[218:219], v[218:219], v[34:35], v[50:51] op_sel_hi:[1,0,0]
  v_pk_fma_f32 v[220:221], v[220:221], v[34:35], v[50:51] op_sel_hi:[1,0,0]
  v_pk_fma_f32 v[222:223], v[222:223], v[34:35], v[50:51] op_sel_hi:[1,0,0]
  v_cvt_pk_bf16_f32 v168, v168, v169
  v_cvt_pk_bf16_f32 v169, v170, v171
  v_cvt_pk_bf16_f32 v170, v172, v173
  v_cvt_pk_bf16_f32 v171, v174, v175
  ds_write_b128 v13, v[168:171] offset:14336
  v_cvt_pk_bf16_f32 v216, v216, v217
  v_cvt_pk_bf16_f32 v217, v218, v219
  v_cvt_pk_bf16_f32 v218, v220, v221
  v_cvt_pk_bf16_f32 v219, v222, v223
  ds_write_b128 v13, v[216:219] offset:14592
  v_lshlrev_b32 v6, 8, v6
  v_bfe_u32 v8, v0, 2, 2
  v_lshl_add_u32 v6, v8, 6, v6
  v_bfe_u32 v8, v0, 4, 1
  v_lshl_add_u32 v6, v8, 5, v6
  v_and_b32 v8, 3, v0
  v_lshl_add_u32 v6, v8, 3, v6
  v_pk_fma_f32 v[176:177], v[176:177], v[32:33], v[48:49] op_sel_hi:[1,0,0]
  v_pk_fma_f32 v[178:179], v[178:179], v[32:33], v[48:49] op_sel_hi:[1,0,0]
  v_pk_fma_f32 v[180:181], v[180:181], v[32:33], v[48:49] op_sel_hi:[1,0,0]
  v_pk_fma_f32 v[182:183], v[182:183], v[32:33], v[48:49] op_sel_hi:[1,0,0]
  v_pk_fma_f32 v[224:225], v[224:225], v[34:35], v[50:51] op_sel_hi:[1,0,0]
  v_pk_fma_f32 v[226:227], v[226:227], v[34:35], v[50:51] op_sel_hi:[1,0,0]
  v_pk_fma_f32 v[228:229], v[228:229], v[34:35], v[50:51] op_sel_hi:[1,0,0]
  v_pk_fma_f32 v[230:231], v[230:231], v[34:35], v[50:51] op_sel_hi:[1,0,0]
  v_cvt_pk_bf16_f32 v176, v176, v177
  v_cvt_pk_bf16_f32 v177, v178, v179
  v_cvt_pk_bf16_f32 v178, v180, v181
  v_cvt_pk_bf16_f32 v179, v182, v183
  ds_write_b128 v13, v[176:179] offset:16384
  v_cvt_pk_bf16_f32 v224, v224, v225
  v_cvt_pk_bf16_f32 v225, v226, v227
  v_cvt_pk_bf16_f32 v226, v228, v229
  v_cvt_pk_bf16_f32 v227, v230, v231
  ds_write_b128 v13, v[224:227] offset:16640
  v_add_u32 v3, s56, v6
  v_lshrrev_b32 v4, 2, v0
  v_mul_u32_u24 v4, 1536, v4
  v_and_b32 v8, 3, v0
  v_lshl_add_u32 v4, v8, 4, v4
  s_mul_i32 s47, s44, 384
  v_add_u32 v4, s47, v4
  v_pk_fma_f32 v[184:185], v[184:185], v[32:33], v[48:49] op_sel_hi:[1,0,0]
  v_pk_fma_f32 v[186:187], v[186:187], v[32:33], v[48:49] op_sel_hi:[1,0,0]
  v_pk_fma_f32 v[188:189], v[188:189], v[32:33], v[48:49] op_sel_hi:[1,0,0]
  v_pk_fma_f32 v[190:191], v[190:191], v[32:33], v[48:49] op_sel_hi:[1,0,0]
  v_pk_fma_f32 v[232:233], v[232:233], v[34:35], v[50:51] op_sel_hi:[1,0,0]
  v_pk_fma_f32 v[234:235], v[234:235], v[34:35], v[50:51] op_sel_hi:[1,0,0]
  v_pk_fma_f32 v[236:237], v[236:237], v[34:35], v[50:51] op_sel_hi:[1,0,0]
  v_pk_fma_f32 v[238:239], v[238:239], v[34:35], v[50:51] op_sel_hi:[1,0,0]
  v_cvt_pk_bf16_f32 v184, v184, v185
  v_cvt_pk_bf16_f32 v185, v186, v187
  v_cvt_pk_bf16_f32 v186, v188, v189
  v_cvt_pk_bf16_f32 v187, v190, v191
  ds_write_b128 v13, v[184:187] offset:18432
  v_cvt_pk_bf16_f32 v232, v232, v233
  v_cvt_pk_bf16_f32 v233, v234, v235
  v_cvt_pk_bf16_f32 v234, v236, v237
  v_cvt_pk_bf16_f32 v235, v238, v239
  ds_write_b128 v13, v[232:235] offset:18688
  v_bfe_u32 v8, v0, 2, 2
  v_and_b32 v6, 3, v0
  v_lshl_add_u32 v6, v8, 3, v6
  v_lshrrev_b32 v8, 5, v0
  v_lshl_add_u32 v6, v8, 2, v6
  s_mul_i32 s47, s44, 768
  v_pk_fma_f32 v[192:193], v[192:193], v[32:33], v[48:49] op_sel_hi:[1,0,0]
  v_pk_fma_f32 v[194:195], v[194:195], v[32:33], v[48:49] op_sel_hi:[1,0,0]
  v_pk_fma_f32 v[196:197], v[196:197], v[32:33], v[48:49] op_sel_hi:[1,0,0]
  v_pk_fma_f32 v[198:199], v[198:199], v[32:33], v[48:49] op_sel_hi:[1,0,0]
  v_pk_fma_f32 v[240:241], v[240:241], v[34:35], v[50:51] op_sel_hi:[1,0,0]
  v_pk_fma_f32 v[242:243], v[242:243], v[34:35], v[50:51] op_sel_hi:[1,0,0]
  v_pk_fma_f32 v[244:245], v[244:245], v[34:35], v[50:51] op_sel_hi:[1,0,0]
  v_pk_fma_f32 v[246:247], v[246:247], v[34:35], v[50:51] op_sel_hi:[1,0,0]
  v_cvt_pk_bf16_f32 v192, v192, v193
  v_cvt_pk_bf16_f32 v193, v194, v195
  v_cvt_pk_bf16_f32 v194, v196, v197
  v_cvt_pk_bf16_f32 v195, v198, v199
  ds_write_b128 v13, v[192:195] offset:20480
  v_cvt_pk_bf16_f32 v240, v240, v241
  v_cvt_pk_bf16_f32 v241, v242, v243
  v_cvt_pk_bf16_f32 v242, v244, v245
  v_cvt_pk_bf16_f32 v243, v246, v247
  ds_write_b128 v13, v[240:243] offset:20736
  s_add_u32 s47, s47, s60
  v_lshl_add_u32 v5, v6, 2, s47
  v_lshrrev_b32 v7, 2, v0
  s_mul_i32 s47, s44, 192
  v_add_u32_e64 v7, s47, v7
  v_mul_u32_u24 v7, 384, v7
  v_pk_fma_f32 v[200:201], v[200:201], v[32:33], v[48:49] op_sel_hi:[1,0,0]
  v_pk_fma_f32 v[202:203], v[202:203], v[32:33], v[48:49] op_sel_hi:[1,0,0]
  v_pk_fma_f32 v[204:205], v[204:205], v[32:33], v[48:49] op_sel_hi:[1,0,0]
  v_pk_fma_f32 v[206:207], v[206:207], v[32:33], v[48:49] op_sel_hi:[1,0,0]
  v_pk_fma_f32 v[248:249], v[248:249], v[34:35], v[50:51] op_sel_hi:[1,0,0]
  v_pk_fma_f32 v[250:251], v[250:251], v[34:35], v[50:51] op_sel_hi:[1,0,0]
  v_pk_fma_f32 v[252:253], v[252:253], v[34:35], v[50:51] op_sel_hi:[1,0,0]
  v_pk_fma_f32 v[254:255], v[254:255], v[34:35], v[50:51] op_sel_hi:[1,0,0]
  v_cvt_pk_bf16_f32 v200, v200, v201
  v_cvt_pk_bf16_f32 v201, v202, v203
  v_cvt_pk_bf16_f32 v202, v204, v205
  v_cvt_pk_bf16_f32 v203, v206, v207
  ds_write_b128 v13, v[200:203] offset:22528
  v_cvt_pk_bf16_f32 v248, v248, v249
  v_cvt_pk_bf16_f32 v249, v250, v251
  v_cvt_pk_bf16_f32 v250, v252, v253
  v_cvt_pk_bf16_f32 v251, v254, v255
  ds_write_b128 v13, v[248:251] offset:22784
  v_and_b32_e64 v6, 3, v0
  v_lshl_add_u32 v7, v6, 4, v7
  s_mov_b32 s64, 0xcccccccc
  s_mov_b32 s65, 0xcccccccc
  s_mov_b32 s58, 0xaaaaaaaa
  s_mov_b32 s59, 0xaaaaaaaa
  s_cmp_eq_u32 s44, 3
  s_cbranch_scc1 L_lndup
  v_pk_fma_f32 v[64:65], v[64:65], v[28:29], v[36:37] op_sel_hi:[1,0,0]
  v_pk_fma_f32 v[66:67], v[66:67], v[28:29], v[36:37] op_sel_hi:[1,0,0]
  v_pk_fma_f32 v[68:69], v[68:69], v[28:29], v[36:37] op_sel_hi:[1,0,0]
  v_pk_fma_f32 v[70:71], v[70:71], v[28:29], v[36:37] op_sel_hi:[1,0,0]
  v_pk_fma_f32 v[112:113], v[112:113], v[30:31], v[38:39] op_sel_hi:[1,0,0]
  v_pk_fma_f32 v[114:115], v[114:115], v[30:31], v[38:39] op_sel_hi:[1,0,0]
  v_pk_fma_f32 v[116:117], v[116:117], v[30:31], v[38:39] op_sel_hi:[1,0,0]
  v_pk_fma_f32 v[118:119], v[118:119], v[30:31], v[38:39] op_sel_hi:[1,0,0]
  v_cvt_pk_bf16_f32 v64, v64, v65
  v_cvt_pk_bf16_f32 v65, v66, v67
  v_cvt_pk_bf16_f32 v66, v68, v69
  v_cvt_pk_bf16_f32 v67, v70, v71
  ds_write_b128 v13, v[64:67] offset:0
  v_cvt_pk_bf16_f32 v112, v112, v113
  v_cvt_pk_bf16_f32 v113, v114, v115
  v_cvt_pk_bf16_f32 v114, v116, v117
  v_cvt_pk_bf16_f32 v115, v118, v119
  ds_write_b128 v13, v[112:115] offset:256
  v_pk_fma_f32 v[72:73], v[72:73], v[28:29], v[36:37] op_sel_hi:[1,0,0]
  v_pk_fma_f32 v[74:75], v[74:75], v[28:29], v[36:37] op_sel_hi:[1,0,0]
  v_pk_fma_f32 v[76:77], v[76:77], v[28:29], v[36:37] op_sel_hi:[1,0,0]
  v_pk_fma_f32 v[78:79], v[78:79], v[28:29], v[36:37] op_sel_hi:[1,0,0]
  v_pk_fma_f32 v[120:121], v[120:121], v[30:31], v[38:39] op_sel_hi:[1,0,0]
  v_pk_fma_f32 v[122:123], v[122:123], v[30:31], v[38:39] op_sel_hi:[1,0,0]
  v_pk_fma_f32 v[124:125], v[124:125], v[30:31], v[38:39] op_sel_hi:[1,0,0]
  v_pk_fma_f32 v[126:127], v[126:127], v[30:31], v[38:39] op_sel_hi:[1,0,0]
  v_cvt_pk_bf16_f32 v72, v72, v73
  v_cvt_pk_bf16_f32 v73, v74, v75
  v_cvt_pk_bf16_f32 v74, v76, v77
  v_cvt_pk_bf16_f32 v75, v78, v79
  ds_write_b128 v13, v[72:75] offset:2048
  v_cvt_pk_bf16_f32 v120, v120, v121
  v_cvt_pk_bf16_f32 v121, v122, v123
  v_cvt_pk_bf16_f32 v122, v124, v125
  v_cvt_pk_bf16_f32 v123, v126, v127
  ds_write_b128 v13, v[120:123] offset:2304
  v_pk_fma_f32 v[80:81], v[80:81], v[28:29], v[36:37] op_sel_hi:[1,0,0]
  v_pk_fma_f32 v[82:83], v[82:83], v[28:29], v[36:37] op_sel_hi:[1,0,0]
  v_pk_fma_f32 v[84:85], v[84:85], v[28:29], v[36:37] op_sel_hi:[1,0,0]
  v_pk_fma_f32 v[86:87], v[86:87], v[28:29], v[36:37] op_sel_hi:[1,0,0]
  v_pk_fma_f32 v[128:129], v[128:129], v[30:31], v[38:39] op_sel_hi:[1,0,0]
  v_pk_fma_f32 v[130:131], v[130:131], v[30:31], v[38:39] op_sel_hi:[1,0,0]
  v_pk_fma_f32 v[132:133], v[132:133], v[30:31], v[38:39] op_sel_hi:[1,0,0]
  v_pk_fma_f32 v[134:135], v[134:135], v[30:31], v[38:39] op_sel_hi:[1,0,0]
  v_cvt_pk_bf16_f32 v80, v80, v81
  v_cvt_pk_bf16_f32 v81, v82, v83
  v_cvt_pk_bf16_f32 v82, v84, v85
  v_cvt_pk_bf16_f32 v83, v86, v87
  ds_write_b128 v13, v[80:83] offset:4096
  v_cvt_pk_bf16_f32 v128, v128, v129
  v_cvt_pk_bf16_f32 v129, v130, v131
  v_cvt_pk_bf16_f32 v130, v132, v133
  v_cvt_pk_bf16_f32 v131, v134, v135
  ds_write_b128 v13, v[128:131] offset:4352
  v_pk_fma_f32 v[88:89], v[88:89], v[28:29], v[36:37] op_sel_hi:[1,0,0]
  v_pk_fma_f32 v[90:91], v[90:91], v[28:29], v[36:37] op_sel_hi:[1,0,0]
  v_pk_fma_f32 v[92:93], v[92:93], v[28:29], v[36:37] op_sel_hi:[1,0,0]
  v_pk_fma_f32 v[94:95], v[94:95], v[28:29], v[36:37] op_sel_hi:[1,0,0]
  v_pk_fma_f32 v[136:137], v[136:137], v[30:31], v[38:39] op_sel_hi:[1,0,0]
  v_pk_fma_f32 v[138:139], v[138:139], v[30:31], v[38:39] op_sel_hi:[1,0,0]
  v_pk_fma_f32 v[140:141], v[140:141], v[30:31], v[38:39] op_sel_hi:[1,0,0]
  v_pk_fma_f32 v[142:143], v[142:143], v[30:31], v[38:39] op_sel_hi:[1,0,0]
  v_cvt_pk_bf16_f32 v88, v88, v89
  v_cvt_pk_bf16_f32 v89, v90, v91
  v_cvt_pk_bf16_f32 v90, v92, v93
  v_cvt_pk_bf16_f32 v91, v94, v95
  ds_write_b128 v13, v[88:91] offset:6144
  v_cvt_pk_bf16_f32 v136, v136, v137
  v_cvt_pk_bf16_f32 v137, v138, v139
  v_cvt_pk_bf16_f32 v138, v140, v141
  v_cvt_pk_bf16_f32 v139, v142, v143
  ds_write_b128 v13, v[136:139] offset:6400
  v_pk_fma_f32 v[96:97], v[96:97], v[28:29], v[36:37] op_sel_hi:[1,0,0]
  v_pk_fma_f32 v[98:99], v[98:99], v[28:29], v[36:37] op_sel_hi:[1,0,0]
  v_pk_fma_f32 v[100:101], v[100:101], v[28:29], v[36:37] op_sel_hi:[1,0,0]
  v_pk_fma_f32 v[102:103], v[102:103], v[28:29], v[36:37] op_sel_hi:[1,0,0]
  v_pk_fma_f32 v[144:145], v[144:145], v[30:31], v[38:39] op_sel_hi:[1,0,0]
  v_pk_fma_f32 v[146:147], v[146:147], v[30:31], v[38:39] op_sel_hi:[1,0,0]
  v_pk_fma_f32 v[148:149], v[148:149], v[30:31], v[38:39] op_sel_hi:[1,0,0]
  v_pk_fma_f32 v[150:151], v[150:151], v[30:31], v[38:39] op_sel_hi:[1,0,0]
  v_cvt_pk_bf16_f32 v96, v96, v97
  v_cvt_pk_bf16_f32 v97, v98, v99
  v_cvt_pk_bf16_f32 v98, v100, v101
  v_cvt_pk_bf16_f32 v99, v102, v103
  ds_write_b128 v13, v[96:99] offset:8192
  v_cvt_pk_bf16_f32 v144, v144, v145
  v_cvt_pk_bf16_f32 v145, v146, v147
  v_cvt_pk_bf16_f32 v146, v148, v149
  v_cvt_pk_bf16_f32 v147, v150, v151
  ds_write_b128 v13, v[144:147] offset:8448
  v_pk_fma_f32 v[104:105], v[104:105], v[28:29], v[36:37] op_sel_hi:[1,0,0]
  v_pk_fma_f32 v[106:107], v[106:107], v[28:29], v[36:37] op_sel_hi:[1,0,0]
  v_pk_fma_f32 v[108:109], v[108:109], v[28:29], v[36:37] op_sel_hi:[1,0,0]
  v_pk_fma_f32 v[110:111], v[110:111], v[28:29], v[36:37] op_sel_hi:[1,0,0]
  v_pk_fma_f32 v[152:153], v[152:153], v[30:31], v[38:39] op_sel_hi:[1,0,0]
  v_pk_fma_f32 v[154:155], v[154:155], v[30:31], v[38:39] op_sel_hi:[1,0,0]
  v_pk_fma_f32 v[156:157], v[156:157], v[30:31], v[38:39] op_sel_hi:[1,0,0]
  v_pk_fma_f32 v[158:159], v[158:159], v[30:31], v[38:39] op_sel_hi:[1,0,0]
  v_cvt_pk_bf16_f32 v104, v104, v105
  v_cvt_pk_bf16_f32 v105, v106, v107
  v_cvt_pk_bf16_f32 v106, v108, v109
  v_cvt_pk_bf16_f32 v107, v110, v111
  ds_write_b128 v13, v[104:107] offset:10240
  v_cvt_pk_bf16_f32 v152, v152, v153
  v_cvt_pk_bf16_f32 v153, v154, v155
  v_cvt_pk_bf16_f32 v154, v156, v157
  v_cvt_pk_bf16_f32 v155, v158, v159
  ds_write_b128 v13, v[152:155] offset:10496
L_lndup:
  s_waitcnt lgkmcnt(0)
  s_barrier
  s_waitcnt vmcnt(0)
  v_readfirstlane_b32 s47, v12
  s_nop 1
  s_cmp_ge_u32 s47, 8
  s_cbranch_scc1 L_flagok
  v_mov_b32 v11, 0
  s_mov_b32 s61, 0
L_flag:
  s_sleep 2
  s_add_u32 s61, s61, 1
  s_cmp_ge_u32 s61, 0x40000
  s_cbranch_scc1 L_flagok
  global_load_dword v12, v11, s[18:19] sc0 sc1
  s_waitcnt vmcnt(0)
  v_readfirstlane_b32 s47, v12
  s_nop 1
  s_cmp_ge_u32 s47, 8
  s_cbranch_scc0 L_flag
L_flagok:
  ds_read_b64_tr_b16 a[240:241], v3 offset:0
  ds_read_b64_tr_b16 a[242:243], v3 offset:1024
  ds_read_b64_tr_b16 a[244:245], v3 offset:512
  ds_read_b64_tr_b16 a[246:247], v3 offset:1536
  ds_read_b64_tr_b16 a[248:249], v3 offset:2048
  ds_read_b64_tr_b16 a[250:251], v3 offset:3072
  ds_read_b64_tr_b16 a[252:253], v3 offset:2560
  ds_read_b64_tr_b16 a[254:255], v3 offset:3584
  ds_read_b64_tr_b16 v[112:113], v3 offset:4096
  ds_read_b64_tr_b16 v[114:115], v3 offset:5120
  ds_read_b64_tr_b16 v[116:117], v3 offset:4608
  ds_read_b64_tr_b16 v[118:119], v3 offset:5632
  ds_read_b64_tr_b16 v[120:121], v3 offset:6144
  ds_read_b64_tr_b16 v[122:123], v3 offset:7168
  ds_read_b64_tr_b16 v[124:125], v3 offset:6656
  ds_read_b64_tr_b16 v[126:127], v3 offset:7680
  ds_read_b64_tr_b16 v[128:129], v3 offset:8192
  ds_read_b64_tr_b16 v[130:131], v3 offset:9216
  ds_read_b64_tr_b16 v[132:133], v3 offset:8704
  ds_read_b64_tr_b16 v[134:135], v3 offset:9728
  ds_read_b64_tr_b16 v[136:137], v3 offset:10240
  ds_read_b64_tr_b16 v[138:139], v3 offset:11264
  ds_read_b64_tr_b16 v[140:141], v3 offset:10752
  ds_read_b64_tr_b16 v[142:143], v3 offset:11776
  ds_read_b128 a[224:227], v1 offset:0
  ds_read_b128 a[228:231], v1 offset:1024
  ds_read_b128 a[232:235], v1 offset:2048
  ds_read_b128 a[236:239], v1 offset:3072
  s_waitcnt lgkmcnt(2)
  v_mfma_f32_32x32x16_bf16 v[8:23], a[240:243], a[224:227], 0
  ds_read_b128 a[224:227], v1 offset:4096
  v_accvgpr_read_b32 v88, a102
  v_accvgpr_read_b32 v89, a103
  v_mfma_f32_32x32x16_bf16 v[8:23], a[244:247], a[228:231], v[8:23]
  s_waitcnt lgkmcnt(1)
  ds_read_b128 a[228:231], v1 offset:5120
  v_accvgpr_read_b32 v90, a104
  v_accvgpr_read_b32 v91, a105
  v_mfma_f32_32x32x16_bf16 v[8:23], a[248:251], a[232:235], v[8:23]
  ds_read_b128 a[232:235], v1 offset:6144
  v_accvgpr_read_b32 v92, a106
  v_accvgpr_read_b32 v93, a107
  v_lshlrev_b32 v88, 16, v88
  v_mfma_f32_32x32x16_bf16 v[8:23], a[252:255], a[236:239], v[8:23]
  s_waitcnt lgkmcnt(1)
  ds_read_b128 a[236:239], v1 offset:7168
  v_lshlrev_b32 v89, 16, v89
  v_lshlrev_b32 v90, 16, v90
  v_mfma_f32_32x32x16_bf16 v[8:23], v[112:115], a[224:227], v[8:23]
  ds_read_b128 a[224:227], v1 offset:8192
  v_lshlrev_b32 v91, 16, v91
  v_lshlrev_b32 v92, 16, v92
  v_mfma_f32_32x32x16_bf16 v[8:23], v[116:119], a[228:231], v[8:23]
  s_waitcnt lgkmcnt(1)
  ds_read_b128 a[228:231], v1 offset:9216
  v_lshlrev_b32 v93, 16, v93
  v_mul_f32 v88, v88, v91
  v_fmac_f32 v88, v89, v92
  v_mfma_f32_32x32x16_bf16 v[8:23], v[120:123], a[232:235], v[8:23]
  ds_read_b128 a[232:235], v1 offset:10240
  v_fmac_f32 v88, v90, v93
  s_nop 1
  v_add_f32_dpp v88, v88, v88 row_ror:8 row_mask:0xf bank_mask:0xf
  v_mfma_f32_32x32x16_bf16 v[8:23], v[124:127], a[236:239], v[8:23]
  s_waitcnt lgkmcnt(1)
  ds_read_b128 a[236:239], v1 offset:11264
  v_add_f32_dpp v88, v88, v88 row_ror:4 row_mask:0xf bank_mask:0xf
  s_nop 1
  v_add_f32_dpp v88, v88, v88 row_ror:2 row_mask:0xf bank_mask:0xf
  v_mfma_f32_32x32x16_bf16 v[8:23], v[128:131], a[224:227], v[8:23]
  ds_read_b128 a[224:227], v1 offset:12288
  v_add_f32_dpp v88, v88, v88 row_ror:1 row_mask:0xf bank_mask:0xf
  v_mov_b32 v89, v88
  s_nop 1
  v_permlane16_swap_b32 v88, v89
  v_mfma_f32_32x32x16_bf16 v[8:23], v[132:135], a[228:231], v[8:23]
  s_waitcnt lgkmcnt(1)
  ds_read_b128 a[228:231], v1 offset:13312
  v_add_f32 v88, v88, v89
  v_mov_b32 v89, v88
  v_mfma_f32_32x32x16_bf16 v[8:23], v[136:139], a[232:235], v[8:23]
  ds_read_b128 a[232:235], v1 offset:14336
  v_permlane32_swap_b32 v88, v89
  v_add_f32_e64 v88, v88, v89
  s_nop 0
  v_readfirstlane_b32 s99, v88
  v_mfma_f32_32x32x16_bf16 v[8:23], v[140:143], a[236:239], v[8:23]
  ds_read_b128 a[236:239], v1 offset:15360
  s_nop 10
  v_pk_fma_f32 v[56:57], v[8:9], v[8:9], s[50:51] neg_lo:[1,0,0] neg_hi:[1,0,0]
  v_pk_fma_f32 v[58:59], v[10:11], v[10:11], s[50:51] neg_lo:[1,0,0] neg_hi:[1,0,0]
  v_pk_fma_f32 v[60:61], v[12:13], v[12:13], s[50:51] neg_lo:[1,0,0] neg_hi:[1,0,0]
  v_pk_fma_f32 v[62:63], v[14:15], v[14:15], s[50:51] neg_lo:[1,0,0] neg_hi:[1,0,0]
  v_pk_fma_f32 v[64:65], v[16:17], v[16:17], s[50:51] neg_lo:[1,0,0] neg_hi:[1,0,0]
  v_pk_fma_f32 v[66:67], v[18:19], v[18:19], s[50:51] neg_lo:[1,0,0] neg_hi:[1,0,0]
  v_pk_fma_f32 v[68:69], v[20:21], v[20:21], s[50:51] neg_lo:[1,0,0] neg_hi:[1,0,0]
  v_pk_fma_f32 v[70:71], v[22:23], v[22:23], s[50:51] neg_lo:[1,0,0] neg_hi:[1,0,0]
  v_pk_mul_f32 v[56:57], v[56:57], v[8:9]
  v_pk_mul_f32 v[58:59], v[58:59], v[10:11]
  v_pk_mul_f32 v[60:61], v[60:61], v[12:13]
  v_pk_mul_f32 v[62:63], v[62:63], v[14:15]
  v_pk_mul_f32 v[64:65], v[64:65], v[16:17]
  v_pk_mul_f32 v[66:67], v[66:67], v[18:19]
  v_pk_mul_f32 v[68:69], v[68:69], v[20:21]
  v_pk_mul_f32 v[70:71], v[70:71], v[22:23]
  s_waitcnt lgkmcnt(2)
  v_mfma_f32_32x32x16_bf16 v[24:39], a[240:243], a[224:227], 0
  ds_read_b128 a[224:227], v1 offset:16384
  v_exp_f32 v56, v56
  v_add_u32 v4, 64, v4
  s_add_u32 m0, s56, 0
  v_mfma_f32_32x32x16_bf16 v[24:39], a[244:247], a[228:231], v[24:39]
  s_waitcnt lgkmcnt(1)
  buffer_load_dwordx4 v4, s[28:31], s72 offen offset:0 lds
  ds_read_b128 a[228:231], v1 offset:17408
  v_exp_f32 v57, v57
  v_mfma_f32_32x32x16_bf16 v[24:39], a[248:251], a[232:235], v[24:39]
  ds_read_b128 a[232:235], v1 offset:18432
  v_exp_f32 v58, v58
  v_mfma_f32_32x32x16_bf16 v[24:39], a[252:255], a[236:239], v[24:39]
  s_waitcnt lgkmcnt(1)
  ds_read_b128 a[236:239], v1 offset:19456
  v_exp_f32 v59, v59
  v_mfma_f32_32x32x16_bf16 v[24:39], v[112:115], a[224:227], v[24:39]
  buffer_load_dwordx4 v4, s[28:31], s73 offen offset:1024 lds
  ds_read_b128 a[224:227], v1 offset:20480
  v_exp_f32 v60, v60
  v_mfma_f32_32x32x16_bf16 v[24:39], v[116:119], a[228:231], v[24:39]
  s_waitcnt lgkmcnt(1)
  ds_read_b128 a[228:231], v1 offset:21504
  v_exp_f32 v61, v61
  v_mfma_f32_32x32x16_bf16 v[24:39], v[120:123], a[232:235], v[24:39]
  ds_read_b128 a[232:235], v1 offset:22528
  v_exp_f32 v62, v62
  v_mfma_f32_32x32x16_bf16 v[24:39], v[124:127], a[236:239], v[24:39]
  s_waitcnt lgkmcnt(1)
  buffer_load_dwordx4 v4, s[28:31], s74 offen offset:2048 lds
  ds_read_b128 a[236:239], v1 offset:23552
  v_exp_f32 v63, v63
  v_mfma_f32_32x32x16_bf16 v[24:39], v[128:131], a[224:227], v[24:39]
  ds_read_b128 a[224:227], v1 offset:24576
  v_exp_f32 v64, v64
  v_mfma_f32_32x32x16_bf16 v[24:39], v[132:135], a[228:231], v[24:39]
  s_waitcnt lgkmcnt(1)
  ds_read_b128 a[228:231], v1 offset:25600
  v_exp_f32 v65, v65
  v_mfma_f32_32x32x16_bf16 v[24:39], v[136:139], a[232:235], v[24:39]
  buffer_load_dwordx4 v4, s[28:31], s75 offen offset:3072 lds
  ds_read_b128 a[232:235], v1 offset:26624
  v_exp_f32 v66, v66
  v_exp_f32 v67, v67
  v_mfma_f32_32x32x16_bf16 v[24:39], v[140:143], a[236:239], v[24:39]
  ds_read_b128 a[236:239], v1 offset:27648
  v_exp_f32 v68, v68
  v_exp_f32 v69, v69
  v_exp_f32 v70, v70
  v_exp_f32 v71, v71
  s_cmp_ge_u32 s2, 192
  s_cbranch_scc1 L_nobias
  s_lshl_b32 s47, s2, 2
  s_add_u32 s47, s47, 3072
  v_mov_b32 v96, s47
  v_mov_b32 v97, s99
  s_mov_b64 exec, 1
  buffer_atomic_add_f32 v97, v96, s[4:7], 0 offen
  s_mov_b64 exec, -1
L_nobias:
  s_nop 0
  v_pk_add_f32 v[56:57], v[56:57], 1.0 op_sel_hi:[1,0]
  v_pk_add_f32 v[58:59], v[58:59], 1.0 op_sel_hi:[1,0]
  v_pk_add_f32 v[60:61], v[60:61], 1.0 op_sel_hi:[1,0]
  v_pk_add_f32 v[62:63], v[62:63], 1.0 op_sel_hi:[1,0]
  v_pk_add_f32 v[64:65], v[64:65], 1.0 op_sel_hi:[1,0]
  v_pk_add_f32 v[66:67], v[66:67], 1.0 op_sel_hi:[1,0]
  v_pk_add_f32 v[68:69], v[68:69], 1.0 op_sel_hi:[1,0]
  v_pk_add_f32 v[70:71], v[70:71], 1.0 op_sel_hi:[1,0]
  v_pk_fma_f32 v[72:73], v[24:25], v[24:25], s[50:51] neg_lo:[1,0,0] neg_hi:[1,0,0]
  v_pk_fma_f32 v[74:75], v[26:27], v[26:27], s[50:51] neg_lo:[1,0,0] neg_hi:[1,0,0]
  v_pk_fma_f32 v[76:77], v[28:29], v[28:29], s[50:51] neg_lo:[1,0,0] neg_hi:[1,0,0]
  v_pk_fma_f32 v[78:79], v[30:31], v[30:31], s[50:51] neg_lo:[1,0,0] neg_hi:[1,0,0]
  v_pk_fma_f32 v[80:81], v[32:33], v[32:33], s[50:51] neg_lo:[1,0,0] neg_hi:[1,0,0]
  v_pk_fma_f32 v[82:83], v[34:35], v[34:35], s[50:51] neg_lo:[1,0,0] neg_hi:[1,0,0]
  v_pk_fma_f32 v[84:85], v[36:37], v[36:37], s[50:51] neg_lo:[1,0,0] neg_hi:[1,0,0]
  v_pk_fma_f32 v[86:87], v[38:39], v[38:39], s[50:51] neg_lo:[1,0,0] neg_hi:[1,0,0]
  v_pk_mul_f32 v[72:73], v[72:73], v[24:25]
  v_pk_mul_f32 v[74:75], v[74:75], v[26:27]
  v_pk_mul_f32 v[76:77], v[76:77], v[28:29]
  v_pk_mul_f32 v[78:79], v[78:79], v[30:31]
  v_pk_mul_f32 v[80:81], v[80:81], v[32:33]
  v_pk_mul_f32 v[82:83], v[82:83], v[34:35]
  v_pk_mul_f32 v[84:85], v[84:85], v[36:37]
  v_pk_mul_f32 v[86:87], v[86:87], v[38:39]
  s_waitcnt lgkmcnt(2)
  v_mfma_f32_32x32x16_bf16 v[40:55], a[240:243], a[224:227], 0
  ds_read_b128 a[224:227], v1 offset:28672
  v_exp_f32 v72, v72
  v_rcp_f32 v56, v56
  s_add_u32 m0, s56, 4096
  v_mfma_f32_32x32x16_bf16 v[40:55], a[244:247], a[228:231], v[40:55]
  s_waitcnt lgkmcnt(1)
  buffer_load_dwordx4 v4, s[28:31], s76 offen offset:0 lds
  ds_read_b128 a[228:231], v1 offset:29696
  v_exp_f32 v73, v73
  v_rcp_f32 v57, v57
  v_mfma_f32_32x32x16_bf16 v[40:55], a[248:251], a[232:235], v[40:55]
  ds_read_b128 a[232:235], v1 offset:30720
  v_exp_f32 v74, v74
  v_rcp_f32 v58, v58
  v_exp_f32 v75, v75
  v_mfma_f32_32x32x16_bf16 v[40:55], a[252:255], a[236:239], v[40:55]
  s_waitcnt lgkmcnt(1)
  ds_read_b128 a[236:239], v1 offset:31744
  v_rcp_f32 v59, v59
  v_exp_f32 v76, v76
  v_mfma_f32_32x32x16_bf16 v[40:55], v[112:115], a[224:227], v[40:55]
  buffer_load_dwordx4 v4, s[28:31], s77 offen offset:1024 lds
  ds_read_b128 a[224:227], v1 offset:32768
  v_rcp_f32 v60, v60
  v_exp_f32 v77, v77
  v_rcp_f32 v61, v61
  v_mfma_f32_32x32x16_bf16 v[40:55], v[116:119], a[228:231], v[40:55]
  s_waitcnt lgkmcnt(1)
  ds_read_b128 a[228:231], v1 offset:33792
  v_exp_f32 v78, v78
  v_rcp_f32 v62, v62
  v_mfma_f32_32x32x16_bf16 v[40:55], v[120:123], a[232:235], v[40:55]
  ds_read_b128 a[232:235], v1 offset:34816
  v_exp_f32 v79, v79
  v_rcp_f32 v63, v63
  v_exp_f32 v80, v80
  v_mfma_f32_32x32x16_bf16 v[40:55], v[124:127], a[236:239], v[40:55]
  s_waitcnt lgkmcnt(1)
  buffer_load_dwordx4 v4, s[28:31], s78 offen offset:2048 lds
  ds_read_b128 a[236:239], v1 offset:35840
  v_rcp_f32 v64, v64
  v_exp_f32 v81, v81
  v_mfma_f32_32x32x16_bf16 v[40:55], v[128:131], a[224:227], v[40:55]
  ds_read_b128 a[224:227], v2 offset:0
  v_rcp_f32 v65, v65
  v_exp_f32 v82, v82
  v_rcp_f32 v66, v66
  v_mfma_f32_32x32x16_bf16 v[40:55], v[132:135], a[228:231], v[40:55]
  s_waitcnt lgkmcnt(1)
  ds_read_b128 a[228:231], v2 offset:1024
  v_exp_f32 v83, v83
  v_rcp_f32 v67, v67
  v_mfma_f32_32x32x16_bf16 v[40:55], v[136:139], a[232:235], v[40:55]
  buffer_load_dwordx4 v4, s[28:31], s79 offen offset:3072 lds
  ds_read_b128 a[232:235], v2 offset:2048
  v_exp_f32 v84, v84
  v_rcp_f32 v68, v68
  v_exp_f32 v85, v85
  v_mfma_f32_32x32x16_bf16 v[40:55], v[140:143], a[236:239], v[40:55]
  ds_read_b128 a[236:239], v2 offset:3072
  v_rcp_f32 v69, v69
  v_exp_f32 v86, v86
  v_rcp_f32 v70, v70
  v_exp_f32 v87, v87
  v_rcp_f32 v71, v71
  v_pk_mul_f32 v[56:57], v[56:57], v[8:9]
  v_pk_mul_f32 v[58:59], v[58:59], v[10:11]
  v_pk_mul_f32 v[60:61], v[60:61], v[12:13]
  v_pk_mul_f32 v[62:63], v[62:63], v[14:15]
  v_pk_mul_f32 v[64:65], v[64:65], v[16:17]
  v_pk_mul_f32 v[66:67], v[66:67], v[18:19]
  v_pk_mul_f32 v[68:69], v[68:69], v[20:21]
  v_pk_mul_f32 v[70:71], v[70:71], v[22:23]
  v_pk_add_f32 v[72:73], v[72:73], 1.0 op_sel_hi:[1,0]
  v_pk_add_f32 v[74:75], v[74:75], 1.0 op_sel_hi:[1,0]
  v_pk_add_f32 v[76:77], v[76:77], 1.0 op_sel_hi:[1,0]
  v_pk_add_f32 v[78:79], v[78:79], 1.0 op_sel_hi:[1,0]
  v_pk_add_f32 v[80:81], v[80:81], 1.0 op_sel_hi:[1,0]
  v_pk_add_f32 v[82:83], v[82:83], 1.0 op_sel_hi:[1,0]
  v_pk_add_f32 v[84:85], v[84:85], 1.0 op_sel_hi:[1,0]
  v_pk_add_f32 v[86:87], v[86:87], 1.0 op_sel_hi:[1,0]
  v_pk_mul_f32 v[88:89], v[56:57], v[56:57]
  v_pk_mul_f32 v[90:91], v[58:59], v[58:59]
  v_pk_mul_f32 v[92:93], v[60:61], v[60:61]
  v_pk_mul_f32 v[94:95], v[62:63], v[62:63]
  v_pk_mul_f32 v[96:97], v[64:65], v[64:65]
  v_pk_mul_f32 v[98:99], v[66:67], v[66:67]
  v_pk_mul_f32 v[100:101], v[68:69], v[68:69]
  v_pk_mul_f32 v[102:103], v[70:71], v[70:71]
  v_cvt_pk_bf16_f32 v104, v56, v57
  v_cvt_pk_bf16_f32 v105, v58, v59
  v_cvt_pk_bf16_f32 v106, v60, v61
  v_cvt_pk_bf16_f32 v107, v62, v63
  v_cvt_pk_bf16_f32 v108, v64, v65
  v_cvt_pk_bf16_f32 v109, v66, v67
  v_cvt_pk_bf16_f32 v110, v68, v69
  v_cvt_pk_bf16_f32 v111, v70, v71
  v_pk_fma_f32 v[56:57], v[40:41], v[40:41], s[50:51] neg_lo:[1,0,0] neg_hi:[1,0,0]
  v_pk_fma_f32 v[58:59], v[42:43], v[42:43], s[50:51] neg_lo:[1,0,0] neg_hi:[1,0,0]
  v_pk_fma_f32 v[60:61], v[44:45], v[44:45], s[50:51] neg_lo:[1,0,0] neg_hi:[1,0,0]
  v_pk_fma_f32 v[62:63], v[46:47], v[46:47], s[50:51] neg_lo:[1,0,0] neg_hi:[1,0,0]
  v_pk_fma_f32 v[64:65], v[48:49], v[48:49], s[50:51] neg_lo:[1,0,0] neg_hi:[1,0,0]
  v_pk_fma_f32 v[66:67], v[50:51], v[50:51], s[50:51] neg_lo:[1,0,0] neg_hi:[1,0,0]
  v_pk_fma_f32 v[68:69], v[52:53], v[52:53], s[50:51] neg_lo:[1,0,0] neg_hi:[1,0,0]
  v_pk_fma_f32 v[70:71], v[54:55], v[54:55], s[50:51] neg_lo:[1,0,0] neg_hi:[1,0,0]
  v_pk_mul_f32 v[56:57], v[56:57], v[40:41]
  v_pk_mul_f32 v[58:59], v[58:59], v[42:43]
  v_pk_mul_f32 v[60:61], v[60:61], v[44:45]
  v_pk_mul_f32 v[62:63], v[62:63], v[46:47]
  v_pk_mul_f32 v[64:65], v[64:65], v[48:49]
  v_pk_mul_f32 v[66:67], v[66:67], v[50:51]
  v_pk_mul_f32 v[68:69], v[68:69], v[52:53]
  v_pk_mul_f32 v[70:71], v[70:71], v[54:55]
  s_waitcnt lgkmcnt(2)
  v_mfma_f32_32x32x16_bf16 v[8:23], a[240:243], a[224:227], 0
  ds_read_b128 a[224:227], v2 offset:4096
  v_exp_f32 v56, v56
  v_rcp_f32 v72, v72
  s_add_u32 m0, s56, 8192
  v_mfma_f32_32x32x16_bf16 v[8:23], a[244:247], a[228:231], v[8:23]
  s_waitcnt lgkmcnt(1)
  buffer_load_dwordx4 v4, s[28:31], s80 offen offset:0 lds
  ds_read_b128 a[228:231], v2 offset:5120
  v_exp_f32 v57, v57
  v_rcp_f32 v73, v73
  v_exp_f32 v58, v58
  v_mfma_f32_32x32x16_bf16 v[8:23], a[248:251], a[232:235], v[8:23]
  ds_read_b128 a[232:235], v2 offset:6144
  v_rcp_f32 v74, v74
  v_exp_f32 v59, v59
  v_rcp_f32 v75, v75
  v_mfma_f32_32x32x16_bf16 v[8:23], a[252:255], a[236:239], v[8:23]
  s_waitcnt lgkmcnt(1)
  ds_read_b128 a[236:239], v2 offset:7168
  v_exp_f32 v60, v60
  v_rcp_f32 v76, v76
  v_exp_f32 v61, v61
  v_mfma_f32_32x32x16_bf16 v[8:23], v[112:115], a[224:227], v[8:23]
  buffer_load_dwordx4 v4, s[28:31], s81 offen offset:1024 lds
  ds_read_b128 a[224:227], v2 offset:8192
  v_rcp_f32 v77, v77
  v_exp_f32 v62, v62
  v_rcp_f32 v78, v78
  v_mfma_f32_32x32x16_bf16 v[8:23], v[116:119], a[228:231], v[8:23]
  s_waitcnt lgkmcnt(1)
  ds_read_b128 a[228:231], v2 offset:9216
  v_exp_f32 v63, v63
  v_rcp_f32 v79, v79
  v_exp_f32 v64, v64
  v_mfma_f32_32x32x16_bf16 v[8:23], v[120:123], a[232:235], v[8:23]
  ds_read_b128 a[232:235], v2 offset:10240
  v_rcp_f32 v80, v80
  v_exp_f32 v65, v65
  v_rcp_f32 v81, v81
  v_mfma_f32_32x32x16_bf16 v[8:23], v[124:127], a[236:239], v[8:23]
  s_waitcnt lgkmcnt(1)
  buffer_load_dwordx4 v4, s[28:31], s82 offen offset:2048 lds
  ds_read_b128 a[236:239], v2 offset:11264
  v_exp_f32 v66, v66
  v_rcp_f32 v82, v82
  v_exp_f32 v67, v67
  v_mfma_f32_32x32x16_bf16 v[8:23], v[128:131], a[224:227], v[8:23]
  ds_read_b128 a[224:227], v2 offset:12288
  v_rcp_f32 v83, v83
  v_exp_f32 v68, v68
  v_rcp_f32 v84, v84
  v_mfma_f32_32x32x16_bf16 v[8:23], v[132:135], a[228:231], v[8:23]
  s_waitcnt lgkmcnt(1)
  ds_read_b128 a[228:231], v2 offset:13312
  v_exp_f32 v69, v69
  v_rcp_f32 v85, v85
  v_exp_f32 v70, v70
  v_mfma_f32_32x32x16_bf16 v[8:23], v[136:139], a[232:235], v[8:23]
  buffer_load_dwordx4 v4, s[28:31], s83 offen offset:3072 lds
  ds_read_b128 a[232:235], v2 offset:14336
  v_rcp_f32 v86, v86
  v_exp_f32 v71, v71
  v_rcp_f32 v87, v87
  v_mfma_f32_32x32x16_bf16 v[8:23], v[140:143], a[236:239], v[8:23]
  ds_read_b128 a[236:239], v2 offset:15360
  v_accvgpr_write_b32 a0, v104
  v_accvgpr_write_b32 a1, v105
  v_accvgpr_write_b32 a2, v106
  v_accvgpr_write_b32 a3, v107
  v_accvgpr_write_b32 a4, v108
  v_accvgpr_write_b32 a5, v109
  v_accvgpr_write_b32 a6, v110
  v_accvgpr_write_b32 a7, v111
  v_pk_mul_f32 v[72:73], v[72:73], v[24:25]
  v_pk_mul_f32 v[74:75], v[74:75], v[26:27]
  v_pk_mul_f32 v[76:77], v[76:77], v[28:29]
  v_pk_mul_f32 v[78:79], v[78:79], v[30:31]
  v_pk_mul_f32 v[80:81], v[80:81], v[32:33]
  v_pk_mul_f32 v[82:83], v[82:83], v[34:35]
  v_pk_mul_f32 v[84:85], v[84:85], v[36:37]
  v_pk_mul_f32 v[86:87], v[86:87], v[38:39]
  v_pk_add_f32 v[56:57], v[56:57], 1.0 op_sel_hi:[1,0]
  v_pk_add_f32 v[58:59], v[58:59], 1.0 op_sel_hi:[1,0]
  v_pk_add_f32 v[60:61], v[60:61], 1.0 op_sel_hi:[1,0]
  v_pk_add_f32 v[62:63], v[62:63], 1.0 op_sel_hi:[1,0]
  v_pk_add_f32 v[64:65], v[64:65], 1.0 op_sel_hi:[1,0]
  v_pk_add_f32 v[66:67], v[66:67], 1.0 op_sel_hi:[1,0]
  v_pk_add_f32 v[68:69], v[68:69], 1.0 op_sel_hi:[1,0]
  v_pk_add_f32 v[70:71], v[70:71], 1.0 op_sel_hi:[1,0]
  v_pk_fma_f32 v[88:89], v[72:73], v[72:73], v[88:89]
  v_pk_fma_f32 v[90:91], v[74:75], v[74:75], v[90:91]
  v_pk_fma_f32 v[92:93], v[76:77], v[76:77], v[92:93]
  v_pk_fma_f32 v[94:95], v[78:79], v[78:79], v[94:95]
  v_pk_fma_f32 v[96:97], v[80:81], v[80:81], v[96:97]
  v_pk_fma_f32 v[98:99], v[82:83], v[82:83], v[98:99]
  v_pk_fma_f32 v[100:101], v[84:85], v[84:85], v[100:101]
  v_pk_fma_f32 v[102:103], v[86:87], v[86:87], v[102:103]
  v_cvt_pk_bf16_f32 v104, v72, v73
  v_cvt_pk_bf16_f32 v105, v74, v75
  v_cvt_pk_bf16_f32 v106, v76, v77
  v_cvt_pk_bf16_f32 v107, v78, v79
  v_cvt_pk_bf16_f32 v108, v80, v81
  v_cvt_pk_bf16_f32 v109, v82, v83
  v_cvt_pk_bf16_f32 v110, v84, v85
  v_cvt_pk_bf16_f32 v111, v86, v87
  v_pk_fma_f32 v[72:73], v[8:9], v[8:9], s[50:51] neg_lo:[1,0,0] neg_hi:[1,0,0]
  v_pk_fma_f32 v[74:75], v[10:11], v[10:11], s[50:51] neg_lo:[1,0,0] neg_hi:[1,0,0]
  v_pk_fma_f32 v[76:77], v[12:13], v[12:13], s[50:51] neg_lo:[1,0,0] neg_hi:[1,0,0]
  v_pk_fma_f32 v[78:79], v[14:15], v[14:15], s[50:51] neg_lo:[1,0,0] neg_hi:[1,0,0]
  v_pk_fma_f32 v[80:81], v[16:17], v[16:17], s[50:51] neg_lo:[1,0,0] neg_hi:[1,0,0]
  v_pk_fma_f32 v[82:83], v[18:19], v[18:19], s[50:51] neg_lo:[1,0,0] neg_hi:[1,0,0]
  v_pk_fma_f32 v[84:85], v[20:21], v[20:21], s[50:51] neg_lo:[1,0,0] neg_hi:[1,0,0]
  v_pk_fma_f32 v[86:87], v[22:23], v[22:23], s[50:51] neg_lo:[1,0,0] neg_hi:[1,0,0]
  v_pk_mul_f32 v[72:73], v[72:73], v[8:9]
  v_pk_mul_f32 v[74:75], v[74:75], v[10:11]
  v_pk_mul_f32 v[76:77], v[76:77], v[12:13]
  v_pk_mul_f32 v[78:79], v[78:79], v[14:15]
  v_pk_mul_f32 v[80:81], v[80:81], v[16:17]
  v_pk_mul_f32 v[82:83], v[82:83], v[18:19]
  v_pk_mul_f32 v[84:85], v[84:85], v[20:21]
  v_pk_mul_f32 v[86:87], v[86:87], v[22:23]
  s_waitcnt lgkmcnt(2)
  v_mfma_f32_32x32x16_bf16 v[24:39], a[240:243], a[224:227], 0
  ds_read_b128 a[224:227], v2 offset:16384
  v_exp_f32 v72, v72
  v_rcp_f32 v56, v56
  v_mfma_f32_32x32x16_bf16 v[24:39], a[244:247], a[228:231], v[24:39]
  s_waitcnt lgkmcnt(1)
  ds_read_b128 a[228:231], v2 offset:17408
  v_exp_f32 v73, v73
  v_rcp_f32 v57, v57
  v_exp_f32 v74, v74
  v_mfma_f32_32x32x16_bf16 v[24:39], a[248:251], a[232:235], v[24:39]
  ds_read_b128 a[232:235], v2 offset:18432
  v_rcp_f32 v58, v58
  v_exp_f32 v75, v75
  v_rcp_f32 v59, v59
  v_mfma_f32_32x32x16_bf16 v[24:39], a[252:255], a[236:239], v[24:39]
  s_waitcnt lgkmcnt(1)
  ds_read_b128 a[236:239], v2 offset:19456
  v_exp_f32 v76, v76
  v_rcp_f32 v60, v60
  v_exp_f32 v77, v77
  v_mfma_f32_32x32x16_bf16 v[24:39], v[112:115], a[224:227], v[24:39]
  ds_read_b128 a[224:227], v2 offset:20480
  v_rcp_f32 v61, v61
  v_exp_f32 v78, v78
  v_rcp_f32 v62, v62
  v_mfma_f32_32x32x16_bf16 v[24:39], v[116:119], a[228:231], v[24:39]
  s_waitcnt lgkmcnt(1)
  ds_read_b128 a[228:231], v2 offset:21504
  v_exp_f32 v79, v79
  v_rcp_f32 v63, v63
  v_exp_f32 v80, v80
  v_mfma_f32_32x32x16_bf16 v[24:39], v[120:123], a[232:235], v[24:39]
  ds_read_b128 a[232:235], v2 offset:22528
  v_rcp_f32 v64, v64
  v_exp_f32 v81, v81
  v_rcp_f32 v65, v65
  v_mfma_f32_32x32x16_bf16 v[24:39], v[124:127], a[236:239], v[24:39]
  s_waitcnt lgkmcnt(1)
  ds_read_b128 a[236:239], v2 offset:23552
  v_exp_f32 v82, v82
  v_rcp_f32 v66, v66
  v_exp_f32 v83, v83
  v_mfma_f32_32x32x16_bf16 v[24:39], v[128:131], a[224:227], v[24:39]
  ds_read_b128 a[224:227], v2 offset:24576
  v_rcp_f32 v67, v67
  v_exp_f32 v84, v84
  v_rcp_f32 v68, v68
  v_mfma_f32_32x32x16_bf16 v[24:39], v[132:135], a[228:231], v[24:39]
  s_waitcnt lgkmcnt(1)
  ds_read_b128 a[228:231], v2 offset:25600
  v_exp_f32 v85, v85
  v_rcp_f32 v69, v69
  v_exp_f32 v86, v86
  v_mfma_f32_32x32x16_bf16 v[24:39], v[136:139], a[232:235], v[24:39]
  ds_read_b128 a[232:235], v2 offset:26624
  v_rcp_f32 v70, v70
  v_exp_f32 v87, v87
  v_rcp_f32 v71, v71
  v_mfma_f32_32x32x16_bf16 v[24:39], v[140:143], a[236:239], v[24:39]
  ds_read_b128 a[236:239], v2 offset:27648
  v_accvgpr_write_b32 a8, v104
  v_accvgpr_write_b32 a9, v105
  v_accvgpr_write_b32 a10, v106
  v_accvgpr_write_b32 a11, v107
  v_accvgpr_write_b32 a12, v108
  v_accvgpr_write_b32 a13, v109
  v_accvgpr_write_b32 a14, v110
  v_accvgpr_write_b32 a15, v111
  v_pk_mul_f32 v[56:57], v[56:57], v[40:41]
  v_pk_mul_f32 v[58:59], v[58:59], v[42:43]
  v_pk_mul_f32 v[60:61], v[60:61], v[44:45]
  v_pk_mul_f32 v[62:63], v[62:63], v[46:47]
  v_pk_mul_f32 v[64:65], v[64:65], v[48:49]
  v_pk_mul_f32 v[66:67], v[66:67], v[50:51]
  v_pk_mul_f32 v[68:69], v[68:69], v[52:53]
  v_pk_mul_f32 v[70:71], v[70:71], v[54:55]
  v_pk_add_f32 v[72:73], v[72:73], 1.0 op_sel_hi:[1,0]
  v_pk_add_f32 v[74:75], v[74:75], 1.0 op_sel_hi:[1,0]
  v_pk_add_f32 v[76:77], v[76:77], 1.0 op_sel_hi:[1,0]
  v_pk_add_f32 v[78:79], v[78:79], 1.0 op_sel_hi:[1,0]
  v_pk_add_f32 v[80:81], v[80:81], 1.0 op_sel_hi:[1,0]
  v_pk_add_f32 v[82:83], v[82:83], 1.0 op_sel_hi:[1,0]
  v_pk_add_f32 v[84:85], v[84:85], 1.0 op_sel_hi:[1,0]
  v_pk_add_f32 v[86:87], v[86:87], 1.0 op_sel_hi:[1,0]
  v_pk_fma_f32 v[88:89], v[56:57], v[56:57], v[88:89]
  v_pk_fma_f32 v[90:91], v[58:59], v[58:59], v[90:91]
  v_pk_fma_f32 v[92:93], v[60:61], v[60:61], v[92:93]
  v_pk_fma_f32 v[94:95], v[62:63], v[62:63], v[94:95]
  v_pk_fma_f32 v[96:97], v[64:65], v[64:65], v[96:97]
  v_pk_fma_f32 v[98:99], v[66:67], v[66:67], v[98:99]
  v_pk_fma_f32 v[100:101], v[68:69], v[68:69], v[100:101]
  v_pk_fma_f32 v[102:103], v[70:71], v[70:71], v[102:103]
  v_cvt_pk_bf16_f32 v104, v56, v57
  v_cvt_pk_bf16_f32 v105, v58, v59
  v_cvt_pk_bf16_f32 v106, v60, v61
  v_cvt_pk_bf16_f32 v107, v62, v63
  v_cvt_pk_bf16_f32 v108, v64, v65
  v_cvt_pk_bf16_f32 v109, v66, v67
  v_cvt_pk_bf16_f32 v110, v68, v69
  v_cvt_pk_bf16_f32 v111, v70, v71
  v_pk_fma_f32 v[56:57], v[24:25], v[24:25], s[50:51] neg_lo:[1,0,0] neg_hi:[1,0,0]
  v_pk_fma_f32 v[58:59], v[26:27], v[26:27], s[50:51] neg_lo:[1,0,0] neg_hi:[1,0,0]
  v_pk_fma_f32 v[60:61], v[28:29], v[28:29], s[50:51] neg_lo:[1,0,0] neg_hi:[1,0,0]
  v_pk_fma_f32 v[62:63], v[30:31], v[30:31], s[50:51] neg_lo:[1,0,0] neg_hi:[1,0,0]
  v_pk_fma_f32 v[64:65], v[32:33], v[32:33], s[50:51] neg_lo:[1,0,0] neg_hi:[1,0,0]
  v_pk_fma_f32 v[66:67], v[34:35], v[34:35], s[50:51] neg_lo:[1,0,0] neg_hi:[1,0,0]
  v_pk_fma_f32 v[68:69], v[36:37], v[36:37], s[50:51] neg_lo:[1,0,0] neg_hi:[1,0,0]
  v_pk_fma_f32 v[70:71], v[38:39], v[38:39], s[50:51] neg_lo:[1,0,0] neg_hi:[1,0,0]
  v_pk_mul_f32 v[56:57], v[56:57], v[24:25]
  v_pk_mul_f32 v[58:59], v[58:59], v[26:27]
  v_pk_mul_f32 v[60:61], v[60:61], v[28:29]
  v_pk_mul_f32 v[62:63], v[62:63], v[30:31]
  v_pk_mul_f32 v[64:65], v[64:65], v[32:33]
  v_pk_mul_f32 v[66:67], v[66:67], v[34:35]
  v_pk_mul_f32 v[68:69], v[68:69], v[36:37]
  v_pk_mul_f32 v[70:71], v[70:71], v[38:39]
  s_waitcnt lgkmcnt(2)
  v_mfma_f32_32x32x16_bf16 v[40:55], a[240:243], a[224:227], 0
  ds_read_b128 a[224:227], v2 offset:28672
  v_exp_f32 v56, v56
  v_rcp_f32 v72, v72
  v_mfma_f32_32x32x16_bf16 v[40:55], a[244:247], a[228:231], v[40:55]
  s_waitcnt lgkmcnt(1)
  ds_read_b128 a[228:231], v2 offset:29696
  v_exp_f32 v57, v57
  v_rcp_f32 v73, v73
  v_exp_f32 v58, v58
  v_mfma_f32_32x32x16_bf16 v[40:55], a[248:251], a[232:235], v[40:55]
  ds_read_b128 a[232:235], v2 offset:30720
  v_rcp_f32 v74, v74
  v_exp_f32 v59, v59
  v_rcp_f32 v75, v75
  v_mfma_f32_32x32x16_bf16 v[40:55], a[252:255], a[236:239], v[40:55]
  s_waitcnt lgkmcnt(1)
  ds_read_b128 a[236:239], v2 offset:31744
  v_exp_f32 v60, v60
  v_rcp_f32 v76, v76
  v_exp_f32 v61, v61
  v_mfma_f32_32x32x16_bf16 v[40:55], v[112:115], a[224:227], v[40:55]
  ds_read_b128 a[224:227], v2 offset:32768
  v_rcp_f32 v77, v77
  v_exp_f32 v62, v62
  v_rcp_f32 v78, v78
  v_mfma_f32_32x32x16_bf16 v[40:55], v[116:119], a[228:231], v[40:55]
  s_waitcnt lgkmcnt(1)
  ds_read_b128 a[228:231], v2 offset:33792
  v_exp_f32 v63, v63
  v_rcp_f32 v79, v79
  v_exp_f32 v64, v64
  v_mfma_f32_32x32x16_bf16 v[40:55], v[120:123], a[232:235], v[40:55]
  ds_read_b128 a[232:235], v2 offset:34816
  v_rcp_f32 v80, v80
  v_exp_f32 v65, v65
  v_rcp_f32 v81, v81
  v_mfma_f32_32x32x16_bf16 v[40:55], v[124:127], a[236:239], v[40:55]
  s_waitcnt lgkmcnt(1)
  ds_read_b128 a[236:239], v2 offset:35840
  v_exp_f32 v66, v66
  v_rcp_f32 v82, v82
  v_exp_f32 v67, v67
  v_mfma_f32_32x32x16_bf16 v[40:55], v[128:131], a[224:227], v[40:55]
  ds_read_b128 a[224:227], v2 offset:36864
  v_rcp_f32 v83, v83
  v_exp_f32 v68, v68
  v_rcp_f32 v84, v84
  v_mfma_f32_32x32x16_bf16 v[40:55], v[132:135], a[228:231], v[40:55]
  s_waitcnt lgkmcnt(1)
  ds_read_b128 a[228:231], v2 offset:37888
  v_exp_f32 v69, v69
  v_rcp_f32 v85, v85
  v_exp_f32 v70, v70
  v_mfma_f32_32x32x16_bf16 v[40:55], v[136:139], a[232:235], v[40:55]
  ds_read_b128 a[232:235], v2 offset:38912
  v_rcp_f32 v86, v86
  v_exp_f32 v71, v71
  v_rcp_f32 v87, v87
  v_mfma_f32_32x32x16_bf16 v[40:55], v[140:143], a[236:239], v[40:55]
  ds_read_b128 a[236:239], v2 offset:39936
  v_accvgpr_write_b32 a16, v104
  v_accvgpr_write_b32 a17, v105
  v_accvgpr_write_b32 a18, v106
  v_accvgpr_write_b32 a19, v107
  v_accvgpr_write_b32 a20, v108
  v_accvgpr_write_b32 a21, v109
  v_accvgpr_write_b32 a22, v110
  v_accvgpr_write_b32 a23, v111
  v_pk_mul_f32 v[72:73], v[72:73], v[8:9]
  v_pk_mul_f32 v[74:75], v[74:75], v[10:11]
  v_pk_mul_f32 v[76:77], v[76:77], v[12:13]
  v_pk_mul_f32 v[78:79], v[78:79], v[14:15]
  v_pk_mul_f32 v[80:81], v[80:81], v[16:17]
  v_pk_mul_f32 v[82:83], v[82:83], v[18:19]
  v_pk_mul_f32 v[84:85], v[84:85], v[20:21]
  v_pk_mul_f32 v[86:87], v[86:87], v[22:23]
  v_pk_add_f32 v[56:57], v[56:57], 1.0 op_sel_hi:[1,0]
  v_pk_add_f32 v[58:59], v[58:59], 1.0 op_sel_hi:[1,0]
  v_pk_add_f32 v[60:61], v[60:61], 1.0 op_sel_hi:[1,0]
  v_pk_add_f32 v[62:63], v[62:63], 1.0 op_sel_hi:[1,0]
  v_pk_add_f32 v[64:65], v[64:65], 1.0 op_sel_hi:[1,0]
  v_pk_add_f32 v[66:67], v[66:67], 1.0 op_sel_hi:[1,0]
  v_pk_add_f32 v[68:69], v[68:69], 1.0 op_sel_hi:[1,0]
  v_pk_add_f32 v[70:71], v[70:71], 1.0 op_sel_hi:[1,0]
  v_pk_fma_f32 v[88:89], v[72:73], v[72:73], v[88:89]
  v_pk_fma_f32 v[90:91], v[74:75], v[74:75], v[90:91]
  v_pk_fma_f32 v[92:93], v[76:77], v[76:77], v[92:93]
  v_pk_fma_f32 v[94:95], v[78:79], v[78:79], v[94:95]
  v_pk_fma_f32 v[96:97], v[80:81], v[80:81], v[96:97]
  v_pk_fma_f32 v[98:99], v[82:83], v[82:83], v[98:99]
  v_pk_fma_f32 v[100:101], v[84:85], v[84:85], v[100:101]
  v_pk_fma_f32 v[102:103], v[86:87], v[86:87], v[102:103]
  v_cvt_pk_bf16_f32 v104, v72, v73
  v_cvt_pk_bf16_f32 v105, v74, v75
  v_cvt_pk_bf16_f32 v106, v76, v77
  v_cvt_pk_bf16_f32 v107, v78, v79
  v_cvt_pk_bf16_f32 v108, v80, v81
  v_cvt_pk_bf16_f32 v109, v82, v83
  v_cvt_pk_bf16_f32 v110, v84, v85
  v_cvt_pk_bf16_f32 v111, v86, v87
  v_pk_fma_f32 v[72:73], v[40:41], v[40:41], s[50:51] neg_lo:[1,0,0] neg_hi:[1,0,0]
  v_pk_fma_f32 v[74:75], v[42:43], v[42:43], s[50:51] neg_lo:[1,0,0] neg_hi:[1,0,0]
  v_pk_fma_f32 v[76:77], v[44:45], v[44:45], s[50:51] neg_lo:[1,0,0] neg_hi:[1,0,0]
  v_pk_fma_f32 v[78:79], v[46:47], v[46:47], s[50:51] neg_lo:[1,0,0] neg_hi:[1,0,0]
  v_pk_fma_f32 v[80:81], v[48:49], v[48:49], s[50:51] neg_lo:[1,0,0] neg_hi:[1,0,0]
  v_pk_fma_f32 v[82:83], v[50:51], v[50:51], s[50:51] neg_lo:[1,0,0] neg_hi:[1,0,0]
  v_pk_fma_f32 v[84:85], v[52:53], v[52:53], s[50:51] neg_lo:[1,0,0] neg_hi:[1,0,0]
  v_pk_fma_f32 v[86:87], v[54:55], v[54:55], s[50:51] neg_lo:[1,0,0] neg_hi:[1,0,0]
  v_pk_mul_f32 v[72:73], v[72:73], v[40:41]
  v_pk_mul_f32 v[74:75], v[74:75], v[42:43]
  v_pk_mul_f32 v[76:77], v[76:77], v[44:45]
  v_pk_mul_f32 v[78:79], v[78:79], v[46:47]
  v_pk_mul_f32 v[80:81], v[80:81], v[48:49]
  v_pk_mul_f32 v[82:83], v[82:83], v[50:51]
  v_pk_mul_f32 v[84:85], v[84:85], v[52:53]
  v_pk_mul_f32 v[86:87], v[86:87], v[54:55]
  s_waitcnt vmcnt(0)
  s_waitcnt lgkmcnt(2)
  v_mfma_f32_32x32x16_bf16 v[8:23], a[240:243], a[224:227], 0
  ds_read_b128 a[224:227], v2 offset:40960
  ds_read_b64_tr_b16 a[240:241], v3 offset:0
  ds_read_b64_tr_b16 a[242:243], v3 offset:1024
  v_exp_f32 v72, v72
  v_rcp_f32 v56, v56
  v_mfma_f32_32x32x16_bf16 v[8:23], a[244:247], a[228:231], v[8:23]
  s_waitcnt lgkmcnt(3)
  ds_read_b128 a[228:231], v2 offset:41984
  ds_read_b64_tr_b16 a[244:245], v3 offset:512
  ds_read_b64_tr_b16 a[246:247], v3 offset:1536
  v_exp_f32 v73, v73
  v_rcp_f32 v57, v57
  v_exp_f32 v74, v74
  v_mfma_f32_32x32x16_bf16 v[8:23], a[248:251], a[232:235], v[8:23]
  ds_read_b128 a[232:235], v2 offset:43008
  ds_read_b64_tr_b16 a[248:249], v3 offset:2048
  ds_read_b64_tr_b16 a[250:251], v3 offset:3072
  v_rcp_f32 v58, v58
  v_exp_f32 v75, v75
  v_rcp_f32 v59, v59
  v_mfma_f32_32x32x16_bf16 v[8:23], a[252:255], a[236:239], v[8:23]
  s_waitcnt lgkmcnt(5)
  ds_read_b128 a[236:239], v2 offset:44032
  ds_read_b64_tr_b16 a[252:253], v3 offset:2560
  ds_read_b64_tr_b16 a[254:255], v3 offset:3584
  v_exp_f32 v76, v76
  v_rcp_f32 v60, v60
  v_exp_f32 v77, v77
  v_mfma_f32_32x32x16_bf16 v[8:23], v[112:115], a[224:227], v[8:23]
  ds_read_b128 a[224:227], v2 offset:45056
  ds_read_b64_tr_b16 v[112:113], v3 offset:4096
  ds_read_b64_tr_b16 v[114:115], v3 offset:5120
  v_rcp_f32 v61, v61
  v_exp_f32 v78, v78
  v_rcp_f32 v62, v62
  v_mfma_f32_32x32x16_bf16 v[8:23], v[116:119], a[228:231], v[8:23]
  s_waitcnt lgkmcnt(5)
  ds_read_b128 a[228:231], v2 offset:46080
  ds_read_b64_tr_b16 v[116:117], v3 offset:4608
  ds_read_b64_tr_b16 v[118:119], v3 offset:5632
  v_exp_f32 v79, v79
  v_rcp_f32 v63, v63
  v_exp_f32 v80, v80
  v_mfma_f32_32x32x16_bf16 v[8:23], v[120:123], a[232:235], v[8:23]
  ds_read_b128 a[232:235], v2 offset:47104
  ds_read_b64_tr_b16 v[120:121], v3 offset:6144
  ds_read_b64_tr_b16 v[122:123], v3 offset:7168
  v_rcp_f32 v64, v64
  v_exp_f32 v81, v81
  v_rcp_f32 v65, v65
  v_mfma_f32_32x32x16_bf16 v[8:23], v[124:127], a[236:239], v[8:23]
  s_waitcnt lgkmcnt(5)
  ds_read_b128 a[236:239], v2 offset:48128
  ds_read_b64_tr_b16 v[124:125], v3 offset:6656
  ds_read_b64_tr_b16 v[126:127], v3 offset:7680
  v_exp_f32 v82, v82
  v_rcp_f32 v66, v66
  v_exp_f32 v83, v83
  v_mfma_f32_32x32x16_bf16 v[8:23], v[128:131], a[224:227], v[8:23]
  ds_read_b128 a[224:227], v1 offset:0
  ds_read_b64_tr_b16 v[128:129], v3 offset:8192
  ds_read_b64_tr_b16 v[130:131], v3 offset:9216
  v_rcp_f32 v67, v67
  v_exp_f32 v84, v84
  v_rcp_f32 v68, v68
  v_mfma_f32_32x32x16_bf16 v[8:23], v[132:135], a[228:231], v[8:23]
  s_waitcnt lgkmcnt(5)
  ds_read_b128 a[228:231], v1 offset:1024
  ds_read_b64_tr_b16 v[132:133], v3 offset:8704
  ds_read_b64_tr_b16 v[134:135], v3 offset:9728
  v_exp_f32 v85, v85
  v_rcp_f32 v69, v69
  v_exp_f32 v86, v86
  v_mfma_f32_32x32x16_bf16 v[8:23], v[136:139], a[232:235], v[8:23]
  ds_read_b128 a[232:235], v1 offset:2048
  ds_read_b64_tr_b16 v[136:137], v3 offset:10240
  ds_read_b64_tr_b16 v[138:139], v3 offset:11264
  v_rcp_f32 v70, v70
  v_exp_f32 v87, v87
  v_rcp_f32_e64 v71, v71
  v_mfma_f32_32x32x16_bf16 v[8:23], v[140:143], a[236:239], v[8:23]
  ds_read_b128 a[236:239], v1 offset:3072
  ds_read_b64_tr_b16 v[140:141], v3 offset:10752
  ds_read_b64_tr_b16 v[142:143], v3 offset:11776
  v_accvgpr_write_b32 a24, v104
  v_accvgpr_write_b32 a25, v105
  v_accvgpr_write_b32 a26, v106
  v_accvgpr_write_b32 a27, v107
  v_accvgpr_write_b32 a28, v108
  v_accvgpr_write_b32 a29, v109
  v_accvgpr_write_b32 a30, v110
  v_accvgpr_write_b32 a31, v111
  v_pk_mul_f32 v[56:57], v[56:57], v[24:25]
  v_pk_mul_f32 v[58:59], v[58:59], v[26:27]
  v_pk_mul_f32 v[60:61], v[60:61], v[28:29]
  v_pk_mul_f32 v[62:63], v[62:63], v[30:31]
  v_pk_mul_f32 v[64:65], v[64:65], v[32:33]
  v_pk_mul_f32 v[66:67], v[66:67], v[34:35]
  v_pk_mul_f32 v[68:69], v[68:69], v[36:37]
  v_pk_mul_f32 v[70:71], v[70:71], v[38:39]
  v_pk_add_f32 v[72:73], v[72:73], 1.0 op_sel_hi:[1,0]
  v_pk_add_f32 v[74:75], v[74:75], 1.0 op_sel_hi:[1,0]
  v_pk_add_f32 v[76:77], v[76:77], 1.0 op_sel_hi:[1,0]
  v_pk_add_f32 v[78:79], v[78:79], 1.0 op_sel_hi:[1,0]
  v_pk_add_f32 v[80:81], v[80:81], 1.0 op_sel_hi:[1,0]
  v_pk_add_f32 v[82:83], v[82:83], 1.0 op_sel_hi:[1,0]
  v_pk_add_f32 v[84:85], v[84:85], 1.0 op_sel_hi:[1,0]
  v_pk_add_f32 v[86:87], v[86:87], 1.0 op_sel_hi:[1,0]
  v_pk_fma_f32 v[88:89], v[56:57], v[56:57], v[88:89]
  v_pk_fma_f32 v[90:91], v[58:59], v[58:59], v[90:91]
  v_pk_fma_f32 v[92:93], v[60:61], v[60:61], v[92:93]
  v_pk_fma_f32 v[94:95], v[62:63], v[62:63], v[94:95]
  v_pk_fma_f32 v[96:97], v[64:65], v[64:65], v[96:97]
  v_pk_fma_f32 v[98:99], v[66:67], v[66:67], v[98:99]
  v_pk_fma_f32 v[100:101], v[68:69], v[68:69], v[100:101]
  v_pk_fma_f32 v[102:103], v[70:71], v[70:71], v[102:103]
  v_cvt_pk_bf16_f32 v104, v56, v57
  v_cvt_pk_bf16_f32 v105, v58, v59
  v_cvt_pk_bf16_f32 v106, v60, v61
  v_cvt_pk_bf16_f32 v107, v62, v63
  v_cvt_pk_bf16_f32 v108, v64, v65
  v_cvt_pk_bf16_f32 v109, v66, v67
  v_cvt_pk_bf16_f32 v110, v68, v69
  v_cvt_pk_bf16_f32 v111, v70, v71
  v_pk_fma_f32 v[56:57], v[8:9], v[8:9], s[50:51] neg_lo:[1,0,0] neg_hi:[1,0,0]
  v_pk_fma_f32 v[58:59], v[10:11], v[10:11], s[50:51] neg_lo:[1,0,0] neg_hi:[1,0,0]
  v_pk_fma_f32 v[60:61], v[12:13], v[12:13], s[50:51] neg_lo:[1,0,0] neg_hi:[1,0,0]
  v_pk_fma_f32 v[62:63], v[14:15], v[14:15], s[50:51] neg_lo:[1,0,0] neg_hi:[1,0,0]
  v_pk_fma_f32 v[64:65], v[16:17], v[16:17], s[50:51] neg_lo:[1,0,0] neg_hi:[1,0,0]
  v_pk_fma_f32 v[66:67], v[18:19], v[18:19], s[50:51] neg_lo:[1,0,0] neg_hi:[1,0,0]
  v_pk_fma_f32 v[68:69], v[20:21], v[20:21], s[50:51] neg_lo:[1,0,0] neg_hi:[1,0,0]
  v_pk_fma_f32 v[70:71], v[22:23], v[22:23], s[50:51] neg_lo:[1,0,0] neg_hi:[1,0,0]
  v_pk_mul_f32 v[56:57], v[56:57], v[8:9]
  v_pk_mul_f32 v[58:59], v[58:59], v[10:11]
  v_pk_mul_f32 v[60:61], v[60:61], v[12:13]
  v_pk_mul_f32 v[62:63], v[62:63], v[14:15]
  v_pk_mul_f32 v[64:65], v[64:65], v[16:17]
  v_pk_mul_f32 v[66:67], v[66:67], v[18:19]
  v_pk_mul_f32 v[68:69], v[68:69], v[20:21]
  v_pk_mul_f32 v[70:71], v[70:71], v[22:23]
  s_waitcnt lgkmcnt(8)
  v_mfma_f32_32x32x16_bf16 v[24:39], a[240:243], a[224:227], 0
  ds_read_b128 a[224:227], v1 offset:4096
  v_exp_f32 v56, v56
  v_rcp_f32 v72, v72
  v_mfma_f32_32x32x16_bf16 v[24:39], a[244:247], a[228:231], v[24:39]
  s_waitcnt lgkmcnt(3)
  ds_read_b128 a[228:231], v1 offset:5120
  v_exp_f32 v57, v57
  v_rcp_f32 v73, v73
  v_exp_f32 v58, v58
  v_mfma_f32_32x32x16_bf16 v[24:39], a[248:251], a[232:235], v[24:39]
  ds_read_b128 a[232:235], v1 offset:6144
  v_rcp_f32 v74, v74
  v_exp_f32 v59, v59
  v_rcp_f32 v75, v75
  v_mfma_f32_32x32x16_bf16 v[24:39], a[252:255], a[236:239], v[24:39]
  s_waitcnt lgkmcnt(1)
  ds_read_b128 a[236:239], v1 offset:7168
  v_exp_f32 v60, v60
  v_rcp_f32 v76, v76
  v_exp_f32 v61, v61
  v_mfma_f32_32x32x16_bf16 v[24:39], v[112:115], a[224:227], v[24:39]
  ds_read_b128 a[224:227], v1 offset:8192
  v_rcp_f32 v77, v77
  v_exp_f32 v62, v62
  v_rcp_f32 v78, v78
  v_mfma_f32_32x32x16_bf16 v[24:39], v[116:119], a[228:231], v[24:39]
  s_waitcnt lgkmcnt(1)
  ds_read_b128 a[228:231], v1 offset:9216
  v_exp_f32 v63, v63
  v_rcp_f32 v79, v79
  v_exp_f32 v64, v64
  v_mfma_f32_32x32x16_bf16 v[24:39], v[120:123], a[232:235], v[24:39]
  ds_read_b128 a[232:235], v1 offset:10240
  v_rcp_f32 v80, v80
  v_exp_f32 v65, v65
  v_rcp_f32 v81, v81
  v_mfma_f32_32x32x16_bf16 v[24:39], v[124:127], a[236:239], v[24:39]
  s_waitcnt lgkmcnt(1)
  ds_read_b128 a[236:239], v1 offset:11264
  v_exp_f32 v66, v66
  v_rcp_f32 v82, v82
  v_exp_f32 v67, v67
  v_mfma_f32_32x32x16_bf16 v[24:39], v[128:131], a[224:227], v[24:39]
  ds_read_b128 a[224:227], v1 offset:12288
  v_rcp_f32 v83, v83
  v_exp_f32 v68, v68
  v_rcp_f32 v84, v84
  v_mfma_f32_32x32x16_bf16 v[24:39], v[132:135], a[228:231], v[24:39]
  s_waitcnt lgkmcnt(1)
  ds_read_b128 a[228:231], v1 offset:13312
  v_exp_f32 v69, v69
  v_rcp_f32 v85, v85
  v_exp_f32 v70, v70
  v_mfma_f32_32x32x16_bf16 v[24:39], v[136:139], a[232:235], v[24:39]
  ds_read_b128 a[232:235], v1 offset:14336
  v_rcp_f32 v86, v86
  v_exp_f32 v71, v71
  v_rcp_f32 v87, v87
  v_mfma_f32_32x32x16_bf16 v[24:39], v[140:143], a[236:239], v[24:39]
  ds_read_b128 a[236:239], v1 offset:15360
  v_accvgpr_write_b32 a32, v104
  v_accvgpr_write_b32 a33, v105
  v_accvgpr_write_b32 a34, v106
  v_accvgpr_write_b32 a35, v107
  v_accvgpr_write_b32 a36, v108
  v_accvgpr_write_b32 a37, v109
  v_accvgpr_write_b32 a38, v110
  v_accvgpr_write_b32 a39, v111
  v_pk_mul_f32 v[72:73], v[72:73], v[40:41]
  v_pk_mul_f32 v[74:75], v[74:75], v[42:43]
  v_pk_mul_f32 v[76:77], v[76:77], v[44:45]
  v_pk_mul_f32 v[78:79], v[78:79], v[46:47]
  v_pk_mul_f32 v[80:81], v[80:81], v[48:49]
  v_pk_mul_f32 v[82:83], v[82:83], v[50:51]
  v_pk_mul_f32 v[84:85], v[84:85], v[52:53]
  v_pk_mul_f32 v[86:87], v[86:87], v[54:55]
  v_pk_add_f32 v[56:57], v[56:57], 1.0 op_sel_hi:[1,0]
  v_pk_add_f32 v[58:59], v[58:59], 1.0 op_sel_hi:[1,0]
  v_pk_add_f32 v[60:61], v[60:61], 1.0 op_sel_hi:[1,0]
  v_pk_add_f32 v[62:63], v[62:63], 1.0 op_sel_hi:[1,0]
  v_pk_add_f32 v[64:65], v[64:65], 1.0 op_sel_hi:[1,0]
  v_pk_add_f32 v[66:67], v[66:67], 1.0 op_sel_hi:[1,0]
  v_pk_add_f32 v[68:69], v[68:69], 1.0 op_sel_hi:[1,0]
  v_pk_add_f32 v[70:71], v[70:71], 1.0 op_sel_hi:[1,0]
  v_pk_fma_f32 v[88:89], v[72:73], v[72:73], v[88:89]
  v_pk_fma_f32 v[90:91], v[74:75], v[74:75], v[90:91]
  v_pk_fma_f32 v[92:93], v[76:77], v[76:77], v[92:93]
  v_pk_fma_f32 v[94:95], v[78:79], v[78:79], v[94:95]
  v_pk_fma_f32 v[96:97], v[80:81], v[80:81], v[96:97]
  v_pk_fma_f32 v[98:99], v[82:83], v[82:83], v[98:99]
  v_pk_fma_f32 v[100:101], v[84:85], v[84:85], v[100:101]
  v_pk_fma_f32 v[102:103], v[86:87], v[86:87], v[102:103]
  v_cvt_pk_bf16_f32 v104, v72, v73
  v_cvt_pk_bf16_f32 v105, v74, v75
  v_cvt_pk_bf16_f32 v106, v76, v77
  v_cvt_pk_bf16_f32 v107, v78, v79
  v_cvt_pk_bf16_f32 v108, v80, v81
  v_cvt_pk_bf16_f32 v109, v82, v83
  v_cvt_pk_bf16_f32 v110, v84, v85
  v_cvt_pk_bf16_f32 v111, v86, v87
  v_pk_fma_f32 v[72:73], v[24:25], v[24:25], s[50:51] neg_lo:[1,0,0] neg_hi:[1,0,0]
  v_pk_fma_f32 v[74:75], v[26:27], v[26:27], s[50:51] neg_lo:[1,0,0] neg_hi:[1,0,0]
  v_pk_fma_f32 v[76:77], v[28:29], v[28:29], s[50:51] neg_lo:[1,0,0] neg_hi:[1,0,0]
  v_pk_fma_f32 v[78:79], v[30:31], v[30:31], s[50:51] neg_lo:[1,0,0] neg_hi:[1,0,0]
  v_pk_fma_f32 v[80:81], v[32:33], v[32:33], s[50:51] neg_lo:[1,0,0] neg_hi:[1,0,0]
  v_pk_fma_f32 v[82:83], v[34:35], v[34:35], s[50:51] neg_lo:[1,0,0] neg_hi:[1,0,0]
  v_pk_fma_f32 v[84:85], v[36:37], v[36:37], s[50:51] neg_lo:[1,0,0] neg_hi:[1,0,0]
  v_pk_fma_f32 v[86:87], v[38:39], v[38:39], s[50:51] neg_lo:[1,0,0] neg_hi:[1,0,0]
  v_pk_mul_f32 v[72:73], v[72:73], v[24:25]
  v_pk_mul_f32 v[74:75], v[74:75], v[26:27]
  v_pk_mul_f32 v[76:77], v[76:77], v[28:29]
  v_pk_mul_f32 v[78:79], v[78:79], v[30:31]
  v_pk_mul_f32 v[80:81], v[80:81], v[32:33]
  v_pk_mul_f32 v[82:83], v[82:83], v[34:35]
  v_pk_mul_f32 v[84:85], v[84:85], v[36:37]
  v_pk_mul_f32 v[86:87], v[86:87], v[38:39]
  s_waitcnt lgkmcnt(2)
  v_mfma_f32_32x32x16_bf16 v[40:55], a[240:243], a[224:227], 0
  ds_read_b128 a[224:227], v1 offset:16384
  v_exp_f32 v72, v72
  v_rcp_f32 v56, v56
  v_add_u32 v4, 64, v4
  s_add_u32 m0, s56, 0
  v_mfma_f32_32x32x16_bf16 v[40:55], a[244:247], a[228:231], v[40:55]
  s_waitcnt lgkmcnt(1)
  buffer_load_dwordx4 v4, s[28:31], s72 offen offset:0 lds
  ds_read_b128 a[228:231], v1 offset:17408
  v_exp_f32 v73, v73
  v_rcp_f32 v57, v57
  v_exp_f32 v74, v74
  v_mfma_f32_32x32x16_bf16 v[40:55], a[248:251], a[232:235], v[40:55]
  ds_read_b128 a[232:235], v1 offset:18432
  v_rcp_f32 v58, v58
  v_exp_f32 v75, v75
  v_rcp_f32 v59, v59
  v_mfma_f32_32x32x16_bf16 v[40:55], a[252:255], a[236:239], v[40:55]
  s_waitcnt lgkmcnt(1)
  ds_read_b128 a[236:239], v1 offset:19456
  v_exp_f32 v76, v76
  v_rcp_f32 v60, v60
  v_exp_f32 v77, v77
  v_mfma_f32_32x32x16_bf16 v[40:55], v[112:115], a[224:227], v[40:55]
  buffer_load_dwordx4 v4, s[28:31], s73 offen offset:1024 lds
  ds_read_b128 a[224:227], v1 offset:20480
  v_rcp_f32 v61, v61
  v_exp_f32 v78, v78
  v_rcp_f32 v62, v62
  v_mfma_f32_32x32x16_bf16 v[40:55], v[116:119], a[228:231], v[40:55]
  s_waitcnt lgkmcnt(1)
  ds_read_b128 a[228:231], v1 offset:21504
  v_exp_f32 v79, v79
  v_rcp_f32 v63, v63
  v_exp_f32 v80, v80
  v_mfma_f32_32x32x16_bf16 v[40:55], v[120:123], a[232:235], v[40:55]
  ds_read_b128 a[232:235], v1 offset:22528
  v_rcp_f32 v64, v64
  v_exp_f32 v81, v81
  v_rcp_f32 v65, v65
  v_mfma_f32_32x32x16_bf16 v[40:55], v[124:127], a[236:239], v[40:55]
  s_waitcnt lgkmcnt(1)
  buffer_load_dwordx4 v4, s[28:31], s74 offen offset:2048 lds
  ds_read_b128 a[236:239], v1 offset:23552
  v_exp_f32 v82, v82
  v_rcp_f32 v66, v66
  v_exp_f32 v83, v83
  v_mfma_f32_32x32x16_bf16 v[40:55], v[128:131], a[224:227], v[40:55]
  ds_read_b128 a[224:227], v1 offset:24576
  v_rcp_f32 v67, v67
  v_exp_f32 v84, v84
  v_rcp_f32 v68, v68
  v_mfma_f32_32x32x16_bf16 v[40:55], v[132:135], a[228:231], v[40:55]
  s_waitcnt lgkmcnt(1)
  ds_read_b128 a[228:231], v1 offset:25600
  v_exp_f32 v85, v85
  v_rcp_f32 v69, v69
  v_exp_f32 v86, v86
  v_mfma_f32_32x32x16_bf16 v[40:55], v[136:139], a[232:235], v[40:55]
  buffer_load_dwordx4 v4, s[28:31], s75 offen offset:3072 lds
  ds_read_b128 a[232:235], v1 offset:26624
  v_rcp_f32 v70, v70
  v_exp_f32 v87, v87
  v_rcp_f32 v71, v71
  v_mfma_f32_32x32x16_bf16 v[40:55], v[140:143], a[236:239], v[40:55]
  ds_read_b128 a[236:239], v1 offset:27648
  v_accvgpr_write_b32 a40, v104
  v_accvgpr_write_b32 a41, v105
  v_accvgpr_write_b32 a42, v106
  v_accvgpr_write_b32 a43, v107
  v_accvgpr_write_b32 a44, v108
  v_accvgpr_write_b32 a45, v109
  v_accvgpr_write_b32 a46, v110
  v_accvgpr_write_b32 a47, v111
  v_pk_mul_f32 v[56:57], v[56:57], v[8:9]
  v_pk_mul_f32 v[58:59], v[58:59], v[10:11]
  v_pk_mul_f32 v[60:61], v[60:61], v[12:13]
  v_pk_mul_f32 v[62:63], v[62:63], v[14:15]
  v_pk_mul_f32 v[64:65], v[64:65], v[16:17]
  v_pk_mul_f32 v[66:67], v[66:67], v[18:19]
  v_pk_mul_f32 v[68:69], v[68:69], v[20:21]
  v_pk_mul_f32 v[70:71], v[70:71], v[22:23]
  v_pk_add_f32 v[72:73], v[72:73], 1.0 op_sel_hi:[1,0]
  v_pk_add_f32 v[74:75], v[74:75], 1.0 op_sel_hi:[1,0]
  v_pk_add_f32 v[76:77], v[76:77], 1.0 op_sel_hi:[1,0]
  v_pk_add_f32 v[78:79], v[78:79], 1.0 op_sel_hi:[1,0]
  v_pk_add_f32 v[80:81], v[80:81], 1.0 op_sel_hi:[1,0]
  v_pk_add_f32 v[82:83], v[82:83], 1.0 op_sel_hi:[1,0]
  v_pk_add_f32 v[84:85], v[84:85], 1.0 op_sel_hi:[1,0]
  v_pk_add_f32 v[86:87], v[86:87], 1.0 op_sel_hi:[1,0]
  v_pk_fma_f32 v[88:89], v[56:57], v[56:57], v[88:89]
  v_pk_fma_f32 v[90:91], v[58:59], v[58:59], v[90:91]
  v_pk_fma_f32 v[92:93], v[60:61], v[60:61], v[92:93]
  v_pk_fma_f32 v[94:95], v[62:63], v[62:63], v[94:95]
  v_pk_fma_f32 v[96:97], v[64:65], v[64:65], v[96:97]
  v_pk_fma_f32 v[98:99], v[66:67], v[66:67], v[98:99]
  v_pk_fma_f32 v[100:101], v[68:69], v[68:69], v[100:101]
  v_pk_fma_f32 v[102:103], v[70:71], v[70:71], v[102:103]
  v_cvt_pk_bf16_f32 v104, v56, v57
  v_cvt_pk_bf16_f32 v105, v58, v59
  v_cvt_pk_bf16_f32 v106, v60, v61
  v_cvt_pk_bf16_f32 v107, v62, v63
  v_cvt_pk_bf16_f32 v108, v64, v65
  v_cvt_pk_bf16_f32 v109, v66, v67
  v_cvt_pk_bf16_f32 v110, v68, v69
  v_cvt_pk_bf16_f32 v111, v70, v71
  v_pk_fma_f32 v[56:57], v[40:41], v[40:41], s[50:51] neg_lo:[1,0,0] neg_hi:[1,0,0]
  v_pk_fma_f32 v[58:59], v[42:43], v[42:43], s[50:51] neg_lo:[1,0,0] neg_hi:[1,0,0]
  v_pk_fma_f32 v[60:61], v[44:45], v[44:45], s[50:51] neg_lo:[1,0,0] neg_hi:[1,0,0]
  v_pk_fma_f32 v[62:63], v[46:47], v[46:47], s[50:51] neg_lo:[1,0,0] neg_hi:[1,0,0]
  v_pk_fma_f32 v[64:65], v[48:49], v[48:49], s[50:51] neg_lo:[1,0,0] neg_hi:[1,0,0]
  v_pk_fma_f32 v[66:67], v[50:51], v[50:51], s[50:51] neg_lo:[1,0,0] neg_hi:[1,0,0]
  v_pk_fma_f32 v[68:69], v[52:53], v[52:53], s[50:51] neg_lo:[1,0,0] neg_hi:[1,0,0]
  v_pk_fma_f32 v[70:71], v[54:55], v[54:55], s[50:51] neg_lo:[1,0,0] neg_hi:[1,0,0]
  v_pk_mul_f32 v[56:57], v[56:57], v[40:41]
  v_pk_mul_f32 v[58:59], v[58:59], v[42:43]
  v_pk_mul_f32 v[60:61], v[60:61], v[44:45]
  v_pk_mul_f32 v[62:63], v[62:63], v[46:47]
  v_pk_mul_f32 v[64:65], v[64:65], v[48:49]
  v_pk_mul_f32 v[66:67], v[66:67], v[50:51]
  v_pk_mul_f32 v[68:69], v[68:69], v[52:53]
  v_pk_mul_f32 v[70:71], v[70:71], v[54:55]
  s_waitcnt lgkmcnt(2)
  v_mfma_f32_32x32x16_bf16 v[8:23], a[240:243], a[224:227], 0
  ds_read_b128 a[224:227], v1 offset:28672
  v_exp_f32 v56, v56
  v_add_f32_dpp v88, v88, v88 row_ror:8 row_mask:0xf bank_mask:0x3
  v_rcp_f32 v72, v72
  v_add_f32_dpp v89, v89, v89 row_ror:8 row_mask:0xf bank_mask:0x3
  v_exp_f32 v57, v57
  v_add_f32_dpp v90, v90, v90 row_ror:8 row_mask:0xf bank_mask:0x3
  s_add_u32 m0, s56, 4096
  v_mfma_f32_32x32x16_bf16 v[8:23], a[244:247], a[228:231], v[8:23]
  s_waitcnt lgkmcnt(1)
  buffer_load_dwordx4 v4, s[28:31], s76 offen offset:0 lds
  ds_read_b128 a[228:231], v1 offset:29696
  v_rcp_f32 v73, v73
  v_add_f32_dpp v91, v91, v91 row_ror:8 row_mask:0xf bank_mask:0x3
  v_exp_f32 v58, v58
  v_add_f32_dpp v92, v92, v92 row_ror:8 row_mask:0xf bank_mask:0x3
  v_rcp_f32 v74, v74
  v_add_f32_dpp v93, v93, v93 row_ror:8 row_mask:0xf bank_mask:0x3
  v_mfma_f32_32x32x16_bf16 v[8:23], a[248:251], a[232:235], v[8:23]
  ds_read_b128 a[232:235], v1 offset:30720
  v_exp_f32 v59, v59
  v_add_f32_dpp v94, v94, v94 row_ror:8 row_mask:0xf bank_mask:0x3
  v_add_f32_dpp v95, v95, v95 row_ror:8 row_mask:0xf bank_mask:0x3
  v_rcp_f32 v75, v75
  v_add_f32_dpp v88, v96, v96 row_ror:8 row_mask:0xf bank_mask:0xc
  v_exp_f32 v60, v60
  v_mfma_f32_32x32x16_bf16 v[8:23], a[252:255], a[236:239], v[8:23]
  s_waitcnt lgkmcnt(1)
  ds_read_b128 a[236:239], v1 offset:31744
  v_add_f32_dpp v89, v97, v97 row_ror:8 row_mask:0xf bank_mask:0xc
  v_rcp_f32 v76, v76
  v_add_f32_dpp v90, v98, v98 row_ror:8 row_mask:0xf bank_mask:0xc
  v_exp_f32 v61, v61
  v_add_f32_dpp v91, v99, v99 row_ror:8 row_mask:0xf bank_mask:0xc
  v_rcp_f32 v77, v77
  v_add_f32_dpp v92, v100, v100 row_ror:8 row_mask:0xf bank_mask:0xc
  v_mfma_f32_32x32x16_bf16 v[8:23], v[112:115], a[224:227], v[8:23]
  buffer_load_dwordx4 v4, s[28:31], s77 offen offset:1024 lds
  ds_read_b128 a[224:227], v1 offset:32768
  v_exp_f32 v62, v62
  v_add_f32_dpp v93, v101, v101 row_ror:8 row_mask:0xf bank_mask:0xc
  v_add_f32_dpp v94, v102, v102 row_ror:8 row_mask:0xf bank_mask:0xc
  v_rcp_f32 v78, v78
  v_add_f32_dpp v95, v103, v103 row_ror:8 row_mask:0xf bank_mask:0xc
  v_exp_f32 v63, v63
  v_mfma_f32_32x32x16_bf16 v[8:23], v[116:119], a[228:231], v[8:23]
  s_waitcnt lgkmcnt(1)
  ds_read_b128 a[228:231], v1 offset:33792
  v_add_f32_dpp v88, v88, v88 row_shl:4 row_mask:0xf bank_mask:0x5
  v_rcp_f32 v79, v79
  v_add_f32_dpp v89, v89, v89 row_shl:4 row_mask:0xf bank_mask:0x5
  v_exp_f32 v64, v64
  v_add_f32_dpp v90, v90, v90 row_shl:4 row_mask:0xf bank_mask:0x5
  v_rcp_f32 v80, v80
  v_mfma_f32_32x32x16_bf16 v[8:23], v[120:123], a[232:235], v[8:23]
  ds_read_b128 a[232:235], v1 offset:34816
  v_add_f32_dpp v91, v91, v91 row_shl:4 row_mask:0xf bank_mask:0x5
  v_exp_f32 v65, v65
  v_add_f32_dpp v88, v92, v92 row_shr:4 row_mask:0xf bank_mask:0xa
  v_rcp_f32 v81, v81
  v_add_f32_dpp v89, v93, v93 row_shr:4 row_mask:0xf bank_mask:0xa
  v_add_f32_dpp v90, v94, v94 row_shr:4 row_mask:0xf bank_mask:0xa
  v_mfma_f32_32x32x16_bf16 v[8:23], v[124:127], a[236:239], v[8:23]
  s_waitcnt lgkmcnt(1)
  buffer_load_dwordx4 v4, s[28:31], s78 offen offset:2048 lds
  ds_read_b128 a[236:239], v1 offset:35840
  v_exp_f32 v66, v66
  v_add_f32_dpp v91, v95, v95 row_shr:4 row_mask:0xf bank_mask:0xa
  v_rcp_f32 v82, v82
  v_add_f32_dpp v92, v88, v88 quad_perm:[2,3,0,1] row_mask:0xf bank_mask:0xf
  v_exp_f32 v67, v67
  v_add_f32_dpp v93, v89, v89 quad_perm:[2,3,0,1] row_mask:0xf bank_mask:0xf
  v_rcp_f32 v83, v83
  v_mfma_f32_32x32x16_bf16 v[8:23], v[128:131], a[224:227], v[8:23]
  ds_read_b128 a[224:227], v2 offset:0
  v_add_f32_dpp v94, v90, v90 quad_perm:[2,3,0,1] row_mask:0xf bank_mask:0xf
  v_exp_f32 v68, v68
  v_add_f32_dpp v95, v91, v91 quad_perm:[2,3,0,1] row_mask:0xf bank_mask:0xf
  v_rcp_f32 v84, v84
  v_cndmask_b32 v88, v92, v94, s[64:65]
  v_cndmask_b32 v89, v93, v95, s[64:65]
  v_mfma_f32_32x32x16_bf16 v[8:23], v[132:135], a[228:231], v[8:23]
  s_waitcnt lgkmcnt(1)
  ds_read_b128 a[228:231], v2 offset:1024
  v_exp_f32 v69, v69
  v_add_f32_dpp v90, v88, v88 quad_perm:[1,0,3,2] row_mask:0xf bank_mask:0xf
  v_rcp_f32 v85, v85
  v_add_f32_dpp v91, v89, v89 quad_perm:[1,0,3,2] row_mask:0xf bank_mask:0xf
  v_exp_f32 v70, v70
  v_cndmask_b32 v92, v90, v91, s[58:59]
  v_mfma_f32_32x32x16_bf16 v[8:23], v[136:139], a[232:235], v[8:23]
  buffer_load_dwordx4 v4, s[28:31], s79 offen offset:3072 lds
  ds_read_b128 a[232:235], v2 offset:2048
  v_rcp_f32 v86, v86
  v_mov_b32 v6, v92
  v_exp_f32 v71, v71
  s_nop 0
  v_permlane16_swap_b32 v92, v6
  v_rcp_f32 v87, v87
  v_add_f32_e64 v6, v6, v92
  s_mov_b32 exec_lo, 0xffff
  s_mov_b32 exec_hi, 0xffff
  buffer_atomic_add_f32 v6, v5, s[4:7], 0 offen offset:0
  s_mov_b64 exec, -1
  v_mfma_f32_32x32x16_bf16 v[8:23], v[140:143], a[236:239], v[8:23]
  ds_read_b128 a[236:239], v2 offset:3072
  v_accvgpr_write_b32 a48, v104
  v_accvgpr_write_b32 a49, v105
  v_accvgpr_write_b32 a50, v106
  v_accvgpr_write_b32 a51, v107
  v_accvgpr_write_b32 a52, v108
  v_accvgpr_write_b32 a53, v109
  v_accvgpr_write_b32 a54, v110
  v_accvgpr_write_b32 a55, v111
  v_pk_mul_f32 v[72:73], v[72:73], v[24:25]
  v_pk_mul_f32 v[74:75], v[74:75], v[26:27]
  v_pk_mul_f32 v[76:77], v[76:77], v[28:29]
  v_pk_mul_f32 v[78:79], v[78:79], v[30:31]
  v_pk_mul_f32 v[80:81], v[80:81], v[32:33]
  v_pk_mul_f32 v[82:83], v[82:83], v[34:35]
  v_pk_mul_f32 v[84:85], v[84:85], v[36:37]
  v_pk_mul_f32 v[86:87], v[86:87], v[38:39]
  v_pk_add_f32 v[56:57], v[56:57], 1.0 op_sel_hi:[1,0]
  v_pk_add_f32 v[58:59], v[58:59], 1.0 op_sel_hi:[1,0]
  v_pk_add_f32 v[60:61], v[60:61], 1.0 op_sel_hi:[1,0]
  v_pk_add_f32 v[62:63], v[62:63], 1.0 op_sel_hi:[1,0]
  v_pk_add_f32 v[64:65], v[64:65], 1.0 op_sel_hi:[1,0]
  v_pk_add_f32 v[66:67], v[66:67], 1.0 op_sel_hi:[1,0]
  v_pk_add_f32 v[68:69], v[68:69], 1.0 op_sel_hi:[1,0]
  v_pk_add_f32 v[70:71], v[70:71], 1.0 op_sel_hi:[1,0]
  v_pk_mul_f32 v[88:89], v[72:73], v[72:73]
  v_pk_mul_f32 v[90:91], v[74:75], v[74:75]
  v_pk_mul_f32 v[92:93], v[76:77], v[76:77]
  v_pk_mul_f32 v[94:95], v[78:79], v[78:79]
  v_pk_mul_f32 v[96:97], v[80:81], v[80:81]
  v_pk_mul_f32 v[98:99], v[82:83], v[82:83]
  v_pk_mul_f32 v[100:101], v[84:85], v[84:85]
  v_pk_mul_f32 v[102:103], v[86:87], v[86:87]
  v_cvt_pk_bf16_f32 v104, v72, v73
  v_cvt_pk_bf16_f32 v105, v74, v75
  v_cvt_pk_bf16_f32 v106, v76, v77
  v_cvt_pk_bf16_f32 v107, v78, v79
  v_cvt_pk_bf16_f32 v108, v80, v81
  v_cvt_pk_bf16_f32 v109, v82, v83
  v_cvt_pk_bf16_f32 v110, v84, v85
  v_cvt_pk_bf16_f32 v111, v86, v87
  v_pk_fma_f32 v[72:73], v[8:9], v[8:9], s[50:51] neg_lo:[1,0,0] neg_hi:[1,0,0]
  v_pk_fma_f32 v[74:75], v[10:11], v[10:11], s[50:51] neg_lo:[1,0,0] neg_hi:[1,0,0]
  v_pk_fma_f32 v[76:77], v[12:13], v[12:13], s[50:51] neg_lo:[1,0,0] neg_hi:[1,0,0]
  v_pk_fma_f32 v[78:79], v[14:15], v[14:15], s[50:51] neg_lo:[1,0,0] neg_hi:[1,0,0]
  v_pk_fma_f32 v[80:81], v[16:17], v[16:17], s[50:51] neg_lo:[1,0,0] neg_hi:[1,0,0]
  v_pk_fma_f32 v[82:83], v[18:19], v[18:19], s[50:51] neg_lo:[1,0,0] neg_hi:[1,0,0]
  v_pk_fma_f32 v[84:85], v[20:21], v[20:21], s[50:51] neg_lo:[1,0,0] neg_hi:[1,0,0]
  v_pk_fma_f32 v[86:87], v[22:23], v[22:23], s[50:51] neg_lo:[1,0,0] neg_hi:[1,0,0]
  v_pk_mul_f32 v[72:73], v[72:73], v[8:9]
  v_pk_mul_f32 v[74:75], v[74:75], v[10:11]
  v_pk_mul_f32 v[76:77], v[76:77], v[12:13]
  v_pk_mul_f32 v[78:79], v[78:79], v[14:15]
  v_pk_mul_f32 v[80:81], v[80:81], v[16:17]
  v_pk_mul_f32 v[82:83], v[82:83], v[18:19]
  v_pk_mul_f32 v[84:85], v[84:85], v[20:21]
  v_pk_mul_f32 v[86:87], v[86:87], v[22:23]
  s_waitcnt lgkmcnt(2)
  v_mfma_f32_32x32x16_bf16 v[24:39], a[240:243], a[224:227], 0
  ds_read_b128 a[224:227], v2 offset:4096
  v_exp_f32 v72, v72
  v_rcp_f32 v56, v56
  s_add_u32 m0, s56, 8192
  v_mfma_f32_32x32x16_bf16 v[24:39], a[244:247], a[228:231], v[24:39]
  s_waitcnt lgkmcnt(1)
  buffer_load_dwordx4 v4, s[28:31], s80 offen offset:0 lds
  ds_read_b128 a[228:231], v2 offset:5120
  v_exp_f32 v73, v73
  v_rcp_f32 v57, v57
  v_exp_f32 v74, v74
  v_mfma_f32_32x32x16_bf16 v[24:39], a[248:251], a[232:235], v[24:39]
  ds_read_b128 a[232:235], v2 offset:6144
  v_rcp_f32 v58, v58
  v_exp_f32 v75, v75
  v_rcp_f32 v59, v59
  v_mfma_f32_32x32x16_bf16 v[24:39], a[252:255], a[236:239], v[24:39]
  s_waitcnt lgkmcnt(1)
  ds_read_b128 a[236:239], v2 offset:7168
  v_exp_f32 v76, v76
  v_rcp_f32 v60, v60
  v_exp_f32 v77, v77
  v_mfma_f32_32x32x16_bf16 v[24:39], v[112:115], a[224:227], v[24:39]
  buffer_load_dwordx4 v4, s[28:31], s81 offen offset:1024 lds
  ds_read_b128 a[224:227], v2 offset:8192
  v_rcp_f32 v61, v61
  v_exp_f32 v78, v78
  v_rcp_f32 v62, v62
  v_mfma_f32_32x32x16_bf16 v[24:39], v[116:119], a[228:231], v[24:39]
  s_waitcnt lgkmcnt(1)
  ds_read_b128 a[228:231], v2 offset:9216
  v_exp_f32 v79, v79
  v_rcp_f32 v63, v63
  v_exp_f32 v80, v80
  v_mfma_f32_32x32x16_bf16 v[24:39], v[120:123], a[232:235], v[24:39]
  ds_read_b128 a[232:235], v2 offset:10240
  v_rcp_f32 v64, v64
  v_exp_f32 v81, v81
  v_rcp_f32 v65, v65
  v_mfma_f32_32x32x16_bf16 v[24:39], v[124:127], a[236:239], v[24:39]
  s_waitcnt lgkmcnt(1)
  buffer_load_dwordx4 v4, s[28:31], s82 offen offset:2048 lds
  ds_read_b128 a[236:239], v2 offset:11264
  v_exp_f32 v82, v82
  v_rcp_f32 v66, v66
  v_exp_f32 v83, v83
  v_mfma_f32_32x32x16_bf16 v[24:39], v[128:131], a[224:227], v[24:39]
  ds_read_b128 a[224:227], v2 offset:12288
  v_rcp_f32 v67, v67
  v_exp_f32 v84, v84
  v_rcp_f32 v68, v68
  v_mfma_f32_32x32x16_bf16 v[24:39], v[132:135], a[228:231], v[24:39]
  s_waitcnt lgkmcnt(1)
  ds_read_b128 a[228:231], v2 offset:13312
  v_exp_f32 v85, v85
  v_rcp_f32 v69, v69
  v_exp_f32 v86, v86
  v_mfma_f32_32x32x16_bf16 v[24:39], v[136:139], a[232:235], v[24:39]
  buffer_load_dwordx4 v4, s[28:31], s83 offen offset:3072 lds
  ds_read_b128 a[232:235], v2 offset:14336
  v_rcp_f32 v70, v70
  v_exp_f32 v87, v87
  v_rcp_f32 v71, v71
  v_mfma_f32_32x32x16_bf16 v[24:39], v[140:143], a[236:239], v[24:39]
  ds_read_b128 a[236:239], v2 offset:15360
  v_accvgpr_write_b32 a56, v104
  v_accvgpr_write_b32 a57, v105
  v_accvgpr_write_b32 a58, v106
  v_accvgpr_write_b32 a59, v107
  v_accvgpr_write_b32 a60, v108
  v_accvgpr_write_b32 a61, v109
  v_accvgpr_write_b32 a62, v110
  v_accvgpr_write_b32 a63, v111
  v_pk_mul_f32 v[56:57], v[56:57], v[40:41]
  v_pk_mul_f32 v[58:59], v[58:59], v[42:43]
  v_pk_mul_f32 v[60:61], v[60:61], v[44:45]
  v_pk_mul_f32 v[62:63], v[62:63], v[46:47]
  v_pk_mul_f32 v[64:65], v[64:65], v[48:49]
  v_pk_mul_f32 v[66:67], v[66:67], v[50:51]
  v_pk_mul_f32 v[68:69], v[68:69], v[52:53]
  v_pk_mul_f32 v[70:71], v[70:71], v[54:55]
  v_pk_add_f32 v[72:73], v[72:73], 1.0 op_sel_hi:[1,0]
  v_pk_add_f32 v[74:75], v[74:75], 1.0 op_sel_hi:[1,0]
  v_pk_add_f32 v[76:77], v[76:77], 1.0 op_sel_hi:[1,0]
  v_pk_add_f32 v[78:79], v[78:79], 1.0 op_sel_hi:[1,0]
  v_pk_add_f32 v[80:81], v[80:81], 1.0 op_sel_hi:[1,0]
  v_pk_add_f32 v[82:83], v[82:83], 1.0 op_sel_hi:[1,0]
  v_pk_add_f32 v[84:85], v[84:85], 1.0 op_sel_hi:[1,0]
  v_pk_add_f32 v[86:87], v[86:87], 1.0 op_sel_hi:[1,0]
  v_pk_fma_f32 v[88:89], v[56:57], v[56:57], v[88:89]
  v_pk_fma_f32 v[90:91], v[58:59], v[58:59], v[90:91]
  v_pk_fma_f32 v[92:93], v[60:61], v[60:61], v[92:93]
  v_pk_fma_f32 v[94:95], v[62:63], v[62:63], v[94:95]
  v_pk_fma_f32 v[96:97], v[64:65], v[64:65], v[96:97]
  v_pk_fma_f32 v[98:99], v[66:67], v[66:67], v[98:99]
  v_pk_fma_f32 v[100:101], v[68:69], v[68:69], v[100:101]
  v_pk_fma_f32 v[102:103], v[70:71], v[70:71], v[102:103]
  v_cvt_pk_bf16_f32 v104, v56, v57
  v_cvt_pk_bf16_f32 v105, v58, v59
  v_cvt_pk_bf16_f32 v106, v60, v61
  v_cvt_pk_bf16_f32 v107, v62, v63
  v_cvt_pk_bf16_f32 v108, v64, v65
  v_cvt_pk_bf16_f32 v109, v66, v67
  v_cvt_pk_bf16_f32 v110, v68, v69
  v_cvt_pk_bf16_f32 v111, v70, v71
  v_pk_fma_f32 v[56:57], v[24:25], v[24:25], s[50:51] neg_lo:[1,0,0] neg_hi:[1,0,0]
  v_pk_fma_f32 v[58:59], v[26:27], v[26:27], s[50:51] neg_lo:[1,0,0] neg_hi:[1,0,0]
  v_pk_fma_f32 v[60:61], v[28:29], v[28:29], s[50:51] neg_lo:[1,0,0] neg_hi:[1,0,0]
  v_pk_fma_f32 v[62:63], v[30:31], v[30:31], s[50:51] neg_lo:[1,0,0] neg_hi:[1,0,0]
  v_pk_fma_f32 v[64:65], v[32:33], v[32:33], s[50:51] neg_lo:[1,0,0] neg_hi:[1,0,0]
  v_pk_fma_f32 v[66:67], v[34:35], v[34:35], s[50:51] neg_lo:[1,0,0] neg_hi:[1,0,0]
  v_pk_fma_f32 v[68:69], v[36:37], v[36:37], s[50:51] neg_lo:[1,0,0] neg_hi:[1,0,0]
  v_pk_fma_f32 v[70:71], v[38:39], v[38:39], s[50:51] neg_lo:[1,0,0] neg_hi:[1,0,0]
  v_pk_mul_f32 v[56:57], v[56:57], v[24:25]
  v_pk_mul_f32 v[58:59], v[58:59], v[26:27]
  v_pk_mul_f32 v[60:61], v[60:61], v[28:29]
  v_pk_mul_f32 v[62:63], v[62:63], v[30:31]
  v_pk_mul_f32 v[64:65], v[64:65], v[32:33]
  v_pk_mul_f32 v[66:67], v[66:67], v[34:35]
  v_pk_mul_f32 v[68:69], v[68:69], v[36:37]
  v_pk_mul_f32 v[70:71], v[70:71], v[38:39]
  s_waitcnt lgkmcnt(2)
  v_mfma_f32_32x32x16_bf16 v[40:55], a[240:243], a[224:227], 0
  ds_read_b128 a[224:227], v2 offset:16384
  v_exp_f32 v56, v56
  v_rcp_f32 v72, v72
  v_mfma_f32_32x32x16_bf16 v[40:55], a[244:247], a[228:231], v[40:55]
  s_waitcnt lgkmcnt(1)
  ds_read_b128 a[228:231], v2 offset:17408
  v_exp_f32 v57, v57
  v_rcp_f32 v73, v73
  v_exp_f32 v58, v58
  v_mfma_f32_32x32x16_bf16 v[40:55], a[248:251], a[232:235], v[40:55]
  ds_read_b128 a[232:235], v2 offset:18432
  v_rcp_f32 v74, v74
  v_exp_f32 v59, v59
  v_rcp_f32 v75, v75
  v_mfma_f32_32x32x16_bf16 v[40:55], a[252:255], a[236:239], v[40:55]
  s_waitcnt lgkmcnt(1)
  ds_read_b128 a[236:239], v2 offset:19456
  v_exp_f32 v60, v60
  v_rcp_f32 v76, v76
  v_exp_f32 v61, v61
  v_mfma_f32_32x32x16_bf16 v[40:55], v[112:115], a[224:227], v[40:55]
  ds_read_b128 a[224:227], v2 offset:20480
  v_rcp_f32 v77, v77
  v_exp_f32 v62, v62
  v_rcp_f32 v78, v78
  v_mfma_f32_32x32x16_bf16 v[40:55], v[116:119], a[228:231], v[40:55]
  s_waitcnt lgkmcnt(1)
  ds_read_b128 a[228:231], v2 offset:21504
  v_exp_f32 v63, v63
  v_rcp_f32 v79, v79
  v_exp_f32 v64, v64
  v_mfma_f32_32x32x16_bf16 v[40:55], v[120:123], a[232:235], v[40:55]
  ds_read_b128 a[232:235], v2 offset:22528
  v_rcp_f32 v80, v80
  v_exp_f32 v65, v65
  v_rcp_f32 v81, v81
  v_mfma_f32_32x32x16_bf16 v[40:55], v[124:127], a[236:239], v[40:55]
  s_waitcnt lgkmcnt(1)
  ds_read_b128 a[236:239], v2 offset:23552
  v_exp_f32 v66, v66
  v_rcp_f32 v82, v82
  v_exp_f32 v67, v67
  v_mfma_f32_32x32x16_bf16 v[40:55], v[128:131], a[224:227], v[40:55]
  ds_read_b128 a[224:227], v2 offset:24576
  v_rcp_f32 v83, v83
  v_exp_f32 v68, v68
  v_rcp_f32 v84, v84
  v_mfma_f32_32x32x16_bf16 v[40:55], v[132:135], a[228:231], v[40:55]
  s_waitcnt lgkmcnt(1)
  ds_read_b128 a[228:231], v2 offset:25600
  v_exp_f32 v69, v69
  v_rcp_f32 v85, v85
  v_exp_f32 v70, v70
  v_mfma_f32_32x32x16_bf16 v[40:55], v[136:139], a[232:235], v[40:55]
  ds_read_b128 a[232:235], v2 offset:26624
  v_rcp_f32 v86, v86
  v_exp_f32 v71, v71
  v_rcp_f32 v87, v87
  v_mfma_f32_32x32x16_bf16 v[40:55], v[140:143], a[236:239], v[40:55]
  ds_read_b128 a[236:239], v2 offset:27648
  v_accvgpr_write_b32 a64, v104
  v_accvgpr_write_b32 a65, v105
  v_accvgpr_write_b32 a66, v106
  v_accvgpr_write_b32 a67, v107
  v_accvgpr_write_b32 a68, v108
  v_accvgpr_write_b32 a69, v109
  v_accvgpr_write_b32 a70, v110
  v_accvgpr_write_b32 a71, v111
  v_pk_mul_f32 v[72:73], v[72:73], v[8:9]
  v_pk_mul_f32 v[74:75], v[74:75], v[10:11]
  v_pk_mul_f32 v[76:77], v[76:77], v[12:13]
  v_pk_mul_f32 v[78:79], v[78:79], v[14:15]
  v_pk_mul_f32 v[80:81], v[80:81], v[16:17]
  v_pk_mul_f32 v[82:83], v[82:83], v[18:19]
  v_pk_mul_f32 v[84:85], v[84:85], v[20:21]
  v_pk_mul_f32 v[86:87], v[86:87], v[22:23]
  v_pk_add_f32 v[56:57], v[56:57], 1.0 op_sel_hi:[1,0]
  v_pk_add_f32 v[58:59], v[58:59], 1.0 op_sel_hi:[1,0]
  v_pk_add_f32 v[60:61], v[60:61], 1.0 op_sel_hi:[1,0]
  v_pk_add_f32 v[62:63], v[62:63], 1.0 op_sel_hi:[1,0]
  v_pk_add_f32 v[64:65], v[64:65], 1.0 op_sel_hi:[1,0]
  v_pk_add_f32 v[66:67], v[66:67], 1.0 op_sel_hi:[1,0]
  v_pk_add_f32 v[68:69], v[68:69], 1.0 op_sel_hi:[1,0]
  v_pk_add_f32 v[70:71], v[70:71], 1.0 op_sel_hi:[1,0]
  v_pk_fma_f32 v[88:89], v[72:73], v[72:73], v[88:89]
  v_pk_fma_f32 v[90:91], v[74:75], v[74:75], v[90:91]
  v_pk_fma_f32 v[92:93], v[76:77], v[76:77], v[92:93]
  v_pk_fma_f32 v[94:95], v[78:79], v[78:79], v[94:95]
  v_pk_fma_f32 v[96:97], v[80:81], v[80:81], v[96:97]
  v_pk_fma_f32 v[98:99], v[82:83], v[82:83], v[98:99]
  v_pk_fma_f32 v[100:101], v[84:85], v[84:85], v[100:101]
  v_pk_fma_f32 v[102:103], v[86:87], v[86:87], v[102:103]
  v_cvt_pk_bf16_f32 v104, v72, v73
  v_cvt_pk_bf16_f32 v105, v74, v75
  v_cvt_pk_bf16_f32 v106, v76, v77
  v_cvt_pk_bf16_f32 v107, v78, v79
  v_cvt_pk_bf16_f32 v108, v80, v81
  v_cvt_pk_bf16_f32 v109, v82, v83
  v_cvt_pk_bf16_f32 v110, v84, v85
  v_cvt_pk_bf16_f32 v111, v86, v87
  v_pk_fma_f32 v[72:73], v[40:41], v[40:41], s[50:51] neg_lo:[1,0,0] neg_hi:[1,0,0]
  v_pk_fma_f32 v[74:75], v[42:43], v[42:43], s[50:51] neg_lo:[1,0,0] neg_hi:[1,0,0]
  v_pk_fma_f32 v[76:77], v[44:45], v[44:45], s[50:51] neg_lo:[1,0,0] neg_hi:[1,0,0]
  v_pk_fma_f32 v[78:79], v[46:47], v[46:47], s[50:51] neg_lo:[1,0,0] neg_hi:[1,0,0]
  v_pk_fma_f32 v[80:81], v[48:49], v[48:49], s[50:51] neg_lo:[1,0,0] neg_hi:[1,0,0]
  v_pk_fma_f32 v[82:83], v[50:51], v[50:51], s[50:51] neg_lo:[1,0,0] neg_hi:[1,0,0]
  v_pk_fma_f32 v[84:85], v[52:53], v[52:53], s[50:51] neg_lo:[1,0,0] neg_hi:[1,0,0]
  v_pk_fma_f32 v[86:87], v[54:55], v[54:55], s[50:51] neg_lo:[1,0,0] neg_hi:[1,0,0]
  v_pk_mul_f32 v[72:73], v[72:73], v[40:41]
  v_pk_mul_f32 v[74:75], v[74:75], v[42:43]
  v_pk_mul_f32 v[76:77], v[76:77], v[44:45]
  v_pk_mul_f32 v[78:79], v[78:79], v[46:47]
  v_pk_mul_f32 v[80:81], v[80:81], v[48:49]
  v_pk_mul_f32 v[82:83], v[82:83], v[50:51]
  v_pk_mul_f32 v[84:85], v[84:85], v[52:53]
  v_pk_mul_f32 v[86:87], v[86:87], v[54:55]
  s_waitcnt lgkmcnt(2)
  v_mfma_f32_32x32x16_bf16 v[8:23], a[240:243], a[224:227], 0
  ds_read_b128 a[224:227], v2 offset:28672
  v_exp_f32 v72, v72
  v_rcp_f32 v56, v56
  v_mfma_f32_32x32x16_bf16 v[8:23], a[244:247], a[228:231], v[8:23]
  s_waitcnt lgkmcnt(1)
  ds_read_b128 a[228:231], v2 offset:29696
  v_exp_f32 v73, v73
  v_rcp_f32 v57, v57
  v_exp_f32 v74, v74
  v_mfma_f32_32x32x16_bf16 v[8:23], a[248:251], a[232:235], v[8:23]
  ds_read_b128 a[232:235], v2 offset:30720
  v_rcp_f32 v58, v58
  v_exp_f32 v75, v75
  v_rcp_f32 v59, v59
  v_mfma_f32_32x32x16_bf16 v[8:23], a[252:255], a[236:239], v[8:23]
  s_waitcnt lgkmcnt(1)
  ds_read_b128 a[236:239], v2 offset:31744
  v_exp_f32 v76, v76
  v_rcp_f32 v60, v60
  v_exp_f32 v77, v77
  v_mfma_f32_32x32x16_bf16 v[8:23], v[112:115], a[224:227], v[8:23]
  ds_read_b128 a[224:227], v2 offset:32768
  v_rcp_f32 v61, v61
  v_exp_f32 v78, v78
  v_rcp_f32 v62, v62
  v_mfma_f32_32x32x16_bf16 v[8:23], v[116:119], a[228:231], v[8:23]
  s_waitcnt lgkmcnt(1)
  ds_read_b128 a[228:231], v2 offset:33792
  v_exp_f32 v79, v79
  v_rcp_f32 v63, v63
  v_exp_f32 v80, v80
  v_mfma_f32_32x32x16_bf16 v[8:23], v[120:123], a[232:235], v[8:23]
  ds_read_b128 a[232:235], v2 offset:34816
  v_rcp_f32 v64, v64
  v_exp_f32 v81, v81
  v_rcp_f32 v65, v65
  v_mfma_f32_32x32x16_bf16 v[8:23], v[124:127], a[236:239], v[8:23]
  s_waitcnt lgkmcnt(1)
  ds_read_b128 a[236:239], v2 offset:35840
  v_exp_f32 v82, v82
  v_rcp_f32 v66, v66
  v_exp_f32 v83, v83
  v_mfma_f32_32x32x16_bf16 v[8:23], v[128:131], a[224:227], v[8:23]
  ds_read_b128 a[224:227], v2 offset:36864
  v_rcp_f32 v67, v67
  v_exp_f32 v84, v84
  v_rcp_f32 v68, v68
  v_mfma_f32_32x32x16_bf16 v[8:23], v[132:135], a[228:231], v[8:23]
  s_waitcnt lgkmcnt(1)
  ds_read_b128 a[228:231], v2 offset:37888
  v_exp_f32 v85, v85
  v_rcp_f32 v69, v69
  v_exp_f32 v86, v86
  v_mfma_f32_32x32x16_bf16 v[8:23], v[136:139], a[232:235], v[8:23]
  ds_read_b128 a[232:235], v2 offset:38912
  v_rcp_f32 v70, v70
  v_exp_f32 v87, v87
  v_rcp_f32 v71, v71
  v_mfma_f32_32x32x16_bf16 v[8:23], v[140:143], a[236:239], v[8:23]
  ds_read_b128 a[236:239], v2 offset:39936
  v_accvgpr_write_b32 a72, v104
  v_accvgpr_write_b32 a73, v105
  v_accvgpr_write_b32 a74, v106
  v_accvgpr_write_b32 a75, v107
  v_accvgpr_write_b32 a76, v108
  v_accvgpr_write_b32 a77, v109
  v_accvgpr_write_b32 a78, v110
  v_accvgpr_write_b32 a79, v111
  v_pk_mul_f32 v[56:57], v[56:57], v[24:25]
  v_pk_mul_f32 v[58:59], v[58:59], v[26:27]
  v_pk_mul_f32 v[60:61], v[60:61], v[28:29]
  v_pk_mul_f32 v[62:63], v[62:63], v[30:31]
  v_pk_mul_f32 v[64:65], v[64:65], v[32:33]
  v_pk_mul_f32 v[66:67], v[66:67], v[34:35]
  v_pk_mul_f32 v[68:69], v[68:69], v[36:37]
  v_pk_mul_f32 v[70:71], v[70:71], v[38:39]
  v_pk_add_f32 v[72:73], v[72:73], 1.0 op_sel_hi:[1,0]
  v_pk_add_f32 v[74:75], v[74:75], 1.0 op_sel_hi:[1,0]
  v_pk_add_f32 v[76:77], v[76:77], 1.0 op_sel_hi:[1,0]
  v_pk_add_f32 v[78:79], v[78:79], 1.0 op_sel_hi:[1,0]
  v_pk_add_f32 v[80:81], v[80:81], 1.0 op_sel_hi:[1,0]
  v_pk_add_f32 v[82:83], v[82:83], 1.0 op_sel_hi:[1,0]
  v_pk_add_f32 v[84:85], v[84:85], 1.0 op_sel_hi:[1,0]
  v_pk_add_f32 v[86:87], v[86:87], 1.0 op_sel_hi:[1,0]
  v_pk_fma_f32 v[88:89], v[56:57], v[56:57], v[88:89]
  v_pk_fma_f32 v[90:91], v[58:59], v[58:59], v[90:91]
  v_pk_fma_f32 v[92:93], v[60:61], v[60:61], v[92:93]
  v_pk_fma_f32 v[94:95], v[62:63], v[62:63], v[94:95]
  v_pk_fma_f32 v[96:97], v[64:65], v[64:65], v[96:97]
  v_pk_fma_f32 v[98:99], v[66:67], v[66:67], v[98:99]
  v_pk_fma_f32 v[100:101], v[68:69], v[68:69], v[100:101]
  v_pk_fma_f32 v[102:103], v[70:71], v[70:71], v[102:103]
  v_cvt_pk_bf16_f32 v104, v56, v57
  v_cvt_pk_bf16_f32 v105, v58, v59
  v_cvt_pk_bf16_f32 v106, v60, v61
  v_cvt_pk_bf16_f32 v107, v62, v63
  v_cvt_pk_bf16_f32 v108, v64, v65
  v_cvt_pk_bf16_f32 v109, v66, v67
  v_cvt_pk_bf16_f32 v110, v68, v69
  v_cvt_pk_bf16_f32 v111, v70, v71
  v_pk_fma_f32 v[56:57], v[8:9], v[8:9], s[50:51] neg_lo:[1,0,0] neg_hi:[1,0,0]
  v_pk_fma_f32 v[58:59], v[10:11], v[10:11], s[50:51] neg_lo:[1,0,0] neg_hi:[1,0,0]
  v_pk_fma_f32 v[60:61], v[12:13], v[12:13], s[50:51] neg_lo:[1,0,0] neg_hi:[1,0,0]
  v_pk_fma_f32 v[62:63], v[14:15], v[14:15], s[50:51] neg_lo:[1,0,0] neg_hi:[1,0,0]
  v_pk_fma_f32 v[64:65], v[16:17], v[16:17], s[50:51] neg_lo:[1,0,0] neg_hi:[1,0,0]
  v_pk_fma_f32 v[66:67], v[18:19], v[18:19], s[50:51] neg_lo:[1,0,0] neg_hi:[1,0,0]
  v_pk_fma_f32 v[68:69], v[20:21], v[20:21], s[50:51] neg_lo:[1,0,0] neg_hi:[1,0,0]
  v_pk_fma_f32 v[70:71], v[22:23], v[22:23], s[50:51] neg_lo:[1,0,0] neg_hi:[1,0,0]
  v_pk_mul_f32 v[56:57], v[56:57], v[8:9]
  v_pk_mul_f32 v[58:59], v[58:59], v[10:11]
  v_pk_mul_f32 v[60:61], v[60:61], v[12:13]
  v_pk_mul_f32 v[62:63], v[62:63], v[14:15]
  v_pk_mul_f32 v[64:65], v[64:65], v[16:17]
  v_pk_mul_f32 v[66:67], v[66:67], v[18:19]
  v_pk_mul_f32 v[68:69], v[68:69], v[20:21]
  v_pk_mul_f32 v[70:71], v[70:71], v[22:23]
  s_waitcnt vmcnt(0)
  s_waitcnt lgkmcnt(2)
  v_mfma_f32_32x32x16_bf16 v[24:39], a[240:243], a[224:227], 0
  ds_read_b128 a[224:227], v2 offset:40960
  ds_read_b64_tr_b16 a[240:241], v3 offset:0
  ds_read_b64_tr_b16 a[242:243], v3 offset:1024
  v_exp_f32 v56, v56
  v_rcp_f32 v72, v72
  v_mfma_f32_32x32x16_bf16 v[24:39], a[244:247], a[228:231], v[24:39]
  s_waitcnt lgkmcnt(3)
  ds_read_b128 a[228:231], v2 offset:41984
  ds_read_b64_tr_b16 a[244:245], v3 offset:512
  ds_read_b64_tr_b16 a[246:247], v3 offset:1536
  v_exp_f32 v57, v57
  v_rcp_f32 v73, v73
  v_exp_f32 v58, v58
  v_mfma_f32_32x32x16_bf16 v[24:39], a[248:251], a[232:235], v[24:39]
  ds_read_b128 a[232:235], v2 offset:43008
  ds_read_b64_tr_b16 a[248:249], v3 offset:2048
  ds_read_b64_tr_b16 a[250:251], v3 offset:3072
  v_rcp_f32 v74, v74
  v_exp_f32 v59, v59
  v_rcp_f32 v75, v75
  v_mfma_f32_32x32x16_bf16 v[24:39], a[252:255], a[236:239], v[24:39]
  s_waitcnt lgkmcnt(5)
  ds_read_b128 a[236:239], v2 offset:44032
  ds_read_b64_tr_b16 a[252:253], v3 offset:2560
  ds_read_b64_tr_b16 a[254:255], v3 offset:3584
  v_exp_f32 v60, v60
  v_rcp_f32 v76, v76
  v_exp_f32 v61, v61
  v_mfma_f32_32x32x16_bf16 v[24:39], v[112:115], a[224:227], v[24:39]
  ds_read_b128 a[224:227], v2 offset:45056
  ds_read_b64_tr_b16 v[112:113], v3 offset:4096
  ds_read_b64_tr_b16 v[114:115], v3 offset:5120
  v_rcp_f32 v77, v77
  v_exp_f32 v62, v62
  v_rcp_f32 v78, v78
  v_mfma_f32_32x32x16_bf16 v[24:39], v[116:119], a[228:231], v[24:39]
  s_waitcnt lgkmcnt(5)
  ds_read_b128 a[228:231], v2 offset:46080
  ds_read_b64_tr_b16 v[116:117], v3 offset:4608
  ds_read_b64_tr_b16 v[118:119], v3 offset:5632
  v_exp_f32 v63, v63
  v_rcp_f32 v79, v79
  v_exp_f32 v64, v64
  v_mfma_f32_32x32x16_bf16 v[24:39], v[120:123], a[232:235], v[24:39]
  ds_read_b128 a[232:235], v2 offset:47104
  ds_read_b64_tr_b16 v[120:121], v3 offset:6144
  ds_read_b64_tr_b16 v[122:123], v3 offset:7168
  v_rcp_f32 v80, v80
  v_exp_f32 v65, v65
  v_rcp_f32 v81, v81
  v_mfma_f32_32x32x16_bf16 v[24:39], v[124:127], a[236:239], v[24:39]
  s_waitcnt lgkmcnt(5)
  ds_read_b128 a[236:239], v2 offset:48128
  ds_read_b64_tr_b16 v[124:125], v3 offset:6656
  ds_read_b64_tr_b16 v[126:127], v3 offset:7680
  v_exp_f32 v66, v66
  v_rcp_f32 v82, v82
  v_exp_f32 v67, v67
  v_mfma_f32_32x32x16_bf16 v[24:39], v[128:131], a[224:227], v[24:39]
  ds_read_b128 a[224:227], v1 offset:0
  ds_read_b64_tr_b16 v[128:129], v3 offset:8192
  ds_read_b64_tr_b16 v[130:131], v3 offset:9216
  v_rcp_f32 v83, v83
  v_exp_f32 v68, v68
  v_rcp_f32 v84, v84
  v_mfma_f32_32x32x16_bf16 v[24:39], v[132:135], a[228:231], v[24:39]
  s_waitcnt lgkmcnt(5)
  ds_read_b128 a[228:231], v1 offset:1024
  ds_read_b64_tr_b16 v[132:133], v3 offset:8704
  ds_read_b64_tr_b16 v[134:135], v3 offset:9728
  v_exp_f32 v69, v69
  v_rcp_f32 v85, v85
  v_exp_f32 v70, v70
  v_mfma_f32_32x32x16_bf16 v[24:39], v[136:139], a[232:235], v[24:39]
  ds_read_b128 a[232:235], v1 offset:2048
  ds_read_b64_tr_b16 v[136:137], v3 offset:10240
  ds_read_b64_tr_b16 v[138:139], v3 offset:11264
  v_rcp_f32 v86, v86
  v_exp_f32 v71, v71
  v_rcp_f32_e64 v87, v87
  v_mfma_f32_32x32x16_bf16 v[24:39], v[140:143], a[236:239], v[24:39]
  ds_read_b128 a[236:239], v1 offset:3072
  ds_read_b64_tr_b16 v[140:141], v3 offset:10752
  ds_read_b64_tr_b16 v[142:143], v3 offset:11776
  v_accvgpr_write_b32 a80, v104
  v_accvgpr_write_b32 a81, v105
  v_accvgpr_write_b32 a82, v106
  v_accvgpr_write_b32 a83, v107
  v_accvgpr_write_b32 a84, v108
  v_accvgpr_write_b32 a85, v109
  v_accvgpr_write_b32 a86, v110
  v_accvgpr_write_b32 a87, v111
  v_pk_mul_f32 v[72:73], v[72:73], v[40:41]
  v_pk_mul_f32 v[74:75], v[74:75], v[42:43]
  v_pk_mul_f32 v[76:77], v[76:77], v[44:45]
  v_pk_mul_f32 v[78:79], v[78:79], v[46:47]
  v_pk_mul_f32 v[80:81], v[80:81], v[48:49]
  v_pk_mul_f32 v[82:83], v[82:83], v[50:51]
  v_pk_mul_f32 v[84:85], v[84:85], v[52:53]
  v_pk_mul_f32 v[86:87], v[86:87], v[54:55]
  v_pk_add_f32 v[56:57], v[56:57], 1.0 op_sel_hi:[1,0]
  v_pk_add_f32 v[58:59], v[58:59], 1.0 op_sel_hi:[1,0]
  v_pk_add_f32 v[60:61], v[60:61], 1.0 op_sel_hi:[1,0]
  v_pk_add_f32 v[62:63], v[62:63], 1.0 op_sel_hi:[1,0]
  v_pk_add_f32 v[64:65], v[64:65], 1.0 op_sel_hi:[1,0]
  v_pk_add_f32 v[66:67], v[66:67], 1.0 op_sel_hi:[1,0]
  v_pk_add_f32 v[68:69], v[68:69], 1.0 op_sel_hi:[1,0]
  v_pk_add_f32 v[70:71], v[70:71], 1.0 op_sel_hi:[1,0]
  v_pk_fma_f32 v[88:89], v[72:73], v[72:73], v[88:89]
  v_pk_fma_f32 v[90:91], v[74:75], v[74:75], v[90:91]
  v_pk_fma_f32 v[92:93], v[76:77], v[76:77], v[92:93]
  v_pk_fma_f32 v[94:95], v[78:79], v[78:79], v[94:95]
  v_pk_fma_f32 v[96:97], v[80:81], v[80:81], v[96:97]
  v_pk_fma_f32 v[98:99], v[82:83], v[82:83], v[98:99]
  v_pk_fma_f32 v[100:101], v[84:85], v[84:85], v[100:101]
  v_pk_fma_f32 v[102:103], v[86:87], v[86:87], v[102:103]
  v_cvt_pk_bf16_f32 v104, v72, v73
  v_cvt_pk_bf16_f32 v105, v74, v75
  v_cvt_pk_bf16_f32 v106, v76, v77
  v_cvt_pk_bf16_f32 v107, v78, v79
  v_cvt_pk_bf16_f32 v108, v80, v81
  v_cvt_pk_bf16_f32 v109, v82, v83
  v_cvt_pk_bf16_f32 v110, v84, v85
  v_cvt_pk_bf16_f32 v111, v86, v87
  v_pk_fma_f32 v[72:73], v[24:25], v[24:25], s[50:51] neg_lo:[1,0,0] neg_hi:[1,0,0]
  v_pk_fma_f32 v[74:75], v[26:27], v[26:27], s[50:51] neg_lo:[1,0,0] neg_hi:[1,0,0]
  v_pk_fma_f32 v[76:77], v[28:29], v[28:29], s[50:51] neg_lo:[1,0,0] neg_hi:[1,0,0]
  v_pk_fma_f32 v[78:79], v[30:31], v[30:31], s[50:51] neg_lo:[1,0,0] neg_hi:[1,0,0]
  v_pk_fma_f32 v[80:81], v[32:33], v[32:33], s[50:51] neg_lo:[1,0,0] neg_hi:[1,0,0]
  v_pk_fma_f32 v[82:83], v[34:35], v[34:35], s[50:51] neg_lo:[1,0,0] neg_hi:[1,0,0]
  v_pk_fma_f32 v[84:85], v[36:37], v[36:37], s[50:51] neg_lo:[1,0,0] neg_hi:[1,0,0]
  v_pk_fma_f32 v[86:87], v[38:39], v[38:39], s[50:51] neg_lo:[1,0,0] neg_hi:[1,0,0]
  v_pk_mul_f32 v[72:73], v[72:73], v[24:25]
  v_pk_mul_f32 v[74:75], v[74:75], v[26:27]
  v_pk_mul_f32 v[76:77], v[76:77], v[28:29]
  v_pk_mul_f32 v[78:79], v[78:79], v[30:31]
  v_pk_mul_f32 v[80:81], v[80:81], v[32:33]
  v_pk_mul_f32 v[82:83], v[82:83], v[34:35]
  v_pk_mul_f32 v[84:85], v[84:85], v[36:37]
  v_pk_mul_f32 v[86:87], v[86:87], v[38:39]
  s_waitcnt lgkmcnt(8)
  v_mfma_f32_32x32x16_bf16 v[40:55], a[240:243], a[224:227], 0
  ds_read_b128 a[224:227], v1 offset:4096
  v_exp_f32 v72, v72
  v_rcp_f32 v56, v56
  v_mfma_f32_32x32x16_bf16 v[40:55], a[244:247], a[228:231], v[40:55]
  s_waitcnt lgkmcnt(3)
  ds_read_b128 a[228:231], v1 offset:5120
  v_exp_f32 v73, v73
  v_rcp_f32 v57, v57
  v_exp_f32 v74, v74
  v_mfma_f32_32x32x16_bf16 v[40:55], a[248:251], a[232:235], v[40:55]
  ds_read_b128 a[232:235], v1 offset:6144
  v_rcp_f32 v58, v58
  v_exp_f32 v75, v75
  v_rcp_f32 v59, v59
  v_mfma_f32_32x32x16_bf16 v[40:55], a[252:255], a[236:239], v[40:55]
  s_waitcnt lgkmcnt(1)
  ds_read_b128 a[236:239], v1 offset:7168
  v_exp_f32 v76, v76
  v_rcp_f32 v60, v60
  v_exp_f32 v77, v77
  v_mfma_f32_32x32x16_bf16 v[40:55], v[112:115], a[224:227], v[40:55]
  ds_read_b128 a[224:227], v1 offset:8192
  v_rcp_f32 v61, v61
  v_exp_f32 v78, v78
  v_rcp_f32 v62, v62
  v_mfma_f32_32x32x16_bf16 v[40:55], v[116:119], a[228:231], v[40:55]
  s_waitcnt lgkmcnt(1)
  ds_read_b128 a[228:231], v1 offset:9216
  v_exp_f32 v79, v79
  v_rcp_f32 v63, v63
  v_exp_f32 v80, v80
  v_mfma_f32_32x32x16_bf16 v[40:55], v[120:123], a[232:235], v[40:55]
  ds_read_b128 a[232:235], v1 offset:10240
  v_rcp_f32 v64, v64
  v_exp_f32 v81, v81
  v_rcp_f32 v65, v65
  v_mfma_f32_32x32x16_bf16 v[40:55], v[124:127], a[236:239], v[40:55]
  s_waitcnt lgkmcnt(1)
  ds_read_b128 a[236:239], v1 offset:11264
  v_exp_f32 v82, v82
  v_rcp_f32 v66, v66
  v_exp_f32 v83, v83
  v_mfma_f32_32x32x16_bf16 v[40:55], v[128:131], a[224:227], v[40:55]
  ds_read_b128 a[224:227], v1 offset:12288
  v_rcp_f32 v67, v67
  v_exp_f32 v84, v84
  v_rcp_f32 v68, v68
  v_mfma_f32_32x32x16_bf16 v[40:55], v[132:135], a[228:231], v[40:55]
  s_waitcnt lgkmcnt(1)
  ds_read_b128 a[228:231], v1 offset:13312
  v_exp_f32 v85, v85
  v_rcp_f32 v69, v69
  v_exp_f32 v86, v86
  v_mfma_f32_32x32x16_bf16 v[40:55], v[136:139], a[232:235], v[40:55]
  ds_read_b128 a[232:235], v1 offset:14336
  v_rcp_f32 v70, v70
  v_exp_f32 v87, v87
  v_rcp_f32 v71, v71
  v_mfma_f32_32x32x16_bf16 v[40:55], v[140:143], a[236:239], v[40:55]
  ds_read_b128 a[236:239], v1 offset:15360
  v_accvgpr_write_b32 a88, v104
  v_accvgpr_write_b32 a89, v105
  v_accvgpr_write_b32 a90, v106
  v_accvgpr_write_b32 a91, v107
  v_accvgpr_write_b32 a92, v108
  v_accvgpr_write_b32 a93, v109
  v_accvgpr_write_b32 a94, v110
  v_accvgpr_write_b32 a95, v111
  v_pk_mul_f32 v[56:57], v[56:57], v[8:9]
  v_pk_mul_f32 v[58:59], v[58:59], v[10:11]
  v_pk_mul_f32 v[60:61], v[60:61], v[12:13]
  v_pk_mul_f32 v[62:63], v[62:63], v[14:15]
  v_pk_mul_f32 v[64:65], v[64:65], v[16:17]
  v_pk_mul_f32 v[66:67], v[66:67], v[18:19]
  v_pk_mul_f32 v[68:69], v[68:69], v[20:21]
  v_pk_mul_f32 v[70:71], v[70:71], v[22:23]
  v_pk_add_f32 v[72:73], v[72:73], 1.0 op_sel_hi:[1,0]
  v_pk_add_f32 v[74:75], v[74:75], 1.0 op_sel_hi:[1,0]
  v_pk_add_f32 v[76:77], v[76:77], 1.0 op_sel_hi:[1,0]
  v_pk_add_f32 v[78:79], v[78:79], 1.0 op_sel_hi:[1,0]
  v_pk_add_f32 v[80:81], v[80:81], 1.0 op_sel_hi:[1,0]
  v_pk_add_f32 v[82:83], v[82:83], 1.0 op_sel_hi:[1,0]
  v_pk_add_f32 v[84:85], v[84:85], 1.0 op_sel_hi:[1,0]
  v_pk_add_f32 v[86:87], v[86:87], 1.0 op_sel_hi:[1,0]
  v_pk_fma_f32 v[88:89], v[56:57], v[56:57], v[88:89]
  v_pk_fma_f32 v[90:91], v[58:59], v[58:59], v[90:91]
  v_pk_fma_f32 v[92:93], v[60:61], v[60:61], v[92:93]
  v_pk_fma_f32 v[94:95], v[62:63], v[62:63], v[94:95]
  v_pk_fma_f32 v[96:97], v[64:65], v[64:65], v[96:97]
  v_pk_fma_f32 v[98:99], v[66:67], v[66:67], v[98:99]
  v_pk_fma_f32 v[100:101], v[68:69], v[68:69], v[100:101]
  v_pk_fma_f32 v[102:103], v[70:71], v[70:71], v[102:103]
  v_cvt_pk_bf16_f32 v104, v56, v57
  v_cvt_pk_bf16_f32 v105, v58, v59
  v_cvt_pk_bf16_f32 v106, v60, v61
  v_cvt_pk_bf16_f32 v107, v62, v63
  v_cvt_pk_bf16_f32 v108, v64, v65
  v_cvt_pk_bf16_f32 v109, v66, v67
  v_cvt_pk_bf16_f32 v110, v68, v69
  v_cvt_pk_bf16_f32 v111, v70, v71
  v_pk_fma_f32 v[56:57], v[40:41], v[40:41], s[50:51] neg_lo:[1,0,0] neg_hi:[1,0,0]
  v_pk_fma_f32 v[58:59], v[42:43], v[42:43], s[50:51] neg_lo:[1,0,0] neg_hi:[1,0,0]
  v_pk_fma_f32 v[60:61], v[44:45], v[44:45], s[50:51] neg_lo:[1,0,0] neg_hi:[1,0,0]
  v_pk_fma_f32 v[62:63], v[46:47], v[46:47], s[50:51] neg_lo:[1,0,0] neg_hi:[1,0,0]
  v_pk_fma_f32 v[64:65], v[48:49], v[48:49], s[50:51] neg_lo:[1,0,0] neg_hi:[1,0,0]
  v_pk_fma_f32 v[66:67], v[50:51], v[50:51], s[50:51] neg_lo:[1,0,0] neg_hi:[1,0,0]
  v_pk_fma_f32 v[68:69], v[52:53], v[52:53], s[50:51] neg_lo:[1,0,0] neg_hi:[1,0,0]
  v_pk_fma_f32 v[70:71], v[54:55], v[54:55], s[50:51] neg_lo:[1,0,0] neg_hi:[1,0,0]
  v_pk_mul_f32 v[56:57], v[56:57], v[40:41]
  v_pk_mul_f32 v[58:59], v[58:59], v[42:43]
  v_pk_mul_f32 v[60:61], v[60:61], v[44:45]
  v_pk_mul_f32 v[62:63], v[62:63], v[46:47]
  v_pk_mul_f32 v[64:65], v[64:65], v[48:49]
  v_pk_mul_f32 v[66:67], v[66:67], v[50:51]
  v_pk_mul_f32 v[68:69], v[68:69], v[52:53]
  v_pk_mul_f32 v[70:71], v[70:71], v[54:55]
  s_waitcnt lgkmcnt(2)
  v_mfma_f32_32x32x16_bf16 v[8:23], a[240:243], a[224:227], 0
  ds_read_b128 a[224:227], v1 offset:16384
  v_exp_f32 v56, v56
  v_rcp_f32 v72, v72
  v_add_u32 v4, 64, v4
  s_add_u32 m0, s56, 0
  v_mfma_f32_32x32x16_bf16 v[8:23], a[244:247], a[228:231], v[8:23]
  s_waitcnt lgkmcnt(1)
  buffer_load_dwordx4 v4, s[28:31], s72 offen offset:0 lds
  ds_read_b128 a[228:231], v1 offset:17408
  v_exp_f32 v57, v57
  v_rcp_f32 v73, v73
  v_exp_f32 v58, v58
  v_mfma_f32_32x32x16_bf16 v[8:23], a[248:251], a[232:235], v[8:23]
  ds_read_b128 a[232:235], v1 offset:18432
  v_rcp_f32 v74, v74
  v_exp_f32 v59, v59
  v_rcp_f32 v75, v75
  v_mfma_f32_32x32x16_bf16 v[8:23], a[252:255], a[236:239], v[8:23]
  s_waitcnt lgkmcnt(1)
  ds_read_b128 a[236:239], v1 offset:19456
  v_exp_f32 v60, v60
  v_rcp_f32 v76, v76
  v_exp_f32 v61, v61
  v_mfma_f32_32x32x16_bf16 v[8:23], v[112:115], a[224:227], v[8:23]
  buffer_load_dwordx4 v4, s[28:31], s73 offen offset:1024 lds
  ds_read_b128 a[224:227], v1 offset:20480
  v_rcp_f32 v77, v77
  v_exp_f32 v62, v62
  v_rcp_f32 v78, v78
  v_mfma_f32_32x32x16_bf16 v[8:23], v[116:119], a[228:231], v[8:23]
  s_waitcnt lgkmcnt(1)
  ds_read_b128 a[228:231], v1 offset:21504
  v_exp_f32 v63, v63
  v_rcp_f32 v79, v79
  v_exp_f32 v64, v64
  v_mfma_f32_32x32x16_bf16 v[8:23], v[120:123], a[232:235], v[8:23]
  ds_read_b128 a[232:235], v1 offset:22528
  v_rcp_f32 v80, v80
  v_exp_f32 v65, v65
  v_rcp_f32 v81, v81
  v_mfma_f32_32x32x16_bf16 v[8:23], v[124:127], a[236:239], v[8:23]
  s_waitcnt lgkmcnt(1)
  buffer_load_dwordx4 v4, s[28:31], s74 offen offset:2048 lds
  ds_read_b128 a[236:239], v1 offset:23552
  v_exp_f32 v66, v66
  v_rcp_f32 v82, v82
  v_exp_f32 v67, v67
  v_mfma_f32_32x32x16_bf16 v[8:23], v[128:131], a[224:227], v[8:23]
  ds_read_b128 a[224:227], v1 offset:24576
  v_rcp_f32 v83, v83
  v_exp_f32 v68, v68
  v_rcp_f32 v84, v84
  v_mfma_f32_32x32x16_bf16 v[8:23], v[132:135], a[228:231], v[8:23]
  s_waitcnt lgkmcnt(1)
  ds_read_b128 a[228:231], v1 offset:25600
  v_exp_f32 v69, v69
  v_rcp_f32 v85, v85
  v_exp_f32 v70, v70
  v_mfma_f32_32x32x16_bf16 v[8:23], v[136:139], a[232:235], v[8:23]
  buffer_load_dwordx4 v4, s[28:31], s75 offen offset:3072 lds
  ds_read_b128 a[232:235], v1 offset:26624
  v_rcp_f32 v86, v86
  v_exp_f32 v71, v71
  v_rcp_f32 v87, v87
  v_mfma_f32_32x32x16_bf16 v[8:23], v[140:143], a[236:239], v[8:23]
  ds_read_b128 a[236:239], v1 offset:27648
  v_accvgpr_write_b32 a96, v104
  v_accvgpr_write_b32 a97, v105
  v_accvgpr_write_b32 a98, v106
  v_accvgpr_write_b32 a99, v107
  v_accvgpr_write_b32 a100, v108
  v_accvgpr_write_b32 a101, v109
  v_accvgpr_write_b32 a102, v110
  v_accvgpr_write_b32 a103, v111
  v_pk_mul_f32 v[72:73], v[72:73], v[24:25]
  v_pk_mul_f32 v[74:75], v[74:75], v[26:27]
  v_pk_mul_f32 v[76:77], v[76:77], v[28:29]
  v_pk_mul_f32 v[78:79], v[78:79], v[30:31]
  v_pk_mul_f32 v[80:81], v[80:81], v[32:33]
  v_pk_mul_f32 v[82:83], v[82:83], v[34:35]
  v_pk_mul_f32 v[84:85], v[84:85], v[36:37]
  v_pk_mul_f32 v[86:87], v[86:87], v[38:39]
  v_pk_add_f32 v[56:57], v[56:57], 1.0 op_sel_hi:[1,0]
  v_pk_add_f32 v[58:59], v[58:59], 1.0 op_sel_hi:[1,0]
  v_pk_add_f32 v[60:61], v[60:61], 1.0 op_sel_hi:[1,0]
  v_pk_add_f32 v[62:63], v[62:63], 1.0 op_sel_hi:[1,0]
  v_pk_add_f32 v[64:65], v[64:65], 1.0 op_sel_hi:[1,0]
  v_pk_add_f32 v[66:67], v[66:67], 1.0 op_sel_hi:[1,0]
  v_pk_add_f32 v[68:69], v[68:69], 1.0 op_sel_hi:[1,0]
  v_pk_add_f32 v[70:71], v[70:71], 1.0 op_sel_hi:[1,0]
  v_pk_fma_f32 v[88:89], v[72:73], v[72:73], v[88:89]
  v_pk_fma_f32 v[90:91], v[74:75], v[74:75], v[90:91]
  v_pk_fma_f32 v[92:93], v[76:77], v[76:77], v[92:93]
  v_pk_fma_f32 v[94:95], v[78:79], v[78:79], v[94:95]
  v_pk_fma_f32 v[96:97], v[80:81], v[80:81], v[96:97]
  v_pk_fma_f32 v[98:99], v[82:83], v[82:83], v[98:99]
  v_pk_fma_f32 v[100:101], v[84:85], v[84:85], v[100:101]
  v_pk_fma_f32 v[102:103], v[86:87], v[86:87], v[102:103]
  v_cvt_pk_bf16_f32 v104, v72, v73
  v_cvt_pk_bf16_f32 v105, v74, v75
  v_cvt_pk_bf16_f32 v106, v76, v77
  v_cvt_pk_bf16_f32 v107, v78, v79
  v_cvt_pk_bf16_f32 v108, v80, v81
  v_cvt_pk_bf16_f32 v109, v82, v83
  v_cvt_pk_bf16_f32 v110, v84, v85
  v_cvt_pk_bf16_f32 v111, v86, v87
  v_pk_fma_f32 v[72:73], v[8:9], v[8:9], s[50:51] neg_lo:[1,0,0] neg_hi:[1,0,0]
  v_pk_fma_f32 v[74:75], v[10:11], v[10:11], s[50:51] neg_lo:[1,0,0] neg_hi:[1,0,0]
  v_pk_fma_f32 v[76:77], v[12:13], v[12:13], s[50:51] neg_lo:[1,0,0] neg_hi:[1,0,0]
  v_pk_fma_f32 v[78:79], v[14:15], v[14:15], s[50:51] neg_lo:[1,0,0] neg_hi:[1,0,0]
  v_pk_fma_f32 v[80:81], v[16:17], v[16:17], s[50:51] neg_lo:[1,0,0] neg_hi:[1,0,0]
  v_pk_fma_f32 v[82:83], v[18:19], v[18:19], s[50:51] neg_lo:[1,0,0] neg_hi:[1,0,0]
  v_pk_fma_f32 v[84:85], v[20:21], v[20:21], s[50:51] neg_lo:[1,0,0] neg_hi:[1,0,0]
  v_pk_fma_f32 v[86:87], v[22:23], v[22:23], s[50:51] neg_lo:[1,0,0] neg_hi:[1,0,0]
  v_pk_mul_f32 v[72:73], v[72:73], v[8:9]
  v_pk_mul_f32 v[74:75], v[74:75], v[10:11]
  v_pk_mul_f32 v[76:77], v[76:77], v[12:13]
  v_pk_mul_f32 v[78:79], v[78:79], v[14:15]
  v_pk_mul_f32 v[80:81], v[80:81], v[16:17]
  v_pk_mul_f32 v[82:83], v[82:83], v[18:19]
  v_pk_mul_f32 v[84:85], v[84:85], v[20:21]
  v_pk_mul_f32 v[86:87], v[86:87], v[22:23]
  s_waitcnt lgkmcnt(2)
  v_mfma_f32_32x32x16_bf16 v[24:39], a[240:243], a[224:227], 0
  ds_read_b128 a[224:227], v1 offset:28672
  v_exp_f32 v72, v72
  v_add_f32_dpp v88, v88, v88 row_ror:8 row_mask:0xf bank_mask:0x3
  v_rcp_f32 v56, v56
  v_add_f32_dpp v89, v89, v89 row_ror:8 row_mask:0xf bank_mask:0x3
  v_exp_f32 v73, v73
  v_add_f32_dpp v90, v90, v90 row_ror:8 row_mask:0xf bank_mask:0x3
  s_add_u32 m0, s56, 4096
  v_mfma_f32_32x32x16_bf16 v[24:39], a[244:247], a[228:231], v[24:39]
  s_waitcnt lgkmcnt(1)
  buffer_load_dwordx4 v4, s[28:31], s76 offen offset:0 lds
  ds_read_b128 a[228:231], v1 offset:29696
  v_rcp_f32 v57, v57
  v_add_f32_dpp v91, v91, v91 row_ror:8 row_mask:0xf bank_mask:0x3
  v_exp_f32 v74, v74
  v_add_f32_dpp v92, v92, v92 row_ror:8 row_mask:0xf bank_mask:0x3
  v_rcp_f32 v58, v58
  v_add_f32_dpp v93, v93, v93 row_ror:8 row_mask:0xf bank_mask:0x3
  v_mfma_f32_32x32x16_bf16 v[24:39], a[248:251], a[232:235], v[24:39]
  ds_read_b128 a[232:235], v1 offset:30720
  v_exp_f32 v75, v75
  v_add_f32_dpp v94, v94, v94 row_ror:8 row_mask:0xf bank_mask:0x3
  v_add_f32_dpp v95, v95, v95 row_ror:8 row_mask:0xf bank_mask:0x3
  v_rcp_f32 v59, v59
  v_add_f32_dpp v88, v96, v96 row_ror:8 row_mask:0xf bank_mask:0xc
  v_exp_f32 v76, v76
  v_mfma_f32_32x32x16_bf16 v[24:39], a[252:255], a[236:239], v[24:39]
  s_waitcnt lgkmcnt(1)
  ds_read_b128 a[236:239], v1 offset:31744
  v_add_f32_dpp v89, v97, v97 row_ror:8 row_mask:0xf bank_mask:0xc
  v_rcp_f32 v60, v60
  v_add_f32_dpp v90, v98, v98 row_ror:8 row_mask:0xf bank_mask:0xc
  v_exp_f32 v77, v77
  v_add_f32_dpp v91, v99, v99 row_ror:8 row_mask:0xf bank_mask:0xc
  v_rcp_f32 v61, v61
  v_add_f32_dpp v92, v100, v100 row_ror:8 row_mask:0xf bank_mask:0xc
  v_mfma_f32_32x32x16_bf16 v[24:39], v[112:115], a[224:227], v[24:39]
  buffer_load_dwordx4 v4, s[28:31], s77 offen offset:1024 lds
  ds_read_b128 a[224:227], v1 offset:32768
  v_exp_f32 v78, v78
  v_add_f32_dpp v93, v101, v101 row_ror:8 row_mask:0xf bank_mask:0xc
  v_add_f32_dpp v94, v102, v102 row_ror:8 row_mask:0xf bank_mask:0xc
  v_rcp_f32 v62, v62
  v_add_f32_dpp v95, v103, v103 row_ror:8 row_mask:0xf bank_mask:0xc
  v_exp_f32 v79, v79
  v_mfma_f32_32x32x16_bf16 v[24:39], v[116:119], a[228:231], v[24:39]
  s_waitcnt lgkmcnt(1)
  ds_read_b128 a[228:231], v1 offset:33792
  v_add_f32_dpp v88, v88, v88 row_shl:4 row_mask:0xf bank_mask:0x5
  v_rcp_f32 v63, v63
  v_add_f32_dpp v89, v89, v89 row_shl:4 row_mask:0xf bank_mask:0x5
  v_exp_f32 v80, v80
  v_add_f32_dpp v90, v90, v90 row_shl:4 row_mask:0xf bank_mask:0x5
  v_rcp_f32 v64, v64
  v_mfma_f32_32x32x16_bf16 v[24:39], v[120:123], a[232:235], v[24:39]
  ds_read_b128 a[232:235], v1 offset:34816
  v_add_f32_dpp v91, v91, v91 row_shl:4 row_mask:0xf bank_mask:0x5
  v_exp_f32 v81, v81
  v_add_f32_dpp v88, v92, v92 row_shr:4 row_mask:0xf bank_mask:0xa
  v_rcp_f32 v65, v65
  v_add_f32_dpp v89, v93, v93 row_shr:4 row_mask:0xf bank_mask:0xa
  v_add_f32_dpp v90, v94, v94 row_shr:4 row_mask:0xf bank_mask:0xa
  v_mfma_f32_32x32x16_bf16 v[24:39], v[124:127], a[236:239], v[24:39]
  s_waitcnt lgkmcnt(1)
  buffer_load_dwordx4 v4, s[28:31], s78 offen offset:2048 lds
  ds_read_b128 a[236:239], v1 offset:35840
  v_exp_f32 v82, v82
  v_add_f32_dpp v91, v95, v95 row_shr:4 row_mask:0xf bank_mask:0xa
  v_rcp_f32 v66, v66
  v_add_f32_dpp v92, v88, v88 quad_perm:[2,3,0,1] row_mask:0xf bank_mask:0xf
  v_exp_f32 v83, v83
  v_add_f32_dpp v93, v89, v89 quad_perm:[2,3,0,1] row_mask:0xf bank_mask:0xf
  v_rcp_f32 v67, v67
  v_mfma_f32_32x32x16_bf16 v[24:39], v[128:131], a[224:227], v[24:39]
  ds_read_b128 a[224:227], v2 offset:0
  v_add_f32_dpp v94, v90, v90 quad_perm:[2,3,0,1] row_mask:0xf bank_mask:0xf
  v_exp_f32 v84, v84
  v_add_f32_dpp v95, v91, v91 quad_perm:[2,3,0,1] row_mask:0xf bank_mask:0xf
  v_rcp_f32 v68, v68
  v_cndmask_b32 v88, v92, v94, s[64:65]
  v_cndmask_b32 v89, v93, v95, s[64:65]
  v_mfma_f32_32x32x16_bf16 v[24:39], v[132:135], a[228:231], v[24:39]
  s_waitcnt lgkmcnt(1)
  ds_read_b128 a[228:231], v2 offset:1024
  v_exp_f32 v85, v85
  v_add_f32_dpp v90, v88, v88 quad_perm:[1,0,3,2] row_mask:0xf bank_mask:0xf
  v_rcp_f32 v69, v69
  v_add_f32_dpp v91, v89, v89 quad_perm:[1,0,3,2] row_mask:0xf bank_mask:0xf
  v_exp_f32 v86, v86
  v_cndmask_b32 v92, v90, v91, s[58:59]
  v_mfma_f32_32x32x16_bf16 v[24:39], v[136:139], a[232:235], v[24:39]
  buffer_load_dwordx4 v4, s[28:31], s79 offen offset:3072 lds
  ds_read_b128 a[232:235], v2 offset:2048
  v_rcp_f32 v70, v70
  v_mov_b32 v6, v92
  v_exp_f32 v87, v87
  s_nop 0
  v_permlane16_swap_b32 v92, v6
  v_rcp_f32 v71, v71
  v_add_f32_e64 v6, v6, v92
  s_mov_b32 exec_lo, 0xffff
  s_mov_b32 exec_hi, 0xffff
  buffer_atomic_add_f32 v6, v5, s[4:7], 0 offen offset:128
  s_mov_b64 exec, -1
  v_mfma_f32_32x32x16_bf16 v[24:39], v[140:143], a[236:239], v[24:39]
  ds_read_b128 a[236:239], v2 offset:3072
  v_accvgpr_write_b32 a104, v104
  v_accvgpr_write_b32 a105, v105
  v_accvgpr_write_b32 a106, v106
  v_accvgpr_write_b32 a107, v107
  v_accvgpr_write_b32 a108, v108
  v_accvgpr_write_b32 a109, v109
  v_accvgpr_write_b32 a110, v110
  v_accvgpr_write_b32 a111, v111
  v_pk_mul_f32 v[56:57], v[56:57], v[40:41]
  v_pk_mul_f32 v[58:59], v[58:59], v[42:43]
  v_pk_mul_f32 v[60:61], v[60:61], v[44:45]
  v_pk_mul_f32 v[62:63], v[62:63], v[46:47]
  v_pk_mul_f32 v[64:65], v[64:65], v[48:49]
  v_pk_mul_f32 v[66:67], v[66:67], v[50:51]
  v_pk_mul_f32 v[68:69], v[68:69], v[52:53]
  v_pk_mul_f32 v[70:71], v[70:71], v[54:55]
  v_pk_add_f32 v[72:73], v[72:73], 1.0 op_sel_hi:[1,0]
  v_pk_add_f32 v[74:75], v[74:75], 1.0 op_sel_hi:[1,0]
  v_pk_add_f32 v[76:77], v[76:77], 1.0 op_sel_hi:[1,0]
  v_pk_add_f32 v[78:79], v[78:79], 1.0 op_sel_hi:[1,0]
  v_pk_add_f32 v[80:81], v[80:81], 1.0 op_sel_hi:[1,0]
  v_pk_add_f32 v[82:83], v[82:83], 1.0 op_sel_hi:[1,0]
  v_pk_add_f32 v[84:85], v[84:85], 1.0 op_sel_hi:[1,0]
  v_pk_add_f32 v[86:87], v[86:87], 1.0 op_sel_hi:[1,0]
  v_pk_mul_f32 v[88:89], v[56:57], v[56:57]
  v_pk_mul_f32 v[90:91], v[58:59], v[58:59]
  v_pk_mul_f32 v[92:93], v[60:61], v[60:61]
  v_pk_mul_f32 v[94:95], v[62:63], v[62:63]
  v_pk_mul_f32 v[96:97], v[64:65], v[64:65]
  v_pk_mul_f32 v[98:99], v[66:67], v[66:67]
  v_pk_mul_f32 v[100:101], v[68:69], v[68:69]
  v_pk_mul_f32 v[102:103], v[70:71], v[70:71]
  v_cvt_pk_bf16_f32 v104, v56, v57
  v_cvt_pk_bf16_f32 v105, v58, v59
  v_cvt_pk_bf16_f32 v106, v60, v61
  v_cvt_pk_bf16_f32 v107, v62, v63
  v_cvt_pk_bf16_f32 v108, v64, v65
  v_cvt_pk_bf16_f32 v109, v66, v67
  v_cvt_pk_bf16_f32 v110, v68, v69
  v_cvt_pk_bf16_f32 v111, v70, v71
  v_pk_fma_f32 v[56:57], v[24:25], v[24:25], s[50:51] neg_lo:[1,0,0] neg_hi:[1,0,0]
  v_pk_fma_f32 v[58:59], v[26:27], v[26:27], s[50:51] neg_lo:[1,0,0] neg_hi:[1,0,0]
  v_pk_fma_f32 v[60:61], v[28:29], v[28:29], s[50:51] neg_lo:[1,0,0] neg_hi:[1,0,0]
  v_pk_fma_f32 v[62:63], v[30:31], v[30:31], s[50:51] neg_lo:[1,0,0] neg_hi:[1,0,0]
  v_pk_fma_f32 v[64:65], v[32:33], v[32:33], s[50:51] neg_lo:[1,0,0] neg_hi:[1,0,0]
  v_pk_fma_f32 v[66:67], v[34:35], v[34:35], s[50:51] neg_lo:[1,0,0] neg_hi:[1,0,0]
  v_pk_fma_f32 v[68:69], v[36:37], v[36:37], s[50:51] neg_lo:[1,0,0] neg_hi:[1,0,0]
  v_pk_fma_f32 v[70:71], v[38:39], v[38:39], s[50:51] neg_lo:[1,0,0] neg_hi:[1,0,0]
  v_pk_mul_f32 v[56:57], v[56:57], v[24:25]
  v_pk_mul_f32 v[58:59], v[58:59], v[26:27]
  v_pk_mul_f32 v[60:61], v[60:61], v[28:29]
  v_pk_mul_f32 v[62:63], v[62:63], v[30:31]
  v_pk_mul_f32 v[64:65], v[64:65], v[32:33]
  v_pk_mul_f32 v[66:67], v[66:67], v[34:35]
  v_pk_mul_f32 v[68:69], v[68:69], v[36:37]
  v_pk_mul_f32 v[70:71], v[70:71], v[38:39]
  s_waitcnt lgkmcnt(2)
  v_mfma_f32_32x32x16_bf16 v[40:55], a[240:243], a[224:227], 0
  ds_read_b128 a[224:227], v2 offset:4096
  v_exp_f32 v56, v56
  v_rcp_f32 v72, v72
  s_add_u32 m0, s56, 8192
  v_mfma_f32_32x32x16_bf16 v[40:55], a[244:247], a[228:231], v[40:55]
  s_waitcnt lgkmcnt(1)
  buffer_load_dwordx4 v4, s[28:31], s80 offen offset:0 lds
  ds_read_b128 a[228:231], v2 offset:5120
  v_exp_f32 v57, v57
  v_rcp_f32 v73, v73
  v_exp_f32 v58, v58
  v_mfma_f32_32x32x16_bf16 v[40:55], a[248:251], a[232:235], v[40:55]
  ds_read_b128 a[232:235], v2 offset:6144
  v_rcp_f32 v74, v74
  v_exp_f32 v59, v59
  v_rcp_f32 v75, v75
  v_mfma_f32_32x32x16_bf16 v[40:55], a[252:255], a[236:239], v[40:55]
  s_waitcnt lgkmcnt(1)
  ds_read_b128 a[236:239], v2 offset:7168
  v_exp_f32 v60, v60
  v_rcp_f32 v76, v76
  v_exp_f32 v61, v61
  v_mfma_f32_32x32x16_bf16 v[40:55], v[112:115], a[224:227], v[40:55]
  buffer_load_dwordx4 v4, s[28:31], s81 offen offset:1024 lds
  ds_read_b128 a[224:227], v2 offset:8192
  v_rcp_f32 v77, v77
  v_exp_f32 v62, v62
  v_rcp_f32 v78, v78
  v_mfma_f32_32x32x16_bf16 v[40:55], v[116:119], a[228:231], v[40:55]
  s_waitcnt lgkmcnt(1)
  ds_read_b128 a[228:231], v2 offset:9216
  v_exp_f32 v63, v63
  v_rcp_f32 v79, v79
  v_exp_f32 v64, v64
  v_mfma_f32_32x32x16_bf16 v[40:55], v[120:123], a[232:235], v[40:55]
  ds_read_b128 a[232:235], v2 offset:10240
  v_rcp_f32 v80, v80
  v_exp_f32 v65, v65
  v_rcp_f32 v81, v81
  v_mfma_f32_32x32x16_bf16 v[40:55], v[124:127], a[236:239], v[40:55]
  s_waitcnt lgkmcnt(1)
  buffer_load_dwordx4 v4, s[28:31], s82 offen offset:2048 lds
  ds_read_b128 a[236:239], v2 offset:11264
  v_exp_f32 v66, v66
  v_rcp_f32 v82, v82
  v_exp_f32 v67, v67
  v_mfma_f32_32x32x16_bf16 v[40:55], v[128:131], a[224:227], v[40:55]
  ds_read_b128 a[224:227], v2 offset:12288
  v_rcp_f32 v83, v83
  v_exp_f32 v68, v68
  v_rcp_f32 v84, v84
  v_mfma_f32_32x32x16_bf16 v[40:55], v[132:135], a[228:231], v[40:55]
  s_waitcnt lgkmcnt(1)
  ds_read_b128 a[228:231], v2 offset:13312
  v_exp_f32 v69, v69
  v_rcp_f32 v85, v85
  v_exp_f32 v70, v70
  v_mfma_f32_32x32x16_bf16 v[40:55], v[136:139], a[232:235], v[40:55]
  buffer_load_dwordx4 v4, s[28:31], s83 offen offset:3072 lds
  ds_read_b128 a[232:235], v2 offset:14336
  v_rcp_f32 v86, v86
  v_exp_f32 v71, v71
  v_rcp_f32 v87, v87
  v_mfma_f32_32x32x16_bf16 v[40:55], v[140:143], a[236:239], v[40:55]
  ds_read_b128 a[236:239], v2 offset:15360
  v_accvgpr_write_b32 a112, v104
  v_accvgpr_write_b32 a113, v105
  v_accvgpr_write_b32 a114, v106
  v_accvgpr_write_b32 a115, v107
  v_accvgpr_write_b32 a116, v108
  v_accvgpr_write_b32 a117, v109
  v_accvgpr_write_b32 a118, v110
  v_accvgpr_write_b32 a119, v111
  v_pk_mul_f32 v[72:73], v[72:73], v[8:9]
  v_pk_mul_f32 v[74:75], v[74:75], v[10:11]
  v_pk_mul_f32 v[76:77], v[76:77], v[12:13]
  v_pk_mul_f32 v[78:79], v[78:79], v[14:15]
  v_pk_mul_f32 v[80:81], v[80:81], v[16:17]
  v_pk_mul_f32 v[82:83], v[82:83], v[18:19]
  v_pk_mul_f32 v[84:85], v[84:85], v[20:21]
  v_pk_mul_f32 v[86:87], v[86:87], v[22:23]
  v_pk_add_f32 v[56:57], v[56:57], 1.0 op_sel_hi:[1,0]
  v_pk_add_f32 v[58:59], v[58:59], 1.0 op_sel_hi:[1,0]
  v_pk_add_f32 v[60:61], v[60:61], 1.0 op_sel_hi:[1,0]
  v_pk_add_f32 v[62:63], v[62:63], 1.0 op_sel_hi:[1,0]
  v_pk_add_f32 v[64:65], v[64:65], 1.0 op_sel_hi:[1,0]
  v_pk_add_f32 v[66:67], v[66:67], 1.0 op_sel_hi:[1,0]
  v_pk_add_f32 v[68:69], v[68:69], 1.0 op_sel_hi:[1,0]
  v_pk_add_f32 v[70:71], v[70:71], 1.0 op_sel_hi:[1,0]
  v_pk_fma_f32 v[88:89], v[72:73], v[72:73], v[88:89]
  v_pk_fma_f32 v[90:91], v[74:75], v[74:75], v[90:91]
  v_pk_fma_f32 v[92:93], v[76:77], v[76:77], v[92:93]
  v_pk_fma_f32 v[94:95], v[78:79], v[78:79], v[94:95]
  v_pk_fma_f32 v[96:97], v[80:81], v[80:81], v[96:97]
  v_pk_fma_f32 v[98:99], v[82:83], v[82:83], v[98:99]
  v_pk_fma_f32 v[100:101], v[84:85], v[84:85], v[100:101]
  v_pk_fma_f32 v[102:103], v[86:87], v[86:87], v[102:103]
  v_cvt_pk_bf16_f32 v104, v72, v73
  v_cvt_pk_bf16_f32 v105, v74, v75
  v_cvt_pk_bf16_f32 v106, v76, v77
  v_cvt_pk_bf16_f32 v107, v78, v79
  v_cvt_pk_bf16_f32 v108, v80, v81
  v_cvt_pk_bf16_f32 v109, v82, v83
  v_cvt_pk_bf16_f32 v110, v84, v85
  v_cvt_pk_bf16_f32 v111, v86, v87
  v_pk_fma_f32 v[72:73], v[40:41], v[40:41], s[50:51] neg_lo:[1,0,0] neg_hi:[1,0,0]
  v_pk_fma_f32 v[74:75], v[42:43], v[42:43], s[50:51] neg_lo:[1,0,0] neg_hi:[1,0,0]
  v_pk_fma_f32 v[76:77], v[44:45], v[44:45], s[50:51] neg_lo:[1,0,0] neg_hi:[1,0,0]
  v_pk_fma_f32 v[78:79], v[46:47], v[46:47], s[50:51] neg_lo:[1,0,0] neg_hi:[1,0,0]
  v_pk_fma_f32 v[80:81], v[48:49], v[48:49], s[50:51] neg_lo:[1,0,0] neg_hi:[1,0,0]
  v_pk_fma_f32 v[82:83], v[50:51], v[50:51], s[50:51] neg_lo:[1,0,0] neg_hi:[1,0,0]
  v_pk_fma_f32 v[84:85], v[52:53], v[52:53], s[50:51] neg_lo:[1,0,0] neg_hi:[1,0,0]
  v_pk_fma_f32 v[86:87], v[54:55], v[54:55], s[50:51] neg_lo:[1,0,0] neg_hi:[1,0,0]
  v_pk_mul_f32 v[72:73], v[72:73], v[40:41]
  v_pk_mul_f32 v[74:75], v[74:75], v[42:43]
  v_pk_mul_f32 v[76:77], v[76:77], v[44:45]
  v_pk_mul_f32 v[78:79], v[78:79], v[46:47]
  v_pk_mul_f32 v[80:81], v[80:81], v[48:49]
  v_pk_mul_f32 v[82:83], v[82:83], v[50:51]
  v_pk_mul_f32 v[84:85], v[84:85], v[52:53]
  v_pk_mul_f32 v[86:87], v[86:87], v[54:55]
  s_waitcnt lgkmcnt(2)
  v_mfma_f32_32x32x16_bf16 v[8:23], a[240:243], a[224:227], 0
  ds_read_b128 a[224:227], v2 offset:16384
  v_exp_f32 v72, v72
  v_rcp_f32 v56, v56
  v_mfma_f32_32x32x16_bf16 v[8:23], a[244:247], a[228:231], v[8:23]
  s_waitcnt lgkmcnt(1)
  ds_read_b128 a[228:231], v2 offset:17408
  v_exp_f32 v73, v73
  v_rcp_f32 v57, v57
  v_exp_f32 v74, v74
  v_mfma_f32_32x32x16_bf16 v[8:23], a[248:251], a[232:235], v[8:23]
  ds_read_b128 a[232:235], v2 offset:18432
  v_rcp_f32 v58, v58
  v_exp_f32 v75, v75
  v_rcp_f32 v59, v59
  v_mfma_f32_32x32x16_bf16 v[8:23], a[252:255], a[236:239], v[8:23]
  s_waitcnt lgkmcnt(1)
  ds_read_b128 a[236:239], v2 offset:19456
  v_exp_f32 v76, v76
  v_rcp_f32 v60, v60
  v_exp_f32 v77, v77
  v_mfma_f32_32x32x16_bf16 v[8:23], v[112:115], a[224:227], v[8:23]
  ds_read_b128 a[224:227], v2 offset:20480
  v_rcp_f32 v61, v61
  v_exp_f32 v78, v78
  v_rcp_f32 v62, v62
  v_mfma_f32_32x32x16_bf16 v[8:23], v[116:119], a[228:231], v[8:23]
  s_waitcnt lgkmcnt(1)
  ds_read_b128 a[228:231], v2 offset:21504
  v_exp_f32 v79, v79
  v_rcp_f32 v63, v63
  v_exp_f32 v80, v80
  v_mfma_f32_32x32x16_bf16 v[8:23], v[120:123], a[232:235], v[8:23]
  ds_read_b128 a[232:235], v2 offset:22528
  v_rcp_f32 v64, v64
  v_exp_f32 v81, v81
  v_rcp_f32 v65, v65
  v_mfma_f32_32x32x16_bf16 v[8:23], v[124:127], a[236:239], v[8:23]
  s_waitcnt lgkmcnt(1)
  ds_read_b128 a[236:239], v2 offset:23552
  v_exp_f32 v82, v82
  v_rcp_f32 v66, v66
  v_exp_f32 v83, v83
  v_mfma_f32_32x32x16_bf16 v[8:23], v[128:131], a[224:227], v[8:23]
  ds_read_b128 a[224:227], v2 offset:24576
  v_rcp_f32 v67, v67
  v_exp_f32 v84, v84
  v_rcp_f32 v68, v68
  v_mfma_f32_32x32x16_bf16 v[8:23], v[132:135], a[228:231], v[8:23]
  s_waitcnt lgkmcnt(1)
  ds_read_b128 a[228:231], v2 offset:25600
  v_exp_f32 v85, v85
  v_rcp_f32 v69, v69
  v_exp_f32 v86, v86
  v_mfma_f32_32x32x16_bf16 v[8:23], v[136:139], a[232:235], v[8:23]
  ds_read_b128 a[232:235], v2 offset:26624
  v_rcp_f32 v70, v70
  v_exp_f32 v87, v87
  v_rcp_f32 v71, v71
  v_mfma_f32_32x32x16_bf16 v[8:23], v[140:143], a[236:239], v[8:23]
  ds_read_b128 a[236:239], v2 offset:27648
  v_accvgpr_write_b32 a120, v104
  v_accvgpr_write_b32 a121, v105
  v_accvgpr_write_b32 a122, v106
  v_accvgpr_write_b32 a123, v107
  v_accvgpr_write_b32 a124, v108
  v_accvgpr_write_b32 a125, v109
  v_accvgpr_write_b32 a126, v110
  v_accvgpr_write_b32 a127, v111
  v_pk_mul_f32 v[56:57], v[56:57], v[24:25]
  v_pk_mul_f32 v[58:59], v[58:59], v[26:27]
  v_pk_mul_f32 v[60:61], v[60:61], v[28:29]
  v_pk_mul_f32 v[62:63], v[62:63], v[30:31]
  v_pk_mul_f32 v[64:65], v[64:65], v[32:33]
  v_pk_mul_f32 v[66:67], v[66:67], v[34:35]
  v_pk_mul_f32 v[68:69], v[68:69], v[36:37]
  v_pk_mul_f32 v[70:71], v[70:71], v[38:39]
  v_pk_add_f32 v[72:73], v[72:73], 1.0 op_sel_hi:[1,0]
  v_pk_add_f32 v[74:75], v[74:75], 1.0 op_sel_hi:[1,0]
  v_pk_add_f32 v[76:77], v[76:77], 1.0 op_sel_hi:[1,0]
  v_pk_add_f32 v[78:79], v[78:79], 1.0 op_sel_hi:[1,0]
  v_pk_add_f32 v[80:81], v[80:81], 1.0 op_sel_hi:[1,0]
  v_pk_add_f32 v[82:83], v[82:83], 1.0 op_sel_hi:[1,0]
  v_pk_add_f32 v[84:85], v[84:85], 1.0 op_sel_hi:[1,0]
  v_pk_add_f32 v[86:87], v[86:87], 1.0 op_sel_hi:[1,0]
  v_pk_fma_f32 v[88:89], v[56:57], v[56:57], v[88:89]
  v_pk_fma_f32 v[90:91], v[58:59], v[58:59], v[90:91]
  v_pk_fma_f32 v[92:93], v[60:61], v[60:61], v[92:93]
  v_pk_fma_f32 v[94:95], v[62:63], v[62:63], v[94:95]
  v_pk_fma_f32 v[96:97], v[64:65], v[64:65], v[96:97]
  v_pk_fma_f32 v[98:99], v[66:67], v[66:67], v[98:99]
  v_pk_fma_f32 v[100:101], v[68:69], v[68:69], v[100:101]
  v_pk_fma_f32 v[102:103], v[70:71], v[70:71], v[102:103]
  v_cvt_pk_bf16_f32 v104, v56, v57
  v_cvt_pk_bf16_f32 v105, v58, v59
  v_cvt_pk_bf16_f32 v106, v60, v61
  v_cvt_pk_bf16_f32 v107, v62, v63
  v_cvt_pk_bf16_f32 v108, v64, v65
  v_cvt_pk_bf16_f32 v109, v66, v67
  v_cvt_pk_bf16_f32 v110, v68, v69
  v_cvt_pk_bf16_f32 v111, v70, v71
  v_pk_fma_f32 v[56:57], v[8:9], v[8:9], s[50:51] neg_lo:[1,0,0] neg_hi:[1,0,0]
  v_pk_fma_f32 v[58:59], v[10:11], v[10:11], s[50:51] neg_lo:[1,0,0] neg_hi:[1,0,0]
  v_pk_fma_f32 v[60:61], v[12:13], v[12:13], s[50:51] neg_lo:[1,0,0] neg_hi:[1,0,0]
  v_pk_fma_f32 v[62:63], v[14:15], v[14:15], s[50:51] neg_lo:[1,0,0] neg_hi:[1,0,0]
  v_pk_fma_f32 v[64:65], v[16:17], v[16:17], s[50:51] neg_lo:[1,0,0] neg_hi:[1,0,0]
  v_pk_fma_f32 v[66:67], v[18:19], v[18:19], s[50:51] neg_lo:[1,0,0] neg_hi:[1,0,0]
  v_pk_fma_f32 v[68:69], v[20:21], v[20:21], s[50:51] neg_lo:[1,0,0] neg_hi:[1,0,0]
  v_pk_fma_f32 v[70:71], v[22:23], v[22:23], s[50:51] neg_lo:[1,0,0] neg_hi:[1,0,0]
  v_pk_mul_f32 v[56:57], v[56:57], v[8:9]
  v_pk_mul_f32 v[58:59], v[58:59], v[10:11]
  v_pk_mul_f32 v[60:61], v[60:61], v[12:13]
  v_pk_mul_f32 v[62:63], v[62:63], v[14:15]
  v_pk_mul_f32 v[64:65], v[64:65], v[16:17]
  v_pk_mul_f32 v[66:67], v[66:67], v[18:19]
  v_pk_mul_f32 v[68:69], v[68:69], v[20:21]
  v_pk_mul_f32 v[70:71], v[70:71], v[22:23]
  s_waitcnt lgkmcnt(2)
  v_mfma_f32_32x32x16_bf16 v[24:39], a[240:243], a[224:227], 0
  ds_read_b128 a[224:227], v2 offset:28672
  v_exp_f32 v56, v56
  v_rcp_f32 v72, v72
  v_mfma_f32_32x32x16_bf16 v[24:39], a[244:247], a[228:231], v[24:39]
  s_waitcnt lgkmcnt(1)
  ds_read_b128 a[228:231], v2 offset:29696
  v_exp_f32 v57, v57
  v_rcp_f32 v73, v73
  v_exp_f32 v58, v58
  v_mfma_f32_32x32x16_bf16 v[24:39], a[248:251], a[232:235], v[24:39]
  ds_read_b128 a[232:235], v2 offset:30720
  v_rcp_f32 v74, v74
  v_exp_f32 v59, v59
  v_rcp_f32 v75, v75
  v_mfma_f32_32x32x16_bf16 v[24:39], a[252:255], a[236:239], v[24:39]
  s_waitcnt lgkmcnt(1)
  ds_read_b128 a[236:239], v2 offset:31744
  v_exp_f32 v60, v60
  v_rcp_f32 v76, v76
  v_exp_f32 v61, v61
  v_mfma_f32_32x32x16_bf16 v[24:39], v[112:115], a[224:227], v[24:39]
  ds_read_b128 a[224:227], v2 offset:32768
  v_rcp_f32 v77, v77
  v_exp_f32 v62, v62
  v_rcp_f32 v78, v78
  v_mfma_f32_32x32x16_bf16 v[24:39], v[116:119], a[228:231], v[24:39]
  s_waitcnt lgkmcnt(1)
  ds_read_b128 a[228:231], v2 offset:33792
  v_exp_f32 v63, v63
  v_rcp_f32 v79, v79
  v_exp_f32 v64, v64
  v_mfma_f32_32x32x16_bf16 v[24:39], v[120:123], a[232:235], v[24:39]
  ds_read_b128 a[232:235], v2 offset:34816
  v_rcp_f32 v80, v80
  v_exp_f32 v65, v65
  v_rcp_f32 v81, v81
  v_mfma_f32_32x32x16_bf16 v[24:39], v[124:127], a[236:239], v[24:39]
  s_waitcnt lgkmcnt(1)
  ds_read_b128 a[236:239], v2 offset:35840
  v_exp_f32 v66, v66
  v_rcp_f32 v82, v82
  v_exp_f32 v67, v67
  v_mfma_f32_32x32x16_bf16 v[24:39], v[128:131], a[224:227], v[24:39]
  ds_read_b128 a[224:227], v2 offset:36864
  v_rcp_f32 v83, v83
  v_exp_f32 v68, v68
  v_rcp_f32 v84, v84
  v_mfma_f32_32x32x16_bf16 v[24:39], v[132:135], a[228:231], v[24:39]
  s_waitcnt lgkmcnt(1)
  ds_read_b128 a[228:231], v2 offset:37888
  v_exp_f32 v69, v69
  v_rcp_f32 v85, v85
  v_exp_f32 v70, v70
  v_mfma_f32_32x32x16_bf16 v[24:39], v[136:139], a[232:235], v[24:39]
  ds_read_b128 a[232:235], v2 offset:38912
  v_rcp_f32 v86, v86
  v_exp_f32 v71, v71
  v_rcp_f32 v87, v87
  v_mfma_f32_32x32x16_bf16 v[24:39], v[140:143], a[236:239], v[24:39]
  ds_read_b128 a[236:239], v2 offset:39936
  v_accvgpr_write_b32 a128, v104
  v_accvgpr_write_b32 a129, v105
  v_accvgpr_write_b32 a130, v106
  v_accvgpr_write_b32 a131, v107
  v_accvgpr_write_b32 a132, v108
  v_accvgpr_write_b32 a133, v109
  v_accvgpr_write_b32 a134, v110
  v_accvgpr_write_b32 a135, v111
  v_pk_mul_f32 v[72:73], v[72:73], v[40:41]
  v_pk_mul_f32 v[74:75], v[74:75], v[42:43]
  v_pk_mul_f32 v[76:77], v[76:77], v[44:45]
  v_pk_mul_f32 v[78:79], v[78:79], v[46:47]
  v_pk_mul_f32 v[80:81], v[80:81], v[48:49]
  v_pk_mul_f32 v[82:83], v[82:83], v[50:51]
  v_pk_mul_f32 v[84:85], v[84:85], v[52:53]
  v_pk_mul_f32 v[86:87], v[86:87], v[54:55]
  v_pk_add_f32 v[56:57], v[56:57], 1.0 op_sel_hi:[1,0]
  v_pk_add_f32 v[58:59], v[58:59], 1.0 op_sel_hi:[1,0]
  v_pk_add_f32 v[60:61], v[60:61], 1.0 op_sel_hi:[1,0]
  v_pk_add_f32 v[62:63], v[62:63], 1.0 op_sel_hi:[1,0]
  v_pk_add_f32 v[64:65], v[64:65], 1.0 op_sel_hi:[1,0]
  v_pk_add_f32 v[66:67], v[66:67], 1.0 op_sel_hi:[1,0]
  v_pk_add_f32 v[68:69], v[68:69], 1.0 op_sel_hi:[1,0]
  v_pk_add_f32 v[70:71], v[70:71], 1.0 op_sel_hi:[1,0]
  v_pk_fma_f32 v[88:89], v[72:73], v[72:73], v[88:89]
  v_pk_fma_f32 v[90:91], v[74:75], v[74:75], v[90:91]
  v_pk_fma_f32 v[92:93], v[76:77], v[76:77], v[92:93]
  v_pk_fma_f32 v[94:95], v[78:79], v[78:79], v[94:95]
  v_pk_fma_f32 v[96:97], v[80:81], v[80:81], v[96:97]
  v_pk_fma_f32 v[98:99], v[82:83], v[82:83], v[98:99]
  v_pk_fma_f32 v[100:101], v[84:85], v[84:85], v[100:101]
  v_pk_fma_f32 v[102:103], v[86:87], v[86:87], v[102:103]
  v_cvt_pk_bf16_f32 v104, v72, v73
  v_cvt_pk_bf16_f32 v105, v74, v75
  v_cvt_pk_bf16_f32 v106, v76, v77
  v_cvt_pk_bf16_f32 v107, v78, v79
  v_cvt_pk_bf16_f32 v108, v80, v81
  v_cvt_pk_bf16_f32 v109, v82, v83
  v_cvt_pk_bf16_f32 v110, v84, v85
  v_cvt_pk_bf16_f32 v111, v86, v87
  v_pk_fma_f32 v[72:73], v[24:25], v[24:25], s[50:51] neg_lo:[1,0,0] neg_hi:[1,0,0]
  v_pk_fma_f32 v[74:75], v[26:27], v[26:27], s[50:51] neg_lo:[1,0,0] neg_hi:[1,0,0]
  v_pk_fma_f32 v[76:77], v[28:29], v[28:29], s[50:51] neg_lo:[1,0,0] neg_hi:[1,0,0]
  v_pk_fma_f32 v[78:79], v[30:31], v[30:31], s[50:51] neg_lo:[1,0,0] neg_hi:[1,0,0]
  v_pk_fma_f32 v[80:81], v[32:33], v[32:33], s[50:51] neg_lo:[1,0,0] neg_hi:[1,0,0]
  v_pk_fma_f32 v[82:83], v[34:35], v[34:35], s[50:51] neg_lo:[1,0,0] neg_hi:[1,0,0]
  v_pk_fma_f32 v[84:85], v[36:37], v[36:37], s[50:51] neg_lo:[1,0,0] neg_hi:[1,0,0]
  v_pk_fma_f32 v[86:87], v[38:39], v[38:39], s[50:51] neg_lo:[1,0,0] neg_hi:[1,0,0]
  v_pk_mul_f32 v[72:73], v[72:73], v[24:25]
  v_pk_mul_f32 v[74:75], v[74:75], v[26:27]
  v_pk_mul_f32 v[76:77], v[76:77], v[28:29]
  v_pk_mul_f32 v[78:79], v[78:79], v[30:31]
  v_pk_mul_f32 v[80:81], v[80:81], v[32:33]
  v_pk_mul_f32 v[82:83], v[82:83], v[34:35]
  v_pk_mul_f32 v[84:85], v[84:85], v[36:37]
  v_pk_mul_f32 v[86:87], v[86:87], v[38:39]
  s_waitcnt vmcnt(0)
  s_waitcnt lgkmcnt(2)
  v_mfma_f32_32x32x16_bf16 v[40:55], a[240:243], a[224:227], 0
  ds_read_b128 a[224:227], v2 offset:40960
  ds_read_b64_tr_b16 a[240:241], v3 offset:0
  ds_read_b64_tr_b16 a[242:243], v3 offset:1024
  v_exp_f32 v72, v72
  v_rcp_f32 v56, v56
  v_mfma_f32_32x32x16_bf16 v[40:55], a[244:247], a[228:231], v[40:55]
  s_waitcnt lgkmcnt(3)
  ds_read_b128 a[228:231], v2 offset:41984
  ds_read_b64_tr_b16 a[244:245], v3 offset:512
  ds_read_b64_tr_b16 a[246:247], v3 offset:1536
  v_exp_f32 v73, v73
  v_rcp_f32 v57, v57
  v_exp_f32 v74, v74
  v_mfma_f32_32x32x16_bf16 v[40:55], a[248:251], a[232:235], v[40:55]
  ds_read_b128 a[232:235], v2 offset:43008
  ds_read_b64_tr_b16 a[248:249], v3 offset:2048
  ds_read_b64_tr_b16 a[250:251], v3 offset:3072
  v_rcp_f32 v58, v58
  v_exp_f32 v75, v75
  v_rcp_f32 v59, v59
  v_mfma_f32_32x32x16_bf16 v[40:55], a[252:255], a[236:239], v[40:55]
  s_waitcnt lgkmcnt(5)
  ds_read_b128 a[236:239], v2 offset:44032
  ds_read_b64_tr_b16 a[252:253], v3 offset:2560
  ds_read_b64_tr_b16 a[254:255], v3 offset:3584
  v_exp_f32 v76, v76
  v_rcp_f32 v60, v60
  v_exp_f32 v77, v77
  v_mfma_f32_32x32x16_bf16 v[40:55], v[112:115], a[224:227], v[40:55]
  ds_read_b128 a[224:227], v2 offset:45056
  ds_read_b64_tr_b16 v[112:113], v3 offset:4096
  ds_read_b64_tr_b16 v[114:115], v3 offset:5120
  v_rcp_f32 v61, v61
  v_exp_f32 v78, v78
  v_rcp_f32 v62, v62
  v_mfma_f32_32x32x16_bf16 v[40:55], v[116:119], a[228:231], v[40:55]
  s_waitcnt lgkmcnt(5)
  ds_read_b128 a[228:231], v2 offset:46080
  ds_read_b64_tr_b16 v[116:117], v3 offset:4608
  ds_read_b64_tr_b16 v[118:119], v3 offset:5632
  v_exp_f32 v79, v79
  v_rcp_f32 v63, v63
  v_exp_f32 v80, v80
  v_mfma_f32_32x32x16_bf16 v[40:55], v[120:123], a[232:235], v[40:55]
  ds_read_b128 a[232:235], v2 offset:47104
  ds_read_b64_tr_b16 v[120:121], v3 offset:6144
  ds_read_b64_tr_b16 v[122:123], v3 offset:7168
  v_rcp_f32 v64, v64
  v_exp_f32 v81, v81
  v_rcp_f32 v65, v65
  v_mfma_f32_32x32x16_bf16 v[40:55], v[124:127], a[236:239], v[40:55]
  s_waitcnt lgkmcnt(5)
  ds_read_b128 a[236:239], v2 offset:48128
  ds_read_b64_tr_b16 v[124:125], v3 offset:6656
  ds_read_b64_tr_b16 v[126:127], v3 offset:7680
  v_exp_f32 v82, v82
  v_rcp_f32 v66, v66
  v_exp_f32 v83, v83
  v_mfma_f32_32x32x16_bf16 v[40:55], v[128:131], a[224:227], v[40:55]
  ds_read_b128 a[224:227], v1 offset:0
  ds_read_b64_tr_b16 v[128:129], v3 offset:8192
  ds_read_b64_tr_b16 v[130:131], v3 offset:9216
  v_rcp_f32 v67, v67
  v_exp_f32 v84, v84
  v_rcp_f32 v68, v68
  v_mfma_f32_32x32x16_bf16 v[40:55], v[132:135], a[228:231], v[40:55]
  s_waitcnt lgkmcnt(5)
  ds_read_b128 a[228:231], v1 offset:1024
  ds_read_b64_tr_b16 v[132:133], v3 offset:8704
  ds_read_b64_tr_b16 v[134:135], v3 offset:9728
  v_exp_f32 v85, v85
  v_rcp_f32 v69, v69
  v_exp_f32 v86, v86
  v_mfma_f32_32x32x16_bf16 v[40:55], v[136:139], a[232:235], v[40:55]
  ds_read_b128 a[232:235], v1 offset:2048
  ds_read_b64_tr_b16 v[136:137], v3 offset:10240
  ds_read_b64_tr_b16 v[138:139], v3 offset:11264
  v_rcp_f32 v70, v70
  v_exp_f32 v87, v87
  v_rcp_f32_e64 v71, v71
  v_mfma_f32_32x32x16_bf16 v[40:55], v[140:143], a[236:239], v[40:55]
  ds_read_b128 a[236:239], v1 offset:3072
  ds_read_b64_tr_b16 v[140:141], v3 offset:10752
  ds_read_b64_tr_b16 v[142:143], v3 offset:11776
  v_accvgpr_write_b32 a136, v104
  v_accvgpr_write_b32 a137, v105
  v_accvgpr_write_b32 a138, v106
  v_accvgpr_write_b32 a139, v107
  v_accvgpr_write_b32 a140, v108
  v_accvgpr_write_b32 a141, v109
  v_accvgpr_write_b32 a142, v110
  v_accvgpr_write_b32 a143, v111
  v_pk_mul_f32 v[56:57], v[56:57], v[8:9]
  v_pk_mul_f32 v[58:59], v[58:59], v[10:11]
  v_pk_mul_f32 v[60:61], v[60:61], v[12:13]
  v_pk_mul_f32 v[62:63], v[62:63], v[14:15]
  v_pk_mul_f32 v[64:65], v[64:65], v[16:17]
  v_pk_mul_f32 v[66:67], v[66:67], v[18:19]
  v_pk_mul_f32 v[68:69], v[68:69], v[20:21]
  v_pk_mul_f32 v[70:71], v[70:71], v[22:23]
  v_pk_add_f32 v[72:73], v[72:73], 1.0 op_sel_hi:[1,0]
  v_pk_add_f32 v[74:75], v[74:75], 1.0 op_sel_hi:[1,0]
  v_pk_add_f32 v[76:77], v[76:77], 1.0 op_sel_hi:[1,0]
  v_pk_add_f32 v[78:79], v[78:79], 1.0 op_sel_hi:[1,0]
  v_pk_add_f32 v[80:81], v[80:81], 1.0 op_sel_hi:[1,0]
  v_pk_add_f32 v[82:83], v[82:83], 1.0 op_sel_hi:[1,0]
  v_pk_add_f32 v[84:85], v[84:85], 1.0 op_sel_hi:[1,0]
  v_pk_add_f32 v[86:87], v[86:87], 1.0 op_sel_hi:[1,0]
  v_pk_fma_f32 v[88:89], v[56:57], v[56:57], v[88:89]
  v_pk_fma_f32 v[90:91], v[58:59], v[58:59], v[90:91]
  v_pk_fma_f32 v[92:93], v[60:61], v[60:61], v[92:93]
  v_pk_fma_f32 v[94:95], v[62:63], v[62:63], v[94:95]
  v_pk_fma_f32 v[96:97], v[64:65], v[64:65], v[96:97]
  v_pk_fma_f32 v[98:99], v[66:67], v[66:67], v[98:99]
  v_pk_fma_f32 v[100:101], v[68:69], v[68:69], v[100:101]
  v_pk_fma_f32 v[102:103], v[70:71], v[70:71], v[102:103]
  v_cvt_pk_bf16_f32 v104, v56, v57
  v_cvt_pk_bf16_f32 v105, v58, v59
  v_cvt_pk_bf16_f32 v106, v60, v61
  v_cvt_pk_bf16_f32 v107, v62, v63
  v_cvt_pk_bf16_f32 v108, v64, v65
  v_cvt_pk_bf16_f32 v109, v66, v67
  v_cvt_pk_bf16_f32 v110, v68, v69
  v_cvt_pk_bf16_f32 v111, v70, v71
  v_pk_fma_f32 v[56:57], v[40:41], v[40:41], s[50:51] neg_lo:[1,0,0] neg_hi:[1,0,0]
  v_pk_fma_f32 v[58:59], v[42:43], v[42:43], s[50:51] neg_lo:[1,0,0] neg_hi:[1,0,0]
  v_pk_fma_f32 v[60:61], v[44:45], v[44:45], s[50:51] neg_lo:[1,0,0] neg_hi:[1,0,0]
  v_pk_fma_f32 v[62:63], v[46:47], v[46:47], s[50:51] neg_lo:[1,0,0] neg_hi:[1,0,0]
  v_pk_fma_f32 v[64:65], v[48:49], v[48:49], s[50:51] neg_lo:[1,0,0] neg_hi:[1,0,0]
  v_pk_fma_f32 v[66:67], v[50:51], v[50:51], s[50:51] neg_lo:[1,0,0] neg_hi:[1,0,0]
  v_pk_fma_f32 v[68:69], v[52:53], v[52:53], s[50:51] neg_lo:[1,0,0] neg_hi:[1,0,0]
  v_pk_fma_f32 v[70:71], v[54:55], v[54:55], s[50:51] neg_lo:[1,0,0] neg_hi:[1,0,0]
  v_pk_mul_f32 v[56:57], v[56:57], v[40:41]
  v_pk_mul_f32 v[58:59], v[58:59], v[42:43]
  v_pk_mul_f32 v[60:61], v[60:61], v[44:45]
  v_pk_mul_f32 v[62:63], v[62:63], v[46:47]
  v_pk_mul_f32 v[64:65], v[64:65], v[48:49]
  v_pk_mul_f32 v[66:67], v[66:67], v[50:51]
  v_pk_mul_f32 v[68:69], v[68:69], v[52:53]
  v_pk_mul_f32 v[70:71], v[70:71], v[54:55]
  s_waitcnt lgkmcnt(8)
  v_mfma_f32_32x32x16_bf16 v[8:23], a[240:243], a[224:227], 0
  ds_read_b128 a[224:227], v1 offset:4096
  v_exp_f32 v56, v56
  v_rcp_f32 v72, v72
  v_mfma_f32_32x32x16_bf16 v[8:23], a[244:247], a[228:231], v[8:23]
  s_waitcnt lgkmcnt(3)
  ds_read_b128 a[228:231], v1 offset:5120
  v_exp_f32 v57, v57
  v_rcp_f32 v73, v73
  v_exp_f32 v58, v58
  v_mfma_f32_32x32x16_bf16 v[8:23], a[248:251], a[232:235], v[8:23]
  ds_read_b128 a[232:235], v1 offset:6144
  v_rcp_f32 v74, v74
  v_exp_f32 v59, v59
  v_rcp_f32 v75, v75
  v_mfma_f32_32x32x16_bf16 v[8:23], a[252:255], a[236:239], v[8:23]
  s_waitcnt lgkmcnt(1)
  ds_read_b128 a[236:239], v1 offset:7168
  v_exp_f32 v60, v60
  v_rcp_f32 v76, v76
  v_exp_f32 v61, v61
  v_mfma_f32_32x32x16_bf16 v[8:23], v[112:115], a[224:227], v[8:23]
  ds_read_b128 a[224:227], v1 offset:8192
  v_rcp_f32 v77, v77
  v_exp_f32 v62, v62
  v_rcp_f32 v78, v78
  v_mfma_f32_32x32x16_bf16 v[8:23], v[116:119], a[228:231], v[8:23]
  s_waitcnt lgkmcnt(1)
  ds_read_b128 a[228:231], v1 offset:9216
  v_exp_f32 v63, v63
  v_rcp_f32 v79, v79
  v_exp_f32 v64, v64
  v_mfma_f32_32x32x16_bf16 v[8:23], v[120:123], a[232:235], v[8:23]
  ds_read_b128 a[232:235], v1 offset:10240
  v_rcp_f32 v80, v80
  v_exp_f32 v65, v65
  v_rcp_f32 v81, v81
  v_mfma_f32_32x32x16_bf16 v[8:23], v[124:127], a[236:239], v[8:23]
  s_waitcnt lgkmcnt(1)
  ds_read_b128 a[236:239], v1 offset:11264
  v_exp_f32 v66, v66
  v_rcp_f32 v82, v82
  v_exp_f32 v67, v67
  v_mfma_f32_32x32x16_bf16 v[8:23], v[128:131], a[224:227], v[8:23]
  ds_read_b128 a[224:227], v1 offset:12288
  v_rcp_f32 v83, v83
  v_exp_f32 v68, v68
  v_rcp_f32 v84, v84
  v_mfma_f32_32x32x16_bf16 v[8:23], v[132:135], a[228:231], v[8:23]
  s_waitcnt lgkmcnt(1)
  ds_read_b128 a[228:231], v1 offset:13312
  v_exp_f32 v69, v69
  v_rcp_f32 v85, v85
  v_exp_f32 v70, v70
  v_mfma_f32_32x32x16_bf16 v[8:23], v[136:139], a[232:235], v[8:23]
  ds_read_b128 a[232:235], v1 offset:14336
  v_rcp_f32 v86, v86
  v_exp_f32 v71, v71
  v_rcp_f32 v87, v87
  v_mfma_f32_32x32x16_bf16 v[8:23], v[140:143], a[236:239], v[8:23]
  ds_read_b128 a[236:239], v1 offset:15360
  v_accvgpr_write_b32 a144, v104
  v_accvgpr_write_b32 a145, v105
  v_accvgpr_write_b32 a146, v106
  v_accvgpr_write_b32 a147, v107
  v_accvgpr_write_b32 a148, v108
  v_accvgpr_write_b32 a149, v109
  v_accvgpr_write_b32 a150, v110
  v_accvgpr_write_b32 a151, v111
  v_pk_mul_f32 v[72:73], v[72:73], v[24:25]
  v_pk_mul_f32 v[74:75], v[74:75], v[26:27]
  v_pk_mul_f32 v[76:77], v[76:77], v[28:29]
  v_pk_mul_f32 v[78:79], v[78:79], v[30:31]
  v_pk_mul_f32 v[80:81], v[80:81], v[32:33]
  v_pk_mul_f32 v[82:83], v[82:83], v[34:35]
  v_pk_mul_f32 v[84:85], v[84:85], v[36:37]
  v_pk_mul_f32 v[86:87], v[86:87], v[38:39]
  v_pk_add_f32 v[56:57], v[56:57], 1.0 op_sel_hi:[1,0]
  v_pk_add_f32 v[58:59], v[58:59], 1.0 op_sel_hi:[1,0]
  v_pk_add_f32 v[60:61], v[60:61], 1.0 op_sel_hi:[1,0]
  v_pk_add_f32 v[62:63], v[62:63], 1.0 op_sel_hi:[1,0]
  v_pk_add_f32 v[64:65], v[64:65], 1.0 op_sel_hi:[1,0]
  v_pk_add_f32 v[66:67], v[66:67], 1.0 op_sel_hi:[1,0]
  v_pk_add_f32 v[68:69], v[68:69], 1.0 op_sel_hi:[1,0]
  v_pk_add_f32 v[70:71], v[70:71], 1.0 op_sel_hi:[1,0]
  v_pk_fma_f32 v[88:89], v[72:73], v[72:73], v[88:89]
  v_pk_fma_f32 v[90:91], v[74:75], v[74:75], v[90:91]
  v_pk_fma_f32 v[92:93], v[76:77], v[76:77], v[92:93]
  v_pk_fma_f32 v[94:95], v[78:79], v[78:79], v[94:95]
  v_pk_fma_f32 v[96:97], v[80:81], v[80:81], v[96:97]
  v_pk_fma_f32 v[98:99], v[82:83], v[82:83], v[98:99]
  v_pk_fma_f32 v[100:101], v[84:85], v[84:85], v[100:101]
  v_pk_fma_f32 v[102:103], v[86:87], v[86:87], v[102:103]
  v_cvt_pk_bf16_f32 v104, v72, v73
  v_cvt_pk_bf16_f32 v105, v74, v75
  v_cvt_pk_bf16_f32 v106, v76, v77
  v_cvt_pk_bf16_f32 v107, v78, v79
  v_cvt_pk_bf16_f32 v108, v80, v81
  v_cvt_pk_bf16_f32 v109, v82, v83
  v_cvt_pk_bf16_f32 v110, v84, v85
  v_cvt_pk_bf16_f32 v111, v86, v87
  v_pk_fma_f32 v[72:73], v[8:9], v[8:9], s[50:51] neg_lo:[1,0,0] neg_hi:[1,0,0]
  v_pk_fma_f32 v[74:75], v[10:11], v[10:11], s[50:51] neg_lo:[1,0,0] neg_hi:[1,0,0]
  v_pk_fma_f32 v[76:77], v[12:13], v[12:13], s[50:51] neg_lo:[1,0,0] neg_hi:[1,0,0]
  v_pk_fma_f32 v[78:79], v[14:15], v[14:15], s[50:51] neg_lo:[1,0,0] neg_hi:[1,0,0]
  v_pk_fma_f32 v[80:81], v[16:17], v[16:17], s[50:51] neg_lo:[1,0,0] neg_hi:[1,0,0]
  v_pk_fma_f32 v[82:83], v[18:19], v[18:19], s[50:51] neg_lo:[1,0,0] neg_hi:[1,0,0]
  v_pk_fma_f32 v[84:85], v[20:21], v[20:21], s[50:51] neg_lo:[1,0,0] neg_hi:[1,0,0]
  v_pk_fma_f32 v[86:87], v[22:23], v[22:23], s[50:51] neg_lo:[1,0,0] neg_hi:[1,0,0]
  v_pk_mul_f32 v[72:73], v[72:73], v[8:9]
  v_pk_mul_f32 v[74:75], v[74:75], v[10:11]
  v_pk_mul_f32 v[76:77], v[76:77], v[12:13]
  v_pk_mul_f32 v[78:79], v[78:79], v[14:15]
  v_pk_mul_f32 v[80:81], v[80:81], v[16:17]
  v_pk_mul_f32 v[82:83], v[82:83], v[18:19]
  v_pk_mul_f32 v[84:85], v[84:85], v[20:21]
  v_pk_mul_f32 v[86:87], v[86:87], v[22:23]
  s_waitcnt lgkmcnt(2)
  v_mfma_f32_32x32x16_bf16 v[24:39], a[240:243], a[224:227], 0
  ds_read_b128 a[224:227], v1 offset:16384
  v_exp_f32 v72, v72
  v_rcp_f32 v56, v56
  v_add_u32 v4, 64, v4
  s_add_u32 m0, s56, 0
  v_mfma_f32_32x32x16_bf16 v[24:39], a[244:247], a[228:231], v[24:39]
  s_waitcnt lgkmcnt(1)
  buffer_load_dwordx4 v4, s[28:31], s72 offen offset:0 lds
  ds_read_b128 a[228:231], v1 offset:17408
  v_exp_f32 v73, v73
  v_rcp_f32 v57, v57
  v_exp_f32 v74, v74
  v_mfma_f32_32x32x16_bf16 v[24:39], a[248:251], a[232:235], v[24:39]
  ds_read_b128 a[232:235], v1 offset:18432
  v_rcp_f32 v58, v58
  v_exp_f32 v75, v75
  v_rcp_f32 v59, v59
  v_mfma_f32_32x32x16_bf16 v[24:39], a[252:255], a[236:239], v[24:39]
  s_waitcnt lgkmcnt(1)
  ds_read_b128 a[236:239], v1 offset:19456
  v_exp_f32 v76, v76
  v_rcp_f32 v60, v60
  v_exp_f32 v77, v77
  v_mfma_f32_32x32x16_bf16 v[24:39], v[112:115], a[224:227], v[24:39]
  buffer_load_dwordx4 v4, s[28:31], s73 offen offset:1024 lds
  ds_read_b128 a[224:227], v1 offset:20480
  v_rcp_f32 v61, v61
  v_exp_f32 v78, v78
  v_rcp_f32 v62, v62
  v_mfma_f32_32x32x16_bf16 v[24:39], v[116:119], a[228:231], v[24:39]
  s_waitcnt lgkmcnt(1)
  ds_read_b128 a[228:231], v1 offset:21504
  v_exp_f32 v79, v79
  v_rcp_f32 v63, v63
  v_exp_f32 v80, v80
  v_mfma_f32_32x32x16_bf16 v[24:39], v[120:123], a[232:235], v[24:39]
  ds_read_b128 a[232:235], v1 offset:22528
  v_rcp_f32 v64, v64
  v_exp_f32 v81, v81
  v_rcp_f32 v65, v65
  v_mfma_f32_32x32x16_bf16 v[24:39], v[124:127], a[236:239], v[24:39]
  s_waitcnt lgkmcnt(1)
  buffer_load_dwordx4 v4, s[28:31], s74 offen offset:2048 lds
  ds_read_b128 a[236:239], v1 offset:23552
  v_exp_f32 v82, v82
  v_rcp_f32 v66, v66
  v_exp_f32 v83, v83
  v_mfma_f32_32x32x16_bf16 v[24:39], v[128:131], a[224:227], v[24:39]
  ds_read_b128 a[224:227], v1 offset:24576
  v_rcp_f32 v67, v67
  v_exp_f32 v84, v84
  v_rcp_f32 v68, v68
  v_mfma_f32_32x32x16_bf16 v[24:39], v[132:135], a[228:231], v[24:39]
  s_waitcnt lgkmcnt(1)
  ds_read_b128 a[228:231], v1 offset:25600
  v_exp_f32 v85, v85
  v_rcp_f32 v69, v69
  v_exp_f32 v86, v86
  v_mfma_f32_32x32x16_bf16 v[24:39], v[136:139], a[232:235], v[24:39]
  buffer_load_dwordx4 v4, s[28:31], s75 offen offset:3072 lds
  ds_read_b128 a[232:235], v1 offset:26624
  v_rcp_f32 v70, v70
  v_exp_f32 v87, v87
  v_rcp_f32 v71, v71
  v_mfma_f32_32x32x16_bf16 v[24:39], v[140:143], a[236:239], v[24:39]
  ds_read_b128 a[236:239], v1 offset:27648
  v_accvgpr_write_b32 a152, v104
  v_accvgpr_write_b32 a153, v105
  v_accvgpr_write_b32 a154, v106
  v_accvgpr_write_b32 a155, v107
  v_accvgpr_write_b32 a156, v108
  v_accvgpr_write_b32 a157, v109
  v_accvgpr_write_b32 a158, v110
  v_accvgpr_write_b32 a159, v111
  v_pk_mul_f32 v[56:57], v[56:57], v[40:41]
  v_pk_mul_f32 v[58:59], v[58:59], v[42:43]
  v_pk_mul_f32 v[60:61], v[60:61], v[44:45]
  v_pk_mul_f32 v[62:63], v[62:63], v[46:47]
  v_pk_mul_f32 v[64:65], v[64:65], v[48:49]
  v_pk_mul_f32 v[66:67], v[66:67], v[50:51]
  v_pk_mul_f32 v[68:69], v[68:69], v[52:53]
  v_pk_mul_f32 v[70:71], v[70:71], v[54:55]
  v_pk_add_f32 v[72:73], v[72:73], 1.0 op_sel_hi:[1,0]
  v_pk_add_f32 v[74:75], v[74:75], 1.0 op_sel_hi:[1,0]
  v_pk_add_f32 v[76:77], v[76:77], 1.0 op_sel_hi:[1,0]
  v_pk_add_f32 v[78:79], v[78:79], 1.0 op_sel_hi:[1,0]
  v_pk_add_f32 v[80:81], v[80:81], 1.0 op_sel_hi:[1,0]
  v_pk_add_f32 v[82:83], v[82:83], 1.0 op_sel_hi:[1,0]
  v_pk_add_f32 v[84:85], v[84:85], 1.0 op_sel_hi:[1,0]
  v_pk_add_f32 v[86:87], v[86:87], 1.0 op_sel_hi:[1,0]
  v_pk_fma_f32 v[88:89], v[56:57], v[56:57], v[88:89]
  v_pk_fma_f32 v[90:91], v[58:59], v[58:59], v[90:91]
  v_pk_fma_f32 v[92:93], v[60:61], v[60:61], v[92:93]
  v_pk_fma_f32 v[94:95], v[62:63], v[62:63], v[94:95]
  v_pk_fma_f32 v[96:97], v[64:65], v[64:65], v[96:97]
  v_pk_fma_f32 v[98:99], v[66:67], v[66:67], v[98:99]
  v_pk_fma_f32 v[100:101], v[68:69], v[68:69], v[100:101]
  v_pk_fma_f32 v[102:103], v[70:71], v[70:71], v[102:103]
  v_cvt_pk_bf16_f32 v104, v56, v57
  v_cvt_pk_bf16_f32 v105, v58, v59
  v_cvt_pk_bf16_f32 v106, v60, v61
  v_cvt_pk_bf16_f32 v107, v62, v63
  v_cvt_pk_bf16_f32 v108, v64, v65
  v_cvt_pk_bf16_f32 v109, v66, v67
  v_cvt_pk_bf16_f32 v110, v68, v69
  v_cvt_pk_bf16_f32 v111, v70, v71
  v_pk_fma_f32 v[56:57], v[24:25], v[24:25], s[50:51] neg_lo:[1,0,0] neg_hi:[1,0,0]
  v_pk_fma_f32 v[58:59], v[26:27], v[26:27], s[50:51] neg_lo:[1,0,0] neg_hi:[1,0,0]
  v_pk_fma_f32 v[60:61], v[28:29], v[28:29], s[50:51] neg_lo:[1,0,0] neg_hi:[1,0,0]
  v_pk_fma_f32 v[62:63], v[30:31], v[30:31], s[50:51] neg_lo:[1,0,0] neg_hi:[1,0,0]
  v_pk_fma_f32 v[64:65], v[32:33], v[32:33], s[50:51] neg_lo:[1,0,0] neg_hi:[1,0,0]
  v_pk_fma_f32 v[66:67], v[34:35], v[34:35], s[50:51] neg_lo:[1,0,0] neg_hi:[1,0,0]
  v_pk_fma_f32 v[68:69], v[36:37], v[36:37], s[50:51] neg_lo:[1,0,0] neg_hi:[1,0,0]
  v_pk_fma_f32 v[70:71], v[38:39], v[38:39], s[50:51] neg_lo:[1,0,0] neg_hi:[1,0,0]
  v_pk_mul_f32 v[56:57], v[56:57], v[24:25]
  v_pk_mul_f32 v[58:59], v[58:59], v[26:27]
  v_pk_mul_f32 v[60:61], v[60:61], v[28:29]
  v_pk_mul_f32 v[62:63], v[62:63], v[30:31]
  v_pk_mul_f32 v[64:65], v[64:65], v[32:33]
  v_pk_mul_f32 v[66:67], v[66:67], v[34:35]
  v_pk_mul_f32 v[68:69], v[68:69], v[36:37]
  v_pk_mul_f32 v[70:71], v[70:71], v[38:39]
  s_waitcnt lgkmcnt(2)
  v_mfma_f32_32x32x16_bf16 v[40:55], a[240:243], a[224:227], 0
  ds_read_b128 a[224:227], v1 offset:28672
  v_exp_f32 v56, v56
  v_add_f32_dpp v88, v88, v88 row_ror:8 row_mask:0xf bank_mask:0x3
  v_rcp_f32 v72, v72
  v_add_f32_dpp v89, v89, v89 row_ror:8 row_mask:0xf bank_mask:0x3
  v_exp_f32 v57, v57
  v_add_f32_dpp v90, v90, v90 row_ror:8 row_mask:0xf bank_mask:0x3
  s_add_u32 m0, s56, 4096
  v_mfma_f32_32x32x16_bf16 v[40:55], a[244:247], a[228:231], v[40:55]
  s_waitcnt lgkmcnt(1)
  buffer_load_dwordx4 v4, s[28:31], s76 offen offset:0 lds
  ds_read_b128 a[228:231], v1 offset:29696
  v_rcp_f32 v73, v73
  v_add_f32_dpp v91, v91, v91 row_ror:8 row_mask:0xf bank_mask:0x3
  v_exp_f32 v58, v58
  v_add_f32_dpp v92, v92, v92 row_ror:8 row_mask:0xf bank_mask:0x3
  v_rcp_f32 v74, v74
  v_add_f32_dpp v93, v93, v93 row_ror:8 row_mask:0xf bank_mask:0x3
  v_mfma_f32_32x32x16_bf16 v[40:55], a[248:251], a[232:235], v[40:55]
  ds_read_b128 a[232:235], v1 offset:30720
  v_exp_f32 v59, v59
  v_add_f32_dpp v94, v94, v94 row_ror:8 row_mask:0xf bank_mask:0x3
  v_add_f32_dpp v95, v95, v95 row_ror:8 row_mask:0xf bank_mask:0x3
  v_rcp_f32 v75, v75
  v_add_f32_dpp v88, v96, v96 row_ror:8 row_mask:0xf bank_mask:0xc
  v_exp_f32 v60, v60
  v_mfma_f32_32x32x16_bf16 v[40:55], a[252:255], a[236:239], v[40:55]
  s_waitcnt lgkmcnt(1)
  ds_read_b128 a[236:239], v1 offset:31744
  v_add_f32_dpp v89, v97, v97 row_ror:8 row_mask:0xf bank_mask:0xc
  v_rcp_f32 v76, v76
  v_add_f32_dpp v90, v98, v98 row_ror:8 row_mask:0xf bank_mask:0xc
  v_exp_f32 v61, v61
  v_add_f32_dpp v91, v99, v99 row_ror:8 row_mask:0xf bank_mask:0xc
  v_rcp_f32 v77, v77
  v_add_f32_dpp v92, v100, v100 row_ror:8 row_mask:0xf bank_mask:0xc
  v_mfma_f32_32x32x16_bf16 v[40:55], v[112:115], a[224:227], v[40:55]
  buffer_load_dwordx4 v4, s[28:31], s77 offen offset:1024 lds
  ds_read_b128 a[224:227], v1 offset:32768
  v_exp_f32 v62, v62
  v_add_f32_dpp v93, v101, v101 row_ror:8 row_mask:0xf bank_mask:0xc
  v_add_f32_dpp v94, v102, v102 row_ror:8 row_mask:0xf bank_mask:0xc
  v_rcp_f32 v78, v78
  v_add_f32_dpp v95, v103, v103 row_ror:8 row_mask:0xf bank_mask:0xc
  v_exp_f32 v63, v63
  v_mfma_f32_32x32x16_bf16 v[40:55], v[116:119], a[228:231], v[40:55]
  s_waitcnt lgkmcnt(1)
  ds_read_b128 a[228:231], v1 offset:33792
  v_add_f32_dpp v88, v88, v88 row_shl:4 row_mask:0xf bank_mask:0x5
  v_rcp_f32 v79, v79
  v_add_f32_dpp v89, v89, v89 row_shl:4 row_mask:0xf bank_mask:0x5
  v_exp_f32 v64, v64
  v_add_f32_dpp v90, v90, v90 row_shl:4 row_mask:0xf bank_mask:0x5
  v_rcp_f32 v80, v80
  v_mfma_f32_32x32x16_bf16 v[40:55], v[120:123], a[232:235], v[40:55]
  ds_read_b128 a[232:235], v1 offset:34816
  v_add_f32_dpp v91, v91, v91 row_shl:4 row_mask:0xf bank_mask:0x5
  v_exp_f32 v65, v65
  v_add_f32_dpp v88, v92, v92 row_shr:4 row_mask:0xf bank_mask:0xa
  v_rcp_f32 v81, v81
  v_add_f32_dpp v89, v93, v93 row_shr:4 row_mask:0xf bank_mask:0xa
  v_add_f32_dpp v90, v94, v94 row_shr:4 row_mask:0xf bank_mask:0xa
  v_mfma_f32_32x32x16_bf16 v[40:55], v[124:127], a[236:239], v[40:55]
  s_waitcnt lgkmcnt(1)
  buffer_load_dwordx4 v4, s[28:31], s78 offen offset:2048 lds
  ds_read_b128 a[236:239], v1 offset:35840
  v_exp_f32 v66, v66
  v_add_f32_dpp v91, v95, v95 row_shr:4 row_mask:0xf bank_mask:0xa
  v_rcp_f32 v82, v82
  v_add_f32_dpp v92, v88, v88 quad_perm:[2,3,0,1] row_mask:0xf bank_mask:0xf
  v_exp_f32 v67, v67
  v_add_f32_dpp v93, v89, v89 quad_perm:[2,3,0,1] row_mask:0xf bank_mask:0xf
  v_rcp_f32 v83, v83
  v_mfma_f32_32x32x16_bf16 v[40:55], v[128:131], a[224:227], v[40:55]
  ds_read_b128 a[224:227], v2 offset:0
  v_add_f32_dpp v94, v90, v90 quad_perm:[2,3,0,1] row_mask:0xf bank_mask:0xf
  v_exp_f32 v68, v68
  v_add_f32_dpp v95, v91, v91 quad_perm:[2,3,0,1] row_mask:0xf bank_mask:0xf
  v_rcp_f32 v84, v84
  v_cndmask_b32 v88, v92, v94, s[64:65]
  v_cndmask_b32 v89, v93, v95, s[64:65]
  v_mfma_f32_32x32x16_bf16 v[40:55], v[132:135], a[228:231], v[40:55]
  s_waitcnt lgkmcnt(1)
  ds_read_b128 a[228:231], v2 offset:1024
  v_exp_f32 v69, v69
  v_add_f32_dpp v90, v88, v88 quad_perm:[1,0,3,2] row_mask:0xf bank_mask:0xf
  v_rcp_f32 v85, v85
  v_add_f32_dpp v91, v89, v89 quad_perm:[1,0,3,2] row_mask:0xf bank_mask:0xf
  v_exp_f32 v70, v70
  v_cndmask_b32 v92, v90, v91, s[58:59]
  v_mfma_f32_32x32x16_bf16 v[40:55], v[136:139], a[232:235], v[40:55]
  buffer_load_dwordx4 v4, s[28:31], s79 offen offset:3072 lds
  ds_read_b128 a[232:235], v2 offset:2048
  v_rcp_f32 v86, v86
  v_mov_b32 v6, v92
  v_exp_f32 v71, v71
  s_nop 0
  v_permlane16_swap_b32 v92, v6
  v_rcp_f32 v87, v87
  v_add_f32_e64 v6, v6, v92
  s_mov_b32 exec_lo, 0xffff
  s_mov_b32 exec_hi, 0xffff
  buffer_atomic_add_f32 v6, v5, s[4:7], 0 offen offset:256
  s_mov_b64 exec, -1
  v_mfma_f32_32x32x16_bf16 v[40:55], v[140:143], a[236:239], v[40:55]
  ds_read_b128 a[236:239], v2 offset:3072
  v_accvgpr_write_b32 a160, v104
  v_accvgpr_write_b32 a161, v105
  v_accvgpr_write_b32 a162, v106
  v_accvgpr_write_b32 a163, v107
  v_accvgpr_write_b32 a164, v108
  v_accvgpr_write_b32 a165, v109
  v_accvgpr_write_b32 a166, v110
  v_accvgpr_write_b32 a167, v111
  v_pk_mul_f32 v[72:73], v[72:73], v[8:9]
  v_pk_mul_f32 v[74:75], v[74:75], v[10:11]
  v_pk_mul_f32 v[76:77], v[76:77], v[12:13]
  v_pk_mul_f32 v[78:79], v[78:79], v[14:15]
  v_pk_mul_f32 v[80:81], v[80:81], v[16:17]
  v_pk_mul_f32 v[82:83], v[82:83], v[18:19]
  v_pk_mul_f32 v[84:85], v[84:85], v[20:21]
  v_pk_mul_f32 v[86:87], v[86:87], v[22:23]
  v_pk_add_f32 v[56:57], v[56:57], 1.0 op_sel_hi:[1,0]
  v_pk_add_f32 v[58:59], v[58:59], 1.0 op_sel_hi:[1,0]
  v_pk_add_f32 v[60:61], v[60:61], 1.0 op_sel_hi:[1,0]
  v_pk_add_f32 v[62:63], v[62:63], 1.0 op_sel_hi:[1,0]
  v_pk_add_f32 v[64:65], v[64:65], 1.0 op_sel_hi:[1,0]
  v_pk_add_f32 v[66:67], v[66:67], 1.0 op_sel_hi:[1,0]
  v_pk_add_f32 v[68:69], v[68:69], 1.0 op_sel_hi:[1,0]
  v_pk_add_f32 v[70:71], v[70:71], 1.0 op_sel_hi:[1,0]
  v_pk_mul_f32 v[88:89], v[72:73], v[72:73]
  v_pk_mul_f32 v[90:91], v[74:75], v[74:75]
  v_pk_mul_f32 v[92:93], v[76:77], v[76:77]
  v_pk_mul_f32 v[94:95], v[78:79], v[78:79]
  v_pk_mul_f32 v[96:97], v[80:81], v[80:81]
  v_pk_mul_f32 v[98:99], v[82:83], v[82:83]
  v_pk_mul_f32 v[100:101], v[84:85], v[84:85]
  v_pk_mul_f32 v[102:103], v[86:87], v[86:87]
  v_cvt_pk_bf16_f32 v104, v72, v73
  v_cvt_pk_bf16_f32 v105, v74, v75
  v_cvt_pk_bf16_f32 v106, v76, v77
  v_cvt_pk_bf16_f32 v107, v78, v79
  v_cvt_pk_bf16_f32 v108, v80, v81
  v_cvt_pk_bf16_f32 v109, v82, v83
  v_cvt_pk_bf16_f32 v110, v84, v85
  v_cvt_pk_bf16_f32 v111, v86, v87
  v_pk_fma_f32 v[72:73], v[40:41], v[40:41], s[50:51] neg_lo:[1,0,0] neg_hi:[1,0,0]
  v_pk_fma_f32 v[74:75], v[42:43], v[42:43], s[50:51] neg_lo:[1,0,0] neg_hi:[1,0,0]
  v_pk_fma_f32 v[76:77], v[44:45], v[44:45], s[50:51] neg_lo:[1,0,0] neg_hi:[1,0,0]
  v_pk_fma_f32 v[78:79], v[46:47], v[46:47], s[50:51] neg_lo:[1,0,0] neg_hi:[1,0,0]
  v_pk_fma_f32 v[80:81], v[48:49], v[48:49], s[50:51] neg_lo:[1,0,0] neg_hi:[1,0,0]
  v_pk_fma_f32 v[82:83], v[50:51], v[50:51], s[50:51] neg_lo:[1,0,0] neg_hi:[1,0,0]
  v_pk_fma_f32 v[84:85], v[52:53], v[52:53], s[50:51] neg_lo:[1,0,0] neg_hi:[1,0,0]
  v_pk_fma_f32 v[86:87], v[54:55], v[54:55], s[50:51] neg_lo:[1,0,0] neg_hi:[1,0,0]
  v_pk_mul_f32 v[72:73], v[72:73], v[40:41]
  v_pk_mul_f32 v[74:75], v[74:75], v[42:43]
  v_pk_mul_f32 v[76:77], v[76:77], v[44:45]
  v_pk_mul_f32 v[78:79], v[78:79], v[46:47]
  v_pk_mul_f32 v[80:81], v[80:81], v[48:49]
  v_pk_mul_f32 v[82:83], v[82:83], v[50:51]
  v_pk_mul_f32 v[84:85], v[84:85], v[52:53]
  v_pk_mul_f32 v[86:87], v[86:87], v[54:55]
  s_waitcnt lgkmcnt(2)
  v_mfma_f32_32x32x16_bf16 v[8:23], a[240:243], a[224:227], 0
  ds_read_b128 a[224:227], v2 offset:4096
  v_exp_f32 v72, v72
  v_rcp_f32 v56, v56
  s_add_u32 m0, s56, 8192
  v_mfma_f32_32x32x16_bf16 v[8:23], a[244:247], a[228:231], v[8:23]
  s_waitcnt lgkmcnt(1)
  buffer_load_dwordx4 v4, s[28:31], s80 offen offset:0 lds
  ds_read_b128 a[228:231], v2 offset:5120
  v_exp_f32 v73, v73
  v_rcp_f32 v57, v57
  v_exp_f32 v74, v74
  v_mfma_f32_32x32x16_bf16 v[8:23], a[248:251], a[232:235], v[8:23]
  ds_read_b128 a[232:235], v2 offset:6144
  v_rcp_f32 v58, v58
  v_exp_f32 v75, v75
  v_rcp_f32 v59, v59
  v_mfma_f32_32x32x16_bf16 v[8:23], a[252:255], a[236:239], v[8:23]
  s_waitcnt lgkmcnt(1)
  ds_read_b128 a[236:239], v2 offset:7168
  v_exp_f32 v76, v76
  v_rcp_f32 v60, v60
  v_exp_f32 v77, v77
  v_mfma_f32_32x32x16_bf16 v[8:23], v[112:115], a[224:227], v[8:23]
  buffer_load_dwordx4 v4, s[28:31], s81 offen offset:1024 lds
  ds_read_b128 a[224:227], v2 offset:8192
  v_rcp_f32 v61, v61
  v_exp_f32 v78, v78
  v_rcp_f32 v62, v62
  v_mfma_f32_32x32x16_bf16 v[8:23], v[116:119], a[228:231], v[8:23]
  s_waitcnt lgkmcnt(1)
  ds_read_b128 a[228:231], v2 offset:9216
  v_exp_f32 v79, v79
  v_rcp_f32 v63, v63
  v_exp_f32 v80, v80
  v_mfma_f32_32x32x16_bf16 v[8:23], v[120:123], a[232:235], v[8:23]
  ds_read_b128 a[232:235], v2 offset:10240
  v_rcp_f32 v64, v64
  v_exp_f32 v81, v81
  v_rcp_f32 v65, v65
  v_mfma_f32_32x32x16_bf16 v[8:23], v[124:127], a[236:239], v[8:23]
  s_waitcnt lgkmcnt(1)
  buffer_load_dwordx4 v4, s[28:31], s82 offen offset:2048 lds
  ds_read_b128 a[236:239], v2 offset:11264
  v_exp_f32 v82, v82
  v_rcp_f32 v66, v66
  v_exp_f32 v83, v83
  v_mfma_f32_32x32x16_bf16 v[8:23], v[128:131], a[224:227], v[8:23]
  ds_read_b128 a[224:227], v2 offset:12288
  v_rcp_f32 v67, v67
  v_exp_f32 v84, v84
  v_rcp_f32 v68, v68
  v_mfma_f32_32x32x16_bf16 v[8:23], v[132:135], a[228:231], v[8:23]
  s_waitcnt lgkmcnt(1)
  ds_read_b128 a[228:231], v2 offset:13312
  v_exp_f32 v85, v85
  v_rcp_f32 v69, v69
  v_exp_f32 v86, v86
  v_mfma_f32_32x32x16_bf16 v[8:23], v[136:139], a[232:235], v[8:23]
  buffer_load_dwordx4 v4, s[28:31], s83 offen offset:3072 lds
  ds_read_b128 a[232:235], v2 offset:14336
  v_rcp_f32 v70, v70
  v_exp_f32 v87, v87
  v_rcp_f32 v71, v71
  v_mfma_f32_32x32x16_bf16 v[8:23], v[140:143], a[236:239], v[8:23]
  ds_read_b128 a[236:239], v2 offset:15360
  v_accvgpr_write_b32 a168, v104
  v_accvgpr_write_b32 a169, v105
  v_accvgpr_write_b32 a170, v106
  v_accvgpr_write_b32 a171, v107
  v_accvgpr_write_b32 a172, v108
  v_accvgpr_write_b32 a173, v109
  v_accvgpr_write_b32 a174, v110
  v_accvgpr_write_b32 a175, v111
  v_pk_mul_f32 v[56:57], v[56:57], v[24:25]
  v_pk_mul_f32 v[58:59], v[58:59], v[26:27]
  v_pk_mul_f32 v[60:61], v[60:61], v[28:29]
  v_pk_mul_f32 v[62:63], v[62:63], v[30:31]
  v_pk_mul_f32 v[64:65], v[64:65], v[32:33]
  v_pk_mul_f32 v[66:67], v[66:67], v[34:35]
  v_pk_mul_f32 v[68:69], v[68:69], v[36:37]
  v_pk_mul_f32 v[70:71], v[70:71], v[38:39]
  v_pk_add_f32 v[72:73], v[72:73], 1.0 op_sel_hi:[1,0]
  v_pk_add_f32 v[74:75], v[74:75], 1.0 op_sel_hi:[1,0]
  v_pk_add_f32 v[76:77], v[76:77], 1.0 op_sel_hi:[1,0]
  v_pk_add_f32 v[78:79], v[78:79], 1.0 op_sel_hi:[1,0]
  v_pk_add_f32 v[80:81], v[80:81], 1.0 op_sel_hi:[1,0]
  v_pk_add_f32 v[82:83], v[82:83], 1.0 op_sel_hi:[1,0]
  v_pk_add_f32 v[84:85], v[84:85], 1.0 op_sel_hi:[1,0]
  v_pk_add_f32 v[86:87], v[86:87], 1.0 op_sel_hi:[1,0]
  v_pk_fma_f32 v[88:89], v[56:57], v[56:57], v[88:89]
  v_pk_fma_f32 v[90:91], v[58:59], v[58:59], v[90:91]
  v_pk_fma_f32 v[92:93], v[60:61], v[60:61], v[92:93]
  v_pk_fma_f32 v[94:95], v[62:63], v[62:63], v[94:95]
  v_pk_fma_f32 v[96:97], v[64:65], v[64:65], v[96:97]
  v_pk_fma_f32 v[98:99], v[66:67], v[66:67], v[98:99]
  v_pk_fma_f32 v[100:101], v[68:69], v[68:69], v[100:101]
  v_pk_fma_f32 v[102:103], v[70:71], v[70:71], v[102:103]
  v_cvt_pk_bf16_f32 v104, v56, v57
  v_cvt_pk_bf16_f32 v105, v58, v59
  v_cvt_pk_bf16_f32 v106, v60, v61
  v_cvt_pk_bf16_f32 v107, v62, v63
  v_cvt_pk_bf16_f32 v108, v64, v65
  v_cvt_pk_bf16_f32 v109, v66, v67
  v_cvt_pk_bf16_f32 v110, v68, v69
  v_cvt_pk_bf16_f32 v111, v70, v71
  v_pk_fma_f32 v[56:57], v[8:9], v[8:9], s[50:51] neg_lo:[1,0,0] neg_hi:[1,0,0]
  v_pk_fma_f32 v[58:59], v[10:11], v[10:11], s[50:51] neg_lo:[1,0,0] neg_hi:[1,0,0]
  v_pk_fma_f32 v[60:61], v[12:13], v[12:13], s[50:51] neg_lo:[1,0,0] neg_hi:[1,0,0]
  v_pk_fma_f32 v[62:63], v[14:15], v[14:15], s[50:51] neg_lo:[1,0,0] neg_hi:[1,0,0]
  v_pk_fma_f32 v[64:65], v[16:17], v[16:17], s[50:51] neg_lo:[1,0,0] neg_hi:[1,0,0]
  v_pk_fma_f32 v[66:67], v[18:19], v[18:19], s[50:51] neg_lo:[1,0,0] neg_hi:[1,0,0]
  v_pk_fma_f32 v[68:69], v[20:21], v[20:21], s[50:51] neg_lo:[1,0,0] neg_hi:[1,0,0]
  v_pk_fma_f32 v[70:71], v[22:23], v[22:23], s[50:51] neg_lo:[1,0,0] neg_hi:[1,0,0]
  v_pk_mul_f32 v[56:57], v[56:57], v[8:9]
  v_pk_mul_f32 v[58:59], v[58:59], v[10:11]
  v_pk_mul_f32 v[60:61], v[60:61], v[12:13]
  v_pk_mul_f32 v[62:63], v[62:63], v[14:15]
  v_pk_mul_f32 v[64:65], v[64:65], v[16:17]
  v_pk_mul_f32 v[66:67], v[66:67], v[18:19]
  v_pk_mul_f32 v[68:69], v[68:69], v[20:21]
  v_pk_mul_f32 v[70:71], v[70:71], v[22:23]
  s_waitcnt lgkmcnt(2)
  v_mfma_f32_32x32x16_bf16 v[24:39], a[240:243], a[224:227], 0
  ds_read_b128 a[224:227], v2 offset:16384
  v_exp_f32 v56, v56
  v_rcp_f32 v72, v72
  v_mfma_f32_32x32x16_bf16 v[24:39], a[244:247], a[228:231], v[24:39]
  s_waitcnt lgkmcnt(1)
  ds_read_b128 a[228:231], v2 offset:17408
  v_exp_f32 v57, v57
  v_rcp_f32 v73, v73
  v_exp_f32 v58, v58
  v_mfma_f32_32x32x16_bf16 v[24:39], a[248:251], a[232:235], v[24:39]
  ds_read_b128 a[232:235], v2 offset:18432
  v_rcp_f32 v74, v74
  v_exp_f32 v59, v59
  v_rcp_f32 v75, v75
  v_mfma_f32_32x32x16_bf16 v[24:39], a[252:255], a[236:239], v[24:39]
  s_waitcnt lgkmcnt(1)
  ds_read_b128 a[236:239], v2 offset:19456
  v_exp_f32 v60, v60
  v_rcp_f32 v76, v76
  v_exp_f32 v61, v61
  v_mfma_f32_32x32x16_bf16 v[24:39], v[112:115], a[224:227], v[24:39]
  ds_read_b128 a[224:227], v2 offset:20480
  v_rcp_f32 v77, v77
  v_exp_f32 v62, v62
  v_rcp_f32 v78, v78
  v_mfma_f32_32x32x16_bf16 v[24:39], v[116:119], a[228:231], v[24:39]
  s_waitcnt lgkmcnt(1)
  ds_read_b128 a[228:231], v2 offset:21504
  v_exp_f32 v63, v63
  v_rcp_f32 v79, v79
  v_exp_f32 v64, v64
  v_mfma_f32_32x32x16_bf16 v[24:39], v[120:123], a[232:235], v[24:39]
  ds_read_b128 a[232:235], v2 offset:22528
  v_rcp_f32 v80, v80
  v_exp_f32 v65, v65
  v_rcp_f32 v81, v81
  v_mfma_f32_32x32x16_bf16 v[24:39], v[124:127], a[236:239], v[24:39]
  s_waitcnt lgkmcnt(1)
  ds_read_b128 a[236:239], v2 offset:23552
  v_exp_f32 v66, v66
  v_rcp_f32 v82, v82
  v_exp_f32 v67, v67
  v_mfma_f32_32x32x16_bf16 v[24:39], v[128:131], a[224:227], v[24:39]
  ds_read_b128 a[224:227], v2 offset:24576
  v_rcp_f32 v83, v83
  v_exp_f32 v68, v68
  v_rcp_f32 v84, v84
  v_mfma_f32_32x32x16_bf16 v[24:39], v[132:135], a[228:231], v[24:39]
  s_waitcnt lgkmcnt(1)
  ds_read_b128 a[228:231], v2 offset:25600
  v_exp_f32 v69, v69
  v_rcp_f32 v85, v85
  v_exp_f32 v70, v70
  v_mfma_f32_32x32x16_bf16 v[24:39], v[136:139], a[232:235], v[24:39]
  ds_read_b128 a[232:235], v2 offset:26624
  v_rcp_f32 v86, v86
  v_exp_f32 v71, v71
  v_rcp_f32 v87, v87
  v_mfma_f32_32x32x16_bf16 v[24:39], v[140:143], a[236:239], v[24:39]
  ds_read_b128 a[236:239], v2 offset:27648
  v_accvgpr_write_b32 a176, v104
  v_accvgpr_write_b32 a177, v105
  v_accvgpr_write_b32 a178, v106
  v_accvgpr_write_b32 a179, v107
  v_accvgpr_write_b32 a180, v108
  v_accvgpr_write_b32 a181, v109
  v_accvgpr_write_b32 a182, v110
  v_accvgpr_write_b32 a183, v111
  v_pk_mul_f32 v[72:73], v[72:73], v[40:41]
  v_pk_mul_f32 v[74:75], v[74:75], v[42:43]
  v_pk_mul_f32 v[76:77], v[76:77], v[44:45]
  v_pk_mul_f32 v[78:79], v[78:79], v[46:47]
  v_pk_mul_f32 v[80:81], v[80:81], v[48:49]
  v_pk_mul_f32 v[82:83], v[82:83], v[50:51]
  v_pk_mul_f32 v[84:85], v[84:85], v[52:53]
  v_pk_mul_f32 v[86:87], v[86:87], v[54:55]
  v_pk_add_f32 v[56:57], v[56:57], 1.0 op_sel_hi:[1,0]
  v_pk_add_f32 v[58:59], v[58:59], 1.0 op_sel_hi:[1,0]
  v_pk_add_f32 v[60:61], v[60:61], 1.0 op_sel_hi:[1,0]
  v_pk_add_f32 v[62:63], v[62:63], 1.0 op_sel_hi:[1,0]
  v_pk_add_f32 v[64:65], v[64:65], 1.0 op_sel_hi:[1,0]
  v_pk_add_f32 v[66:67], v[66:67], 1.0 op_sel_hi:[1,0]
  v_pk_add_f32 v[68:69], v[68:69], 1.0 op_sel_hi:[1,0]
  v_pk_add_f32 v[70:71], v[70:71], 1.0 op_sel_hi:[1,0]
  v_pk_fma_f32 v[88:89], v[72:73], v[72:73], v[88:89]
  v_pk_fma_f32 v[90:91], v[74:75], v[74:75], v[90:91]
  v_pk_fma_f32 v[92:93], v[76:77], v[76:77], v[92:93]
  v_pk_fma_f32 v[94:95], v[78:79], v[78:79], v[94:95]
  v_pk_fma_f32 v[96:97], v[80:81], v[80:81], v[96:97]
  v_pk_fma_f32 v[98:99], v[82:83], v[82:83], v[98:99]
  v_pk_fma_f32 v[100:101], v[84:85], v[84:85], v[100:101]
  v_pk_fma_f32 v[102:103], v[86:87], v[86:87], v[102:103]
  v_cvt_pk_bf16_f32 v104, v72, v73
  v_cvt_pk_bf16_f32 v105, v74, v75
  v_cvt_pk_bf16_f32 v106, v76, v77
  v_cvt_pk_bf16_f32 v107, v78, v79
  v_cvt_pk_bf16_f32 v108, v80, v81
  v_cvt_pk_bf16_f32 v109, v82, v83
  v_cvt_pk_bf16_f32 v110, v84, v85
  v_cvt_pk_bf16_f32 v111, v86, v87
  v_pk_fma_f32 v[72:73], v[24:25], v[24:25], s[50:51] neg_lo:[1,0,0] neg_hi:[1,0,0]
  v_pk_fma_f32 v[74:75], v[26:27], v[26:27], s[50:51] neg_lo:[1,0,0] neg_hi:[1,0,0]
  v_pk_fma_f32 v[76:77], v[28:29], v[28:29], s[50:51] neg_lo:[1,0,0] neg_hi:[1,0,0]
  v_pk_fma_f32 v[78:79], v[30:31], v[30:31], s[50:51] neg_lo:[1,0,0] neg_hi:[1,0,0]
  v_pk_fma_f32 v[80:81], v[32:33], v[32:33], s[50:51] neg_lo:[1,0,0] neg_hi:[1,0,0]
  v_pk_fma_f32 v[82:83], v[34:35], v[34:35], s[50:51] neg_lo:[1,0,0] neg_hi:[1,0,0]
  v_pk_fma_f32 v[84:85], v[36:37], v[36:37], s[50:51] neg_lo:[1,0,0] neg_hi:[1,0,0]
  v_pk_fma_f32 v[86:87], v[38:39], v[38:39], s[50:51] neg_lo:[1,0,0] neg_hi:[1,0,0]
  v_pk_mul_f32 v[72:73], v[72:73], v[24:25]
  v_pk_mul_f32 v[74:75], v[74:75], v[26:27]
  v_pk_mul_f32 v[76:77], v[76:77], v[28:29]
  v_pk_mul_f32 v[78:79], v[78:79], v[30:31]
  v_pk_mul_f32 v[80:81], v[80:81], v[32:33]
  v_pk_mul_f32 v[82:83], v[82:83], v[34:35]
  v_pk_mul_f32 v[84:85], v[84:85], v[36:37]
  v_pk_mul_f32 v[86:87], v[86:87], v[38:39]
  s_waitcnt lgkmcnt(2)
  v_mfma_f32_32x32x16_bf16 v[40:55], a[240:243], a[224:227], 0
  ds_read_b128 a[224:227], v2 offset:28672
  v_exp_f32 v72, v72
  v_rcp_f32 v56, v56
  v_mfma_f32_32x32x16_bf16 v[40:55], a[244:247], a[228:231], v[40:55]
  s_waitcnt lgkmcnt(1)
  ds_read_b128 a[228:231], v2 offset:29696
  v_exp_f32 v73, v73
  v_rcp_f32 v57, v57
  v_exp_f32 v74, v74
  v_mfma_f32_32x32x16_bf16 v[40:55], a[248:251], a[232:235], v[40:55]
  ds_read_b128 a[232:235], v2 offset:30720
  v_rcp_f32 v58, v58
  v_exp_f32 v75, v75
  v_rcp_f32 v59, v59
  v_mfma_f32_32x32x16_bf16 v[40:55], a[252:255], a[236:239], v[40:55]
  s_waitcnt lgkmcnt(1)
  ds_read_b128 a[236:239], v2 offset:31744
  v_exp_f32 v76, v76
  v_rcp_f32 v60, v60
  v_exp_f32 v77, v77
  v_mfma_f32_32x32x16_bf16 v[40:55], v[112:115], a[224:227], v[40:55]
  ds_read_b128 a[224:227], v2 offset:32768
  v_rcp_f32 v61, v61
  v_exp_f32 v78, v78
  v_rcp_f32 v62, v62
  v_mfma_f32_32x32x16_bf16 v[40:55], v[116:119], a[228:231], v[40:55]
  s_waitcnt lgkmcnt(1)
  ds_read_b128 a[228:231], v2 offset:33792
  v_exp_f32 v79, v79
  v_rcp_f32 v63, v63
  v_exp_f32 v80, v80
  v_mfma_f32_32x32x16_bf16 v[40:55], v[120:123], a[232:235], v[40:55]
  ds_read_b128 a[232:235], v2 offset:34816
  v_rcp_f32 v64, v64
  v_exp_f32 v81, v81
  v_rcp_f32 v65, v65
  v_mfma_f32_32x32x16_bf16 v[40:55], v[124:127], a[236:239], v[40:55]
  s_waitcnt lgkmcnt(1)
  ds_read_b128 a[236:239], v2 offset:35840
  v_exp_f32 v82, v82
  v_rcp_f32 v66, v66
  v_exp_f32 v83, v83
  v_mfma_f32_32x32x16_bf16 v[40:55], v[128:131], a[224:227], v[40:55]
  ds_read_b128 a[224:227], v2 offset:36864
  v_rcp_f32 v67, v67
  v_exp_f32 v84, v84
  v_rcp_f32 v68, v68
  v_mfma_f32_32x32x16_bf16 v[40:55], v[132:135], a[228:231], v[40:55]
  s_waitcnt lgkmcnt(1)
  ds_read_b128 a[228:231], v2 offset:37888
  v_exp_f32 v85, v85
  v_rcp_f32 v69, v69
  v_exp_f32 v86, v86
  v_mfma_f32_32x32x16_bf16 v[40:55], v[136:139], a[232:235], v[40:55]
  ds_read_b128 a[232:235], v2 offset:38912
  v_rcp_f32 v70, v70
  v_exp_f32 v87, v87
  v_rcp_f32 v71, v71
  v_mfma_f32_32x32x16_bf16 v[40:55], v[140:143], a[236:239], v[40:55]
  ds_read_b128 a[236:239], v2 offset:39936
  v_accvgpr_write_b32 a184, v104
  v_accvgpr_write_b32 a185, v105
  v_accvgpr_write_b32 a186, v106
  v_accvgpr_write_b32 a187, v107
  v_accvgpr_write_b32 a188, v108
  v_accvgpr_write_b32 a189, v109
  v_accvgpr_write_b32 a190, v110
  v_accvgpr_write_b32 a191, v111
  v_pk_mul_f32 v[56:57], v[56:57], v[8:9]
  v_pk_mul_f32 v[58:59], v[58:59], v[10:11]
  v_pk_mul_f32 v[60:61], v[60:61], v[12:13]
  v_pk_mul_f32 v[62:63], v[62:63], v[14:15]
  v_pk_mul_f32 v[64:65], v[64:65], v[16:17]
  v_pk_mul_f32 v[66:67], v[66:67], v[18:19]
  v_pk_mul_f32 v[68:69], v[68:69], v[20:21]
  v_pk_mul_f32 v[70:71], v[70:71], v[22:23]
  v_pk_add_f32 v[72:73], v[72:73], 1.0 op_sel_hi:[1,0]
  v_pk_add_f32 v[74:75], v[74:75], 1.0 op_sel_hi:[1,0]
  v_pk_add_f32 v[76:77], v[76:77], 1.0 op_sel_hi:[1,0]
  v_pk_add_f32 v[78:79], v[78:79], 1.0 op_sel_hi:[1,0]
  v_pk_add_f32 v[80:81], v[80:81], 1.0 op_sel_hi:[1,0]
  v_pk_add_f32 v[82:83], v[82:83], 1.0 op_sel_hi:[1,0]
  v_pk_add_f32 v[84:85], v[84:85], 1.0 op_sel_hi:[1,0]
  v_pk_add_f32 v[86:87], v[86:87], 1.0 op_sel_hi:[1,0]
  v_pk_fma_f32 v[88:89], v[56:57], v[56:57], v[88:89]
  v_pk_fma_f32 v[90:91], v[58:59], v[58:59], v[90:91]
  v_pk_fma_f32 v[92:93], v[60:61], v[60:61], v[92:93]
  v_pk_fma_f32 v[94:95], v[62:63], v[62:63], v[94:95]
  v_pk_fma_f32 v[96:97], v[64:65], v[64:65], v[96:97]
  v_pk_fma_f32 v[98:99], v[66:67], v[66:67], v[98:99]
  v_pk_fma_f32 v[100:101], v[68:69], v[68:69], v[100:101]
  v_pk_fma_f32 v[102:103], v[70:71], v[70:71], v[102:103]
  v_cvt_pk_bf16_f32 v104, v56, v57
  v_cvt_pk_bf16_f32 v105, v58, v59
  v_cvt_pk_bf16_f32 v106, v60, v61
  v_cvt_pk_bf16_f32 v107, v62, v63
  v_cvt_pk_bf16_f32 v108, v64, v65
  v_cvt_pk_bf16_f32 v109, v66, v67
  v_cvt_pk_bf16_f32 v110, v68, v69
  v_cvt_pk_bf16_f32 v111, v70, v71
  v_pk_fma_f32 v[56:57], v[40:41], v[40:41], s[50:51] neg_lo:[1,0,0] neg_hi:[1,0,0]
  v_pk_fma_f32 v[58:59], v[42:43], v[42:43], s[50:51] neg_lo:[1,0,0] neg_hi:[1,0,0]
  v_pk_fma_f32 v[60:61], v[44:45], v[44:45], s[50:51] neg_lo:[1,0,0] neg_hi:[1,0,0]
  v_pk_fma_f32 v[62:63], v[46:47], v[46:47], s[50:51] neg_lo:[1,0,0] neg_hi:[1,0,0]
  v_pk_fma_f32 v[64:65], v[48:49], v[48:49], s[50:51] neg_lo:[1,0,0] neg_hi:[1,0,0]
  v_pk_fma_f32 v[66:67], v[50:51], v[50:51], s[50:51] neg_lo:[1,0,0] neg_hi:[1,0,0]
  v_pk_fma_f32 v[68:69], v[52:53], v[52:53], s[50:51] neg_lo:[1,0,0] neg_hi:[1,0,0]
  v_pk_fma_f32 v[70:71], v[54:55], v[54:55], s[50:51] neg_lo:[1,0,0] neg_hi:[1,0,0]
  v_pk_mul_f32 v[56:57], v[56:57], v[40:41]
  v_pk_mul_f32 v[58:59], v[58:59], v[42:43]
  v_pk_mul_f32 v[60:61], v[60:61], v[44:45]
  v_pk_mul_f32 v[62:63], v[62:63], v[46:47]
  v_pk_mul_f32 v[64:65], v[64:65], v[48:49]
  v_pk_mul_f32 v[66:67], v[66:67], v[50:51]
  v_pk_mul_f32 v[68:69], v[68:69], v[52:53]
  v_pk_mul_f32 v[70:71], v[70:71], v[54:55]
  s_waitcnt vmcnt(0)
  s_waitcnt lgkmcnt(2)
  v_mfma_f32_32x32x16_bf16 v[8:23], a[240:243], a[224:227], 0
  ds_read_b128 a[224:227], v2 offset:40960
  ds_read_b64_tr_b16 a[240:241], v3 offset:0
  ds_read_b64_tr_b16 a[242:243], v3 offset:1024
  v_exp_f32 v56, v56
  v_rcp_f32 v72, v72
  v_mfma_f32_32x32x16_bf16 v[8:23], a[244:247], a[228:231], v[8:23]
  s_waitcnt lgkmcnt(3)
  ds_read_b128 a[228:231], v2 offset:41984
  ds_read_b64_tr_b16 a[244:245], v3 offset:512
  ds_read_b64_tr_b16 a[246:247], v3 offset:1536
  v_exp_f32 v57, v57
  v_rcp_f32 v73, v73
  v_exp_f32 v58, v58
  v_mfma_f32_32x32x16_bf16 v[8:23], a[248:251], a[232:235], v[8:23]
  ds_read_b128 a[232:235], v2 offset:43008
  ds_read_b64_tr_b16 a[248:249], v3 offset:2048
  ds_read_b64_tr_b16 a[250:251], v3 offset:3072
  v_rcp_f32 v74, v74
  v_exp_f32 v59, v59
  v_rcp_f32 v75, v75
  v_mfma_f32_32x32x16_bf16 v[8:23], a[252:255], a[236:239], v[8:23]
  s_waitcnt lgkmcnt(5)
  ds_read_b128 a[236:239], v2 offset:44032
  ds_read_b64_tr_b16 a[252:253], v3 offset:2560
  ds_read_b64_tr_b16 a[254:255], v3 offset:3584
  v_exp_f32 v60, v60
  v_rcp_f32 v76, v76
  v_exp_f32 v61, v61
  v_mfma_f32_32x32x16_bf16 v[8:23], v[112:115], a[224:227], v[8:23]
  ds_read_b128 a[224:227], v2 offset:45056
  ds_read_b64_tr_b16 v[112:113], v3 offset:4096
  ds_read_b64_tr_b16 v[114:115], v3 offset:5120
  v_rcp_f32 v77, v77
  v_exp_f32 v62, v62
  v_rcp_f32 v78, v78
  v_mfma_f32_32x32x16_bf16 v[8:23], v[116:119], a[228:231], v[8:23]
  s_waitcnt lgkmcnt(5)
  ds_read_b128 a[228:231], v2 offset:46080
  ds_read_b64_tr_b16 v[116:117], v3 offset:4608
  ds_read_b64_tr_b16 v[118:119], v3 offset:5632
  v_exp_f32 v63, v63
  v_rcp_f32 v79, v79
  v_exp_f32 v64, v64
  v_mfma_f32_32x32x16_bf16 v[8:23], v[120:123], a[232:235], v[8:23]
  ds_read_b128 a[232:235], v2 offset:47104
  ds_read_b64_tr_b16 v[120:121], v3 offset:6144
  ds_read_b64_tr_b16 v[122:123], v3 offset:7168
  v_rcp_f32 v80, v80
  v_exp_f32 v65, v65
  v_rcp_f32 v81, v81
  v_mfma_f32_32x32x16_bf16 v[8:23], v[124:127], a[236:239], v[8:23]
  s_waitcnt lgkmcnt(5)
  ds_read_b128 a[236:239], v2 offset:48128
  ds_read_b64_tr_b16 v[124:125], v3 offset:6656
  ds_read_b64_tr_b16 v[126:127], v3 offset:7680
  v_exp_f32 v66, v66
  v_rcp_f32 v82, v82
  v_exp_f32 v67, v67
  v_mfma_f32_32x32x16_bf16 v[8:23], v[128:131], a[224:227], v[8:23]
  ds_read_b128 a[224:227], v1 offset:0
  ds_read_b64_tr_b16 v[128:129], v3 offset:8192
  ds_read_b64_tr_b16 v[130:131], v3 offset:9216
  v_rcp_f32 v83, v83
  v_exp_f32 v68, v68
  v_rcp_f32 v84, v84
  v_mfma_f32_32x32x16_bf16 v[8:23], v[132:135], a[228:231], v[8:23]
  s_waitcnt lgkmcnt(5)
  ds_read_b128 a[228:231], v1 offset:1024
  ds_read_b64_tr_b16 v[132:133], v3 offset:8704
  ds_read_b64_tr_b16 v[134:135], v3 offset:9728
  v_exp_f32 v69, v69
  v_rcp_f32 v85, v85
  v_exp_f32 v70, v70
  v_mfma_f32_32x32x16_bf16 v[8:23], v[136:139], a[232:235], v[8:23]
  ds_read_b128 a[232:235], v1 offset:2048
  ds_read_b64_tr_b16 v[136:137], v3 offset:10240
  ds_read_b64_tr_b16 v[138:139], v3 offset:11264
  v_rcp_f32 v86, v86
  v_exp_f32 v71, v71
  v_rcp_f32_e64 v87, v87
  v_mfma_f32_32x32x16_bf16 v[8:23], v[140:143], a[236:239], v[8:23]
  ds_read_b128 a[236:239], v1 offset:3072
  ds_read_b64_tr_b16 v[140:141], v3 offset:10752
  ds_read_b64_tr_b16 v[142:143], v3 offset:11776
  v_accvgpr_write_b32 a192, v104
  v_accvgpr_write_b32 a193, v105
  v_accvgpr_write_b32 a194, v106
  v_accvgpr_write_b32 a195, v107
  v_accvgpr_write_b32 a196, v108
  v_accvgpr_write_b32 a197, v109
  v_accvgpr_write_b32 a198, v110
  v_accvgpr_write_b32 a199, v111
  v_pk_mul_f32 v[72:73], v[72:73], v[24:25]
  v_pk_mul_f32 v[74:75], v[74:75], v[26:27]
  v_pk_mul_f32 v[76:77], v[76:77], v[28:29]
  v_pk_mul_f32 v[78:79], v[78:79], v[30:31]
  v_pk_mul_f32 v[80:81], v[80:81], v[32:33]
  v_pk_mul_f32 v[82:83], v[82:83], v[34:35]
  v_pk_mul_f32 v[84:85], v[84:85], v[36:37]
  v_pk_mul_f32 v[86:87], v[86:87], v[38:39]
  v_pk_add_f32 v[56:57], v[56:57], 1.0 op_sel_hi:[1,0]
  v_pk_add_f32 v[58:59], v[58:59], 1.0 op_sel_hi:[1,0]
  v_pk_add_f32 v[60:61], v[60:61], 1.0 op_sel_hi:[1,0]
  v_pk_add_f32 v[62:63], v[62:63], 1.0 op_sel_hi:[1,0]
  v_pk_add_f32 v[64:65], v[64:65], 1.0 op_sel_hi:[1,0]
  v_pk_add_f32 v[66:67], v[66:67], 1.0 op_sel_hi:[1,0]
  v_pk_add_f32 v[68:69], v[68:69], 1.0 op_sel_hi:[1,0]
  v_pk_add_f32 v[70:71], v[70:71], 1.0 op_sel_hi:[1,0]
  v_pk_fma_f32 v[88:89], v[72:73], v[72:73], v[88:89]
  v_pk_fma_f32 v[90:91], v[74:75], v[74:75], v[90:91]
  v_pk_fma_f32 v[92:93], v[76:77], v[76:77], v[92:93]
  v_pk_fma_f32 v[94:95], v[78:79], v[78:79], v[94:95]
  v_pk_fma_f32 v[96:97], v[80:81], v[80:81], v[96:97]
  v_pk_fma_f32 v[98:99], v[82:83], v[82:83], v[98:99]
  v_pk_fma_f32 v[100:101], v[84:85], v[84:85], v[100:101]
  v_pk_fma_f32 v[102:103], v[86:87], v[86:87], v[102:103]
  v_cvt_pk_bf16_f32 v104, v72, v73
  v_cvt_pk_bf16_f32 v105, v74, v75
  v_cvt_pk_bf16_f32 v106, v76, v77
  v_cvt_pk_bf16_f32 v107, v78, v79
  v_cvt_pk_bf16_f32 v108, v80, v81
  v_cvt_pk_bf16_f32 v109, v82, v83
  v_cvt_pk_bf16_f32 v110, v84, v85
  v_cvt_pk_bf16_f32 v111, v86, v87
  v_pk_fma_f32 v[72:73], v[8:9], v[8:9], s[50:51] neg_lo:[1,0,0] neg_hi:[1,0,0]
  v_pk_fma_f32 v[74:75], v[10:11], v[10:11], s[50:51] neg_lo:[1,0,0] neg_hi:[1,0,0]
  v_pk_fma_f32 v[76:77], v[12:13], v[12:13], s[50:51] neg_lo:[1,0,0] neg_hi:[1,0,0]
  v_pk_fma_f32 v[78:79], v[14:15], v[14:15], s[50:51] neg_lo:[1,0,0] neg_hi:[1,0,0]
  v_pk_fma_f32 v[80:81], v[16:17], v[16:17], s[50:51] neg_lo:[1,0,0] neg_hi:[1,0,0]
  v_pk_fma_f32 v[82:83], v[18:19], v[18:19], s[50:51] neg_lo:[1,0,0] neg_hi:[1,0,0]
  v_pk_fma_f32 v[84:85], v[20:21], v[20:21], s[50:51] neg_lo:[1,0,0] neg_hi:[1,0,0]
  v_pk_fma_f32 v[86:87], v[22:23], v[22:23], s[50:51] neg_lo:[1,0,0] neg_hi:[1,0,0]
  v_pk_mul_f32 v[72:73], v[72:73], v[8:9]
  v_pk_mul_f32 v[74:75], v[74:75], v[10:11]
  v_pk_mul_f32 v[76:77], v[76:77], v[12:13]
  v_pk_mul_f32 v[78:79], v[78:79], v[14:15]
  v_pk_mul_f32 v[80:81], v[80:81], v[16:17]
  v_pk_mul_f32 v[82:83], v[82:83], v[18:19]
  v_pk_mul_f32 v[84:85], v[84:85], v[20:21]
  v_pk_mul_f32 v[86:87], v[86:87], v[22:23]
  s_waitcnt lgkmcnt(8)
  v_mfma_f32_32x32x16_bf16 v[24:39], a[240:243], a[224:227], 0
  ds_read_b128 a[224:227], v1 offset:4096
  v_exp_f32 v72, v72
  v_rcp_f32 v56, v56
  v_mfma_f32_32x32x16_bf16 v[24:39], a[244:247], a[228:231], v[24:39]
  s_waitcnt lgkmcnt(3)
  ds_read_b128 a[228:231], v1 offset:5120
  v_exp_f32 v73, v73
  v_rcp_f32 v57, v57
  v_exp_f32 v74, v74
  v_mfma_f32_32x32x16_bf16 v[24:39], a[248:251], a[232:235], v[24:39]
  ds_read_b128 a[232:235], v1 offset:6144
  v_rcp_f32 v58, v58
  v_exp_f32 v75, v75
  v_rcp_f32 v59, v59
  v_mfma_f32_32x32x16_bf16 v[24:39], a[252:255], a[236:239], v[24:39]
  s_waitcnt lgkmcnt(1)
  ds_read_b128 a[236:239], v1 offset:7168
  v_exp_f32 v76, v76
  v_rcp_f32 v60, v60
  v_exp_f32 v77, v77
  v_mfma_f32_32x32x16_bf16 v[24:39], v[112:115], a[224:227], v[24:39]
  ds_read_b128 a[224:227], v1 offset:8192
  v_rcp_f32 v61, v61
  v_exp_f32 v78, v78
  v_rcp_f32 v62, v62
  v_mfma_f32_32x32x16_bf16 v[24:39], v[116:119], a[228:231], v[24:39]
  s_waitcnt lgkmcnt(1)
  ds_read_b128 a[228:231], v1 offset:9216
  v_exp_f32 v79, v79
  v_rcp_f32 v63, v63
  v_exp_f32 v80, v80
  v_mfma_f32_32x32x16_bf16 v[24:39], v[120:123], a[232:235], v[24:39]
  ds_read_b128 a[232:235], v1 offset:10240
  v_rcp_f32 v64, v64
  v_exp_f32 v81, v81
  v_rcp_f32 v65, v65
  v_mfma_f32_32x32x16_bf16 v[24:39], v[124:127], a[236:239], v[24:39]
  s_waitcnt lgkmcnt(1)
  ds_read_b128 a[236:239], v1 offset:11264
  v_exp_f32 v82, v82
  v_rcp_f32 v66, v66
  v_exp_f32 v83, v83
  v_mfma_f32_32x32x16_bf16 v[24:39], v[128:131], a[224:227], v[24:39]
  ds_read_b128 a[224:227], v1 offset:12288
  v_rcp_f32 v67, v67
  v_exp_f32 v84, v84
  v_rcp_f32 v68, v68
  v_mfma_f32_32x32x16_bf16 v[24:39], v[132:135], a[228:231], v[24:39]
  s_waitcnt lgkmcnt(1)
  ds_read_b128 a[228:231], v1 offset:13312
  v_exp_f32 v85, v85
  v_rcp_f32 v69, v69
  v_exp_f32 v86, v86
  v_mfma_f32_32x32x16_bf16 v[24:39], v[136:139], a[232:235], v[24:39]
  ds_read_b128 a[232:235], v1 offset:14336
  v_rcp_f32 v70, v70
  v_exp_f32 v87, v87
  v_rcp_f32 v71, v71
  v_mfma_f32_32x32x16_bf16 v[24:39], v[140:143], a[236:239], v[24:39]
  ds_read_b128 a[236:239], v1 offset:15360
  v_accvgpr_write_b32 a200, v104
  v_accvgpr_write_b32 a201, v105
  v_accvgpr_write_b32 a202, v106
  v_accvgpr_write_b32 a203, v107
  v_accvgpr_write_b32 a204, v108
  v_accvgpr_write_b32 a205, v109
  v_accvgpr_write_b32 a206, v110
  v_accvgpr_write_b32 a207, v111
  v_pk_mul_f32 v[56:57], v[56:57], v[40:41]
  v_pk_mul_f32 v[58:59], v[58:59], v[42:43]
  v_pk_mul_f32 v[60:61], v[60:61], v[44:45]
  v_pk_mul_f32 v[62:63], v[62:63], v[46:47]
  v_pk_mul_f32 v[64:65], v[64:65], v[48:49]
  v_pk_mul_f32 v[66:67], v[66:67], v[50:51]
  v_pk_mul_f32 v[68:69], v[68:69], v[52:53]
  v_pk_mul_f32 v[70:71], v[70:71], v[54:55]
  v_pk_add_f32 v[72:73], v[72:73], 1.0 op_sel_hi:[1,0]
  v_pk_add_f32 v[74:75], v[74:75], 1.0 op_sel_hi:[1,0]
  v_pk_add_f32 v[76:77], v[76:77], 1.0 op_sel_hi:[1,0]
  v_pk_add_f32 v[78:79], v[78:79], 1.0 op_sel_hi:[1,0]
  v_pk_add_f32 v[80:81], v[80:81], 1.0 op_sel_hi:[1,0]
  v_pk_add_f32 v[82:83], v[82:83], 1.0 op_sel_hi:[1,0]
  v_pk_add_f32 v[84:85], v[84:85], 1.0 op_sel_hi:[1,0]
  v_pk_add_f32 v[86:87], v[86:87], 1.0 op_sel_hi:[1,0]
  v_pk_fma_f32 v[88:89], v[56:57], v[56:57], v[88:89]
  v_pk_fma_f32 v[90:91], v[58:59], v[58:59], v[90:91]
  v_pk_fma_f32 v[92:93], v[60:61], v[60:61], v[92:93]
  v_pk_fma_f32 v[94:95], v[62:63], v[62:63], v[94:95]
  v_pk_fma_f32 v[96:97], v[64:65], v[64:65], v[96:97]
  v_pk_fma_f32 v[98:99], v[66:67], v[66:67], v[98:99]
  v_pk_fma_f32 v[100:101], v[68:69], v[68:69], v[100:101]
  v_pk_fma_f32 v[102:103], v[70:71], v[70:71], v[102:103]
  v_cvt_pk_bf16_f32 v104, v56, v57
  v_cvt_pk_bf16_f32 v105, v58, v59
  v_cvt_pk_bf16_f32 v106, v60, v61
  v_cvt_pk_bf16_f32 v107, v62, v63
  v_cvt_pk_bf16_f32 v108, v64, v65
  v_cvt_pk_bf16_f32 v109, v66, v67
  v_cvt_pk_bf16_f32 v110, v68, v69
  v_cvt_pk_bf16_f32 v111, v70, v71
  v_pk_fma_f32 v[56:57], v[24:25], v[24:25], s[50:51] neg_lo:[1,0,0] neg_hi:[1,0,0]
  v_pk_fma_f32 v[58:59], v[26:27], v[26:27], s[50:51] neg_lo:[1,0,0] neg_hi:[1,0,0]
  v_pk_fma_f32 v[60:61], v[28:29], v[28:29], s[50:51] neg_lo:[1,0,0] neg_hi:[1,0,0]
  v_pk_fma_f32 v[62:63], v[30:31], v[30:31], s[50:51] neg_lo:[1,0,0] neg_hi:[1,0,0]
  v_pk_fma_f32 v[64:65], v[32:33], v[32:33], s[50:51] neg_lo:[1,0,0] neg_hi:[1,0,0]
  v_pk_fma_f32 v[66:67], v[34:35], v[34:35], s[50:51] neg_lo:[1,0,0] neg_hi:[1,0,0]
  v_pk_fma_f32 v[68:69], v[36:37], v[36:37], s[50:51] neg_lo:[1,0,0] neg_hi:[1,0,0]
  v_pk_fma_f32 v[70:71], v[38:39], v[38:39], s[50:51] neg_lo:[1,0,0] neg_hi:[1,0,0]
  v_pk_mul_f32 v[56:57], v[56:57], v[24:25]
  v_pk_mul_f32 v[58:59], v[58:59], v[26:27]
  v_pk_mul_f32 v[60:61], v[60:61], v[28:29]
  v_pk_mul_f32 v[62:63], v[62:63], v[30:31]
  v_pk_mul_f32 v[64:65], v[64:65], v[32:33]
  v_pk_mul_f32 v[66:67], v[66:67], v[34:35]
  v_pk_mul_f32 v[68:69], v[68:69], v[36:37]
  v_pk_mul_f32 v[70:71], v[70:71], v[38:39]
  s_waitcnt lgkmcnt(2)
  v_mfma_f32_32x32x16_bf16 v[40:55], a[240:243], a[224:227], 0
  ds_read_b128 a[224:227], v1 offset:16384
  v_exp_f32 v56, v56
  v_rcp_f32 v72, v72
  v_add_u32 v4, 64, v4
  s_add_u32 m0, s56, 0
  v_mfma_f32_32x32x16_bf16 v[40:55], a[244:247], a[228:231], v[40:55]
  s_waitcnt lgkmcnt(1)
  buffer_load_dwordx4 v4, s[28:31], s72 offen offset:0 lds
  ds_read_b128 a[228:231], v1 offset:17408
  v_exp_f32 v57, v57
  v_rcp_f32 v73, v73
  v_exp_f32 v58, v58
  v_mfma_f32_32x32x16_bf16 v[40:55], a[248:251], a[232:235], v[40:55]
  ds_read_b128 a[232:235], v1 offset:18432
  v_rcp_f32 v74, v74
  v_exp_f32 v59, v59
  v_rcp_f32 v75, v75
  v_mfma_f32_32x32x16_bf16 v[40:55], a[252:255], a[236:239], v[40:55]
  s_waitcnt lgkmcnt(1)
  ds_read_b128 a[236:239], v1 offset:19456
  v_exp_f32 v60, v60
  v_rcp_f32 v76, v76
  v_exp_f32 v61, v61
  v_mfma_f32_32x32x16_bf16 v[40:55], v[112:115], a[224:227], v[40:55]
  buffer_load_dwordx4 v4, s[28:31], s73 offen offset:1024 lds
  ds_read_b128 a[224:227], v1 offset:20480
  v_rcp_f32 v77, v77
  v_exp_f32 v62, v62
  v_rcp_f32 v78, v78
  v_mfma_f32_32x32x16_bf16 v[40:55], v[116:119], a[228:231], v[40:55]
  s_waitcnt lgkmcnt(1)
  ds_read_b128 a[228:231], v1 offset:21504
  v_exp_f32 v63, v63
  v_rcp_f32 v79, v79
  v_exp_f32 v64, v64
  v_mfma_f32_32x32x16_bf16 v[40:55], v[120:123], a[232:235], v[40:55]
  ds_read_b128 a[232:235], v1 offset:22528
  v_rcp_f32 v80, v80
  v_exp_f32 v65, v65
  v_rcp_f32 v81, v81
  v_mfma_f32_32x32x16_bf16 v[40:55], v[124:127], a[236:239], v[40:55]
  s_waitcnt lgkmcnt(1)
  buffer_load_dwordx4 v4, s[28:31], s74 offen offset:2048 lds
  ds_read_b128 a[236:239], v1 offset:23552
  v_exp_f32 v66, v66
  v_rcp_f32 v82, v82
  v_exp_f32 v67, v67
  v_mfma_f32_32x32x16_bf16 v[40:55], v[128:131], a[224:227], v[40:55]
  ds_read_b128 a[224:227], v1 offset:24576
  v_rcp_f32 v83, v83
  v_exp_f32 v68, v68
  v_rcp_f32 v84, v84
  v_mfma_f32_32x32x16_bf16 v[40:55], v[132:135], a[228:231], v[40:55]
  s_waitcnt lgkmcnt(1)
  ds_read_b128 a[228:231], v1 offset:25600
  v_exp_f32 v69, v69
  v_rcp_f32 v85, v85
  v_exp_f32 v70, v70
  v_mfma_f32_32x32x16_bf16 v[40:55], v[136:139], a[232:235], v[40:55]
  buffer_load_dwordx4 v4, s[28:31], s75 offen offset:3072 lds
  ds_read_b128 a[232:235], v1 offset:26624
  v_rcp_f32 v86, v86
  v_exp_f32 v71, v71
  v_rcp_f32 v87, v87
  v_mfma_f32_32x32x16_bf16 v[40:55], v[140:143], a[236:239], v[40:55]
  ds_read_b128 a[236:239], v1 offset:27648
  v_accvgpr_write_b32 a208, v104
  v_accvgpr_write_b32 a209, v105
  v_accvgpr_write_b32 a210, v106
  v_accvgpr_write_b32 a211, v107
  v_accvgpr_write_b32 a212, v108
  v_accvgpr_write_b32 a213, v109
  v_accvgpr_write_b32 a214, v110
  v_accvgpr_write_b32 a215, v111
  v_pk_mul_f32 v[72:73], v[72:73], v[8:9]
  v_pk_mul_f32 v[74:75], v[74:75], v[10:11]
  v_pk_mul_f32 v[76:77], v[76:77], v[12:13]
  v_pk_mul_f32 v[78:79], v[78:79], v[14:15]
  v_pk_mul_f32 v[80:81], v[80:81], v[16:17]
  v_pk_mul_f32 v[82:83], v[82:83], v[18:19]
  v_pk_mul_f32 v[84:85], v[84:85], v[20:21]
  v_pk_mul_f32 v[86:87], v[86:87], v[22:23]
  v_pk_add_f32 v[56:57], v[56:57], 1.0 op_sel_hi:[1,0]
  v_pk_add_f32 v[58:59], v[58:59], 1.0 op_sel_hi:[1,0]
  v_pk_add_f32 v[60:61], v[60:61], 1.0 op_sel_hi:[1,0]
  v_pk_add_f32 v[62:63], v[62:63], 1.0 op_sel_hi:[1,0]
  v_pk_add_f32 v[64:65], v[64:65], 1.0 op_sel_hi:[1,0]
  v_pk_add_f32 v[66:67], v[66:67], 1.0 op_sel_hi:[1,0]
  v_pk_add_f32 v[68:69], v[68:69], 1.0 op_sel_hi:[1,0]
  v_pk_add_f32 v[70:71], v[70:71], 1.0 op_sel_hi:[1,0]
  v_pk_fma_f32 v[88:89], v[72:73], v[72:73], v[88:89]
  v_pk_fma_f32 v[90:91], v[74:75], v[74:75], v[90:91]
  v_pk_fma_f32 v[92:93], v[76:77], v[76:77], v[92:93]
  v_pk_fma_f32 v[94:95], v[78:79], v[78:79], v[94:95]
  v_pk_fma_f32 v[96:97], v[80:81], v[80:81], v[96:97]
  v_pk_fma_f32 v[98:99], v[82:83], v[82:83], v[98:99]
  v_pk_fma_f32 v[100:101], v[84:85], v[84:85], v[100:101]
  v_pk_fma_f32 v[102:103], v[86:87], v[86:87], v[102:103]
  v_cvt_pk_bf16_f32 v104, v72, v73
  v_cvt_pk_bf16_f32 v105, v74, v75
  v_cvt_pk_bf16_f32 v106, v76, v77
  v_cvt_pk_bf16_f32 v107, v78, v79
  v_cvt_pk_bf16_f32 v108, v80, v81
  v_cvt_pk_bf16_f32 v109, v82, v83
  v_cvt_pk_bf16_f32 v110, v84, v85
  v_cvt_pk_bf16_f32 v111, v86, v87
  v_pk_fma_f32 v[72:73], v[40:41], v[40:41], s[50:51] neg_lo:[1,0,0] neg_hi:[1,0,0]
  v_pk_fma_f32 v[74:75], v[42:43], v[42:43], s[50:51] neg_lo:[1,0,0] neg_hi:[1,0,0]
  v_pk_fma_f32 v[76:77], v[44:45], v[44:45], s[50:51] neg_lo:[1,0,0] neg_hi:[1,0,0]
  v_pk_fma_f32 v[78:79], v[46:47], v[46:47], s[50:51] neg_lo:[1,0,0] neg_hi:[1,0,0]
  v_pk_fma_f32 v[80:81], v[48:49], v[48:49], s[50:51] neg_lo:[1,0,0] neg_hi:[1,0,0]
  v_pk_fma_f32 v[82:83], v[50:51], v[50:51], s[50:51] neg_lo:[1,0,0] neg_hi:[1,0,0]
  v_pk_fma_f32 v[84:85], v[52:53], v[52:53], s[50:51] neg_lo:[1,0,0] neg_hi:[1,0,0]
  v_pk_fma_f32 v[86:87], v[54:55], v[54:55], s[50:51] neg_lo:[1,0,0] neg_hi:[1,0,0]
  v_pk_mul_f32 v[72:73], v[72:73], v[40:41]
  v_pk_mul_f32 v[74:75], v[74:75], v[42:43]
  v_pk_mul_f32 v[76:77], v[76:77], v[44:45]
  v_pk_mul_f32 v[78:79], v[78:79], v[46:47]
  v_pk_mul_f32 v[80:81], v[80:81], v[48:49]
  v_pk_mul_f32 v[82:83], v[82:83], v[50:51]
  v_pk_mul_f32 v[84:85], v[84:85], v[52:53]
  v_pk_mul_f32 v[86:87], v[86:87], v[54:55]
  s_waitcnt lgkmcnt(2)
  v_mfma_f32_32x32x16_bf16 v[8:23], a[240:243], a[224:227], 0
  ds_read_b128 a[224:227], v1 offset:28672
  v_exp_f32 v72, v72
  v_add_f32_dpp v88, v88, v88 row_ror:8 row_mask:0xf bank_mask:0x3
  v_rcp_f32 v56, v56
  v_add_f32_dpp v89, v89, v89 row_ror:8 row_mask:0xf bank_mask:0x3
  v_exp_f32 v73, v73
  v_add_f32_dpp v90, v90, v90 row_ror:8 row_mask:0xf bank_mask:0x3
  s_add_u32 m0, s56, 4096
  v_mfma_f32_32x32x16_bf16 v[8:23], a[244:247], a[228:231], v[8:23]
  s_waitcnt lgkmcnt(1)
  buffer_load_dwordx4 v4, s[28:31], s76 offen offset:0 lds
  ds_read_b128 a[228:231], v1 offset:29696
  v_rcp_f32 v57, v57
  v_add_f32_dpp v91, v91, v91 row_ror:8 row_mask:0xf bank_mask:0x3
  v_exp_f32 v74, v74
  v_add_f32_dpp v92, v92, v92 row_ror:8 row_mask:0xf bank_mask:0x3
  v_rcp_f32 v58, v58
  v_add_f32_dpp v93, v93, v93 row_ror:8 row_mask:0xf bank_mask:0x3
  v_mfma_f32_32x32x16_bf16 v[8:23], a[248:251], a[232:235], v[8:23]
  ds_read_b128 a[232:235], v1 offset:30720
  v_exp_f32 v75, v75
  v_add_f32_dpp v94, v94, v94 row_ror:8 row_mask:0xf bank_mask:0x3
  v_add_f32_dpp v95, v95, v95 row_ror:8 row_mask:0xf bank_mask:0x3
  v_rcp_f32 v59, v59
  v_add_f32_dpp v88, v96, v96 row_ror:8 row_mask:0xf bank_mask:0xc
  v_exp_f32 v76, v76
  v_mfma_f32_32x32x16_bf16 v[8:23], a[252:255], a[236:239], v[8:23]
  s_waitcnt lgkmcnt(1)
  ds_read_b128 a[236:239], v1 offset:31744
  v_add_f32_dpp v89, v97, v97 row_ror:8 row_mask:0xf bank_mask:0xc
  v_rcp_f32 v60, v60
  v_add_f32_dpp v90, v98, v98 row_ror:8 row_mask:0xf bank_mask:0xc
  v_exp_f32 v77, v77
  v_add_f32_dpp v91, v99, v99 row_ror:8 row_mask:0xf bank_mask:0xc
  v_rcp_f32 v61, v61
  v_add_f32_dpp v92, v100, v100 row_ror:8 row_mask:0xf bank_mask:0xc
  v_mfma_f32_32x32x16_bf16 v[8:23], v[112:115], a[224:227], v[8:23]
  buffer_load_dwordx4 v4, s[28:31], s77 offen offset:1024 lds
  ds_read_b128 a[224:227], v1 offset:32768
  v_exp_f32 v78, v78
  v_add_f32_dpp v93, v101, v101 row_ror:8 row_mask:0xf bank_mask:0xc
  v_add_f32_dpp v94, v102, v102 row_ror:8 row_mask:0xf bank_mask:0xc
  v_rcp_f32 v62, v62
  v_add_f32_dpp v95, v103, v103 row_ror:8 row_mask:0xf bank_mask:0xc
  v_exp_f32 v79, v79
  v_mfma_f32_32x32x16_bf16 v[8:23], v[116:119], a[228:231], v[8:23]
  s_waitcnt lgkmcnt(1)
  ds_read_b128 a[228:231], v1 offset:33792
  v_add_f32_dpp v88, v88, v88 row_shl:4 row_mask:0xf bank_mask:0x5
  v_rcp_f32 v63, v63
  v_add_f32_dpp v89, v89, v89 row_shl:4 row_mask:0xf bank_mask:0x5
  v_exp_f32 v80, v80
  v_add_f32_dpp v90, v90, v90 row_shl:4 row_mask:0xf bank_mask:0x5
  v_rcp_f32 v64, v64
  v_mfma_f32_32x32x16_bf16 v[8:23], v[120:123], a[232:235], v[8:23]
  ds_read_b128 a[232:235], v1 offset:34816
  v_add_f32_dpp v91, v91, v91 row_shl:4 row_mask:0xf bank_mask:0x5
  v_exp_f32 v81, v81
  v_add_f32_dpp v88, v92, v92 row_shr:4 row_mask:0xf bank_mask:0xa
  v_rcp_f32 v65, v65
  v_add_f32_dpp v89, v93, v93 row_shr:4 row_mask:0xf bank_mask:0xa
  v_add_f32_dpp v90, v94, v94 row_shr:4 row_mask:0xf bank_mask:0xa
  v_mfma_f32_32x32x16_bf16 v[8:23], v[124:127], a[236:239], v[8:23]
  s_waitcnt lgkmcnt(1)
  buffer_load_dwordx4 v4, s[28:31], s78 offen offset:2048 lds
  ds_read_b128 a[236:239], v1 offset:35840
  v_exp_f32 v82, v82
  v_add_f32_dpp v91, v95, v95 row_shr:4 row_mask:0xf bank_mask:0xa
  v_rcp_f32 v66, v66
  v_add_f32_dpp v92, v88, v88 quad_perm:[2,3,0,1] row_mask:0xf bank_mask:0xf
  v_exp_f32 v83, v83
  v_add_f32_dpp v93, v89, v89 quad_perm:[2,3,0,1] row_mask:0xf bank_mask:0xf
  v_rcp_f32 v67, v67
  v_mfma_f32_32x32x16_bf16 v[8:23], v[128:131], a[224:227], v[8:23]
  ds_read_b128 a[224:227], v2 offset:0
  v_add_f32_dpp v94, v90, v90 quad_perm:[2,3,0,1] row_mask:0xf bank_mask:0xf
  v_exp_f32 v84, v84
  v_add_f32_dpp v95, v91, v91 quad_perm:[2,3,0,1] row_mask:0xf bank_mask:0xf
  v_rcp_f32 v68, v68
  v_cndmask_b32 v88, v92, v94, s[64:65]
  v_cndmask_b32 v89, v93, v95, s[64:65]
  v_mfma_f32_32x32x16_bf16 v[8:23], v[132:135], a[228:231], v[8:23]
  s_waitcnt lgkmcnt(1)
  ds_read_b128 a[228:231], v2 offset:1024
  v_exp_f32 v85, v85
  v_add_f32_dpp v90, v88, v88 quad_perm:[1,0,3,2] row_mask:0xf bank_mask:0xf
  v_rcp_f32 v69, v69
  v_add_f32_dpp v91, v89, v89 quad_perm:[1,0,3,2] row_mask:0xf bank_mask:0xf
  v_exp_f32 v86, v86
  v_cndmask_b32 v92, v90, v91, s[58:59]
  v_mfma_f32_32x32x16_bf16 v[8:23], v[136:139], a[232:235], v[8:23]
  buffer_load_dwordx4 v4, s[28:31], s79 offen offset:3072 lds
  ds_read_b128 a[232:235], v2 offset:2048
  v_rcp_f32 v70, v70
  v_mov_b32 v6, v92
  v_exp_f32 v87, v87
  s_nop 0
  v_permlane16_swap_b32 v92, v6
  v_rcp_f32 v71, v71
  v_add_f32_e64 v6, v6, v92
  s_mov_b32 exec_lo, 0xffff
  s_mov_b32 exec_hi, 0xffff
  buffer_atomic_add_f32 v6, v5, s[4:7], 0 offen offset:384
  s_mov_b64 exec, -1
  v_mfma_f32_32x32x16_bf16 v[8:23], v[140:143], a[236:239], v[8:23]
  ds_read_b128 a[236:239], v2 offset:3072
  v_accvgpr_write_b32 a216, v104
  v_accvgpr_write_b32 a217, v105
  v_accvgpr_write_b32 a218, v106
  v_accvgpr_write_b32 a219, v107
  v_accvgpr_write_b32 a220, v108
  v_accvgpr_write_b32 a221, v109
  v_accvgpr_write_b32 a222, v110
  v_accvgpr_write_b32 a223, v111
  v_pk_mul_f32 v[56:57], v[56:57], v[24:25]
  v_pk_mul_f32 v[58:59], v[58:59], v[26:27]
  v_pk_mul_f32 v[60:61], v[60:61], v[28:29]
  v_pk_mul_f32 v[62:63], v[62:63], v[30:31]
  v_pk_mul_f32 v[64:65], v[64:65], v[32:33]
  v_pk_mul_f32 v[66:67], v[66:67], v[34:35]
  v_pk_mul_f32 v[68:69], v[68:69], v[36:37]
  v_pk_mul_f32 v[70:71], v[70:71], v[38:39]
  v_pk_add_f32 v[72:73], v[72:73], 1.0 op_sel_hi:[1,0]
  v_pk_add_f32 v[74:75], v[74:75], 1.0 op_sel_hi:[1,0]
  v_pk_add_f32 v[76:77], v[76:77], 1.0 op_sel_hi:[1,0]
  v_pk_add_f32 v[78:79], v[78:79], 1.0 op_sel_hi:[1,0]
  v_pk_add_f32 v[80:81], v[80:81], 1.0 op_sel_hi:[1,0]
  v_pk_add_f32 v[82:83], v[82:83], 1.0 op_sel_hi:[1,0]
  v_pk_add_f32 v[84:85], v[84:85], 1.0 op_sel_hi:[1,0]
  v_pk_add_f32 v[86:87], v[86:87], 1.0 op_sel_hi:[1,0]
  v_pk_mul_f32 v[88:89], v[56:57], v[56:57]
  v_pk_mul_f32 v[90:91], v[58:59], v[58:59]
  v_pk_mul_f32 v[92:93], v[60:61], v[60:61]
  v_pk_mul_f32 v[94:95], v[62:63], v[62:63]
  v_pk_mul_f32 v[96:97], v[64:65], v[64:65]
  v_pk_mul_f32 v[98:99], v[66:67], v[66:67]
  v_pk_mul_f32 v[100:101], v[68:69], v[68:69]
  v_pk_mul_f32 v[102:103], v[70:71], v[70:71]
  v_cvt_pk_bf16_f32 v144, v56, v57
  v_cvt_pk_bf16_f32 v145, v58, v59
  v_cvt_pk_bf16_f32 v146, v60, v61
  v_cvt_pk_bf16_f32 v147, v62, v63
  v_cvt_pk_bf16_f32 v148, v64, v65
  v_cvt_pk_bf16_f32 v149, v66, v67
  v_cvt_pk_bf16_f32 v150, v68, v69
  v_cvt_pk_bf16_f32 v151, v70, v71
  v_pk_fma_f32 v[56:57], v[8:9], v[8:9], s[50:51] neg_lo:[1,0,0] neg_hi:[1,0,0]
  v_pk_fma_f32 v[58:59], v[10:11], v[10:11], s[50:51] neg_lo:[1,0,0] neg_hi:[1,0,0]
  v_pk_fma_f32 v[60:61], v[12:13], v[12:13], s[50:51] neg_lo:[1,0,0] neg_hi:[1,0,0]
  v_pk_fma_f32 v[62:63], v[14:15], v[14:15], s[50:51] neg_lo:[1,0,0] neg_hi:[1,0,0]
  v_pk_fma_f32 v[64:65], v[16:17], v[16:17], s[50:51] neg_lo:[1,0,0] neg_hi:[1,0,0]
  v_pk_fma_f32 v[66:67], v[18:19], v[18:19], s[50:51] neg_lo:[1,0,0] neg_hi:[1,0,0]
  v_pk_fma_f32 v[68:69], v[20:21], v[20:21], s[50:51] neg_lo:[1,0,0] neg_hi:[1,0,0]
  v_pk_fma_f32 v[70:71], v[22:23], v[22:23], s[50:51] neg_lo:[1,0,0] neg_hi:[1,0,0]
  v_pk_mul_f32 v[56:57], v[56:57], v[8:9]
  v_pk_mul_f32 v[58:59], v[58:59], v[10:11]
  v_pk_mul_f32 v[60:61], v[60:61], v[12:13]
  v_pk_mul_f32 v[62:63], v[62:63], v[14:15]
  v_pk_mul_f32 v[64:65], v[64:65], v[16:17]
  v_pk_mul_f32 v[66:67], v[66:67], v[18:19]
  v_pk_mul_f32 v[68:69], v[68:69], v[20:21]
  v_pk_mul_f32 v[70:71], v[70:71], v[22:23]
  s_waitcnt lgkmcnt(2)
  v_mfma_f32_32x32x16_bf16 v[24:39], a[240:243], a[224:227], 0
  ds_read_b128 a[224:227], v2 offset:4096
  v_exp_f32 v56, v56
  v_rcp_f32 v72, v72
  s_add_u32 m0, s56, 8192
  v_mfma_f32_32x32x16_bf16 v[24:39], a[244:247], a[228:231], v[24:39]
  s_waitcnt lgkmcnt(1)
  buffer_load_dwordx4 v4, s[28:31], s80 offen offset:0 lds
  ds_read_b128 a[228:231], v2 offset:5120
  v_exp_f32 v57, v57
  v_rcp_f32 v73, v73
  v_mfma_f32_32x32x16_bf16 v[24:39], a[248:251], a[232:235], v[24:39]
  ds_read_b128 a[232:235], v2 offset:6144
  v_exp_f32 v58, v58
  v_rcp_f32 v74, v74
  v_exp_f32 v59, v59
  v_mfma_f32_32x32x16_bf16 v[24:39], a[252:255], a[236:239], v[24:39]
  s_waitcnt lgkmcnt(1)
  ds_read_b128 a[236:239], v2 offset:7168
  v_rcp_f32 v75, v75
  v_exp_f32 v60, v60
  v_mfma_f32_32x32x16_bf16 v[24:39], v[112:115], a[224:227], v[24:39]
  buffer_load_dwordx4 v4, s[28:31], s81 offen offset:1024 lds
  ds_read_b128 a[224:227], v2 offset:8192
  v_rcp_f32 v76, v76
  v_exp_f32 v61, v61
  v_rcp_f32 v77, v77
  v_mfma_f32_32x32x16_bf16 v[24:39], v[116:119], a[228:231], v[24:39]
  s_waitcnt lgkmcnt(1)
  ds_read_b128 a[228:231], v2 offset:9216
  v_exp_f32 v62, v62
  v_rcp_f32 v78, v78
  v_mfma_f32_32x32x16_bf16 v[24:39], v[120:123], a[232:235], v[24:39]
  ds_read_b128 a[232:235], v2 offset:10240
  v_exp_f32 v63, v63
  v_rcp_f32 v79, v79
  v_exp_f32 v64, v64
  v_mfma_f32_32x32x16_bf16 v[24:39], v[124:127], a[236:239], v[24:39]
  s_waitcnt lgkmcnt(1)
  buffer_load_dwordx4 v4, s[28:31], s82 offen offset:2048 lds
  ds_read_b128 a[236:239], v2 offset:11264
  v_rcp_f32 v80, v80
  v_exp_f32 v65, v65
  v_mfma_f32_32x32x16_bf16 v[24:39], v[128:131], a[224:227], v[24:39]
  ds_read_b128 a[224:227], v2 offset:12288
  v_rcp_f32 v81, v81
  v_exp_f32 v66, v66
  v_rcp_f32 v82, v82
  v_mfma_f32_32x32x16_bf16 v[24:39], v[132:135], a[228:231], v[24:39]
  s_waitcnt lgkmcnt(1)
  ds_read_b128 a[228:231], v2 offset:13312
  v_exp_f32 v67, v67
  v_rcp_f32 v83, v83
  v_mfma_f32_32x32x16_bf16 v[24:39], v[136:139], a[232:235], v[24:39]
  buffer_load_dwordx4 v4, s[28:31], s83 offen offset:3072 lds
  ds_read_b128 a[232:235], v2 offset:14336
  v_exp_f32 v68, v68
  v_rcp_f32 v84, v84
  v_exp_f32 v69, v69
  v_mfma_f32_32x32x16_bf16 v[24:39], v[140:143], a[236:239], v[24:39]
  ds_read_b128 a[236:239], v2 offset:15360
  v_rcp_f32 v85, v85
  v_exp_f32 v70, v70
  v_rcp_f32 v86, v86
  v_exp_f32 v71, v71
  v_rcp_f32 v87, v87
  v_pk_mul_f32 v[72:73], v[72:73], v[40:41]
  v_pk_mul_f32 v[74:75], v[74:75], v[42:43]
  v_pk_mul_f32 v[76:77], v[76:77], v[44:45]
  v_pk_mul_f32 v[78:79], v[78:79], v[46:47]
  v_pk_mul_f32 v[80:81], v[80:81], v[48:49]
  v_pk_mul_f32 v[82:83], v[82:83], v[50:51]
  v_pk_mul_f32 v[84:85], v[84:85], v[52:53]
  v_pk_mul_f32 v[86:87], v[86:87], v[54:55]
  v_pk_add_f32 v[56:57], v[56:57], 1.0 op_sel_hi:[1,0]
  v_pk_add_f32 v[58:59], v[58:59], 1.0 op_sel_hi:[1,0]
  v_pk_add_f32 v[60:61], v[60:61], 1.0 op_sel_hi:[1,0]
  v_pk_add_f32 v[62:63], v[62:63], 1.0 op_sel_hi:[1,0]
  v_pk_add_f32 v[64:65], v[64:65], 1.0 op_sel_hi:[1,0]
  v_pk_add_f32 v[66:67], v[66:67], 1.0 op_sel_hi:[1,0]
  v_pk_add_f32 v[68:69], v[68:69], 1.0 op_sel_hi:[1,0]
  v_pk_add_f32 v[70:71], v[70:71], 1.0 op_sel_hi:[1,0]
  v_pk_fma_f32 v[88:89], v[72:73], v[72:73], v[88:89]
  v_pk_fma_f32 v[90:91], v[74:75], v[74:75], v[90:91]
  v_pk_fma_f32 v[92:93], v[76:77], v[76:77], v[92:93]
  v_pk_fma_f32 v[94:95], v[78:79], v[78:79], v[94:95]
  v_pk_fma_f32 v[96:97], v[80:81], v[80:81], v[96:97]
  v_pk_fma_f32 v[98:99], v[82:83], v[82:83], v[98:99]
  v_pk_fma_f32 v[100:101], v[84:85], v[84:85], v[100:101]
  v_pk_fma_f32 v[102:103], v[86:87], v[86:87], v[102:103]
  v_cvt_pk_bf16_f32 v152, v72, v73
  v_cvt_pk_bf16_f32 v153, v74, v75
  v_cvt_pk_bf16_f32 v154, v76, v77
  v_cvt_pk_bf16_f32 v155, v78, v79
  v_cvt_pk_bf16_f32 v156, v80, v81
  v_cvt_pk_bf16_f32 v157, v82, v83
  v_cvt_pk_bf16_f32 v158, v84, v85
  v_cvt_pk_bf16_f32 v159, v86, v87
  v_pk_fma_f32 v[72:73], v[24:25], v[24:25], s[50:51] neg_lo:[1,0,0] neg_hi:[1,0,0]
  v_pk_fma_f32 v[74:75], v[26:27], v[26:27], s[50:51] neg_lo:[1,0,0] neg_hi:[1,0,0]
  v_pk_fma_f32 v[76:77], v[28:29], v[28:29], s[50:51] neg_lo:[1,0,0] neg_hi:[1,0,0]
  v_pk_fma_f32 v[78:79], v[30:31], v[30:31], s[50:51] neg_lo:[1,0,0] neg_hi:[1,0,0]
  v_pk_fma_f32 v[80:81], v[32:33], v[32:33], s[50:51] neg_lo:[1,0,0] neg_hi:[1,0,0]
  v_pk_fma_f32 v[82:83], v[34:35], v[34:35], s[50:51] neg_lo:[1,0,0] neg_hi:[1,0,0]
  v_pk_fma_f32 v[84:85], v[36:37], v[36:37], s[50:51] neg_lo:[1,0,0] neg_hi:[1,0,0]
  v_pk_fma_f32 v[86:87], v[38:39], v[38:39], s[50:51] neg_lo:[1,0,0] neg_hi:[1,0,0]
  v_pk_mul_f32 v[72:73], v[72:73], v[24:25]
  v_pk_mul_f32 v[74:75], v[74:75], v[26:27]
  v_pk_mul_f32 v[76:77], v[76:77], v[28:29]
  v_pk_mul_f32 v[78:79], v[78:79], v[30:31]
  v_pk_mul_f32 v[80:81], v[80:81], v[32:33]
  v_pk_mul_f32 v[82:83], v[82:83], v[34:35]
  v_pk_mul_f32 v[84:85], v[84:85], v[36:37]
  v_pk_mul_f32 v[86:87], v[86:87], v[38:39]
  s_waitcnt lgkmcnt(2)
  v_mfma_f32_32x32x16_bf16 v[40:55], a[240:243], a[224:227], 0
  ds_read_b128 a[224:227], v2 offset:16384
  v_exp_f32 v72, v72
  v_rcp_f32 v56, v56
  v_mfma_f32_32x32x16_bf16 v[40:55], a[244:247], a[228:231], v[40:55]
  s_waitcnt lgkmcnt(1)
  ds_read_b128 a[228:231], v2 offset:17408
  v_exp_f32 v73, v73
  v_rcp_f32 v57, v57
  v_mfma_f32_32x32x16_bf16 v[40:55], a[248:251], a[232:235], v[40:55]
  ds_read_b128 a[232:235], v2 offset:18432
  v_exp_f32 v74, v74
  v_rcp_f32 v58, v58
  v_exp_f32 v75, v75
  v_mfma_f32_32x32x16_bf16 v[40:55], a[252:255], a[236:239], v[40:55]
  s_waitcnt lgkmcnt(1)
  ds_read_b128 a[236:239], v2 offset:19456
  v_rcp_f32 v59, v59
  v_exp_f32 v76, v76
  v_mfma_f32_32x32x16_bf16 v[40:55], v[112:115], a[224:227], v[40:55]
  ds_read_b128 a[224:227], v2 offset:20480
  v_rcp_f32 v60, v60
  v_exp_f32 v77, v77
  v_rcp_f32 v61, v61
  v_mfma_f32_32x32x16_bf16 v[40:55], v[116:119], a[228:231], v[40:55]
  s_waitcnt lgkmcnt(1)
  ds_read_b128 a[228:231], v2 offset:21504
  v_exp_f32 v78, v78
  v_rcp_f32 v62, v62
  v_mfma_f32_32x32x16_bf16 v[40:55], v[120:123], a[232:235], v[40:55]
  ds_read_b128 a[232:235], v2 offset:22528
  v_exp_f32 v79, v79
  v_rcp_f32 v63, v63
  v_exp_f32 v80, v80
  v_mfma_f32_32x32x16_bf16 v[40:55], v[124:127], a[236:239], v[40:55]
  s_waitcnt lgkmcnt(1)
  ds_read_b128 a[236:239], v2 offset:23552
  v_rcp_f32 v64, v64
  v_exp_f32 v81, v81
  v_mfma_f32_32x32x16_bf16 v[40:55], v[128:131], a[224:227], v[40:55]
  ds_read_b128 a[224:227], v2 offset:24576
  v_rcp_f32 v65, v65
  v_exp_f32 v82, v82
  v_rcp_f32 v66, v66
  v_mfma_f32_32x32x16_bf16 v[40:55], v[132:135], a[228:231], v[40:55]
  s_waitcnt lgkmcnt(1)
  ds_read_b128 a[228:231], v2 offset:25600
  v_exp_f32 v83, v83
  v_rcp_f32 v67, v67
  v_mfma_f32_32x32x16_bf16 v[40:55], v[136:139], a[232:235], v[40:55]
  ds_read_b128 a[232:235], v2 offset:26624
  v_exp_f32 v84, v84
  v_rcp_f32 v68, v68
  v_exp_f32 v85, v85
  v_mfma_f32_32x32x16_bf16 v[40:55], v[140:143], a[236:239], v[40:55]
  ds_read_b128 a[236:239], v2 offset:27648
  v_rcp_f32 v69, v69
  v_exp_f32 v86, v86
  v_rcp_f32 v70, v70
  v_exp_f32 v87, v87
  v_rcp_f32 v71, v71
  v_pk_mul_f32 v[56:57], v[56:57], v[8:9]
  v_pk_mul_f32 v[58:59], v[58:59], v[10:11]
  v_pk_mul_f32 v[60:61], v[60:61], v[12:13]
  v_pk_mul_f32 v[62:63], v[62:63], v[14:15]
  v_pk_mul_f32 v[64:65], v[64:65], v[16:17]
  v_pk_mul_f32 v[66:67], v[66:67], v[18:19]
  v_pk_mul_f32 v[68:69], v[68:69], v[20:21]
  v_pk_mul_f32 v[70:71], v[70:71], v[22:23]
  v_pk_add_f32 v[72:73], v[72:73], 1.0 op_sel_hi:[1,0]
  v_pk_add_f32 v[74:75], v[74:75], 1.0 op_sel_hi:[1,0]
  v_pk_add_f32 v[76:77], v[76:77], 1.0 op_sel_hi:[1,0]
  v_pk_add_f32 v[78:79], v[78:79], 1.0 op_sel_hi:[1,0]
  v_pk_add_f32 v[80:81], v[80:81], 1.0 op_sel_hi:[1,0]
  v_pk_add_f32 v[82:83], v[82:83], 1.0 op_sel_hi:[1,0]
  v_pk_add_f32 v[84:85], v[84:85], 1.0 op_sel_hi:[1,0]
  v_pk_add_f32 v[86:87], v[86:87], 1.0 op_sel_hi:[1,0]
  v_pk_fma_f32 v[88:89], v[56:57], v[56:57], v[88:89]
  v_pk_fma_f32 v[90:91], v[58:59], v[58:59], v[90:91]
  v_pk_fma_f32 v[92:93], v[60:61], v[60:61], v[92:93]
  v_pk_fma_f32 v[94:95], v[62:63], v[62:63], v[94:95]
  v_pk_fma_f32 v[96:97], v[64:65], v[64:65], v[96:97]
  v_pk_fma_f32 v[98:99], v[66:67], v[66:67], v[98:99]
  v_pk_fma_f32 v[100:101], v[68:69], v[68:69], v[100:101]
  v_pk_fma_f32 v[102:103], v[70:71], v[70:71], v[102:103]
  v_cvt_pk_bf16_f32 v160, v56, v57
  v_cvt_pk_bf16_f32 v161, v58, v59
  v_cvt_pk_bf16_f32 v162, v60, v61
  v_cvt_pk_bf16_f32 v163, v62, v63
  v_cvt_pk_bf16_f32 v164, v64, v65
  v_cvt_pk_bf16_f32 v165, v66, v67
  v_cvt_pk_bf16_f32 v166, v68, v69
  v_cvt_pk_bf16_f32 v167, v70, v71
  v_pk_fma_f32 v[56:57], v[40:41], v[40:41], s[50:51] neg_lo:[1,0,0] neg_hi:[1,0,0]
  v_pk_fma_f32 v[58:59], v[42:43], v[42:43], s[50:51] neg_lo:[1,0,0] neg_hi:[1,0,0]
  v_pk_fma_f32 v[60:61], v[44:45], v[44:45], s[50:51] neg_lo:[1,0,0] neg_hi:[1,0,0]
  v_pk_fma_f32 v[62:63], v[46:47], v[46:47], s[50:51] neg_lo:[1,0,0] neg_hi:[1,0,0]
  v_pk_fma_f32 v[64:65], v[48:49], v[48:49], s[50:51] neg_lo:[1,0,0] neg_hi:[1,0,0]
  v_pk_fma_f32 v[66:67], v[50:51], v[50:51], s[50:51] neg_lo:[1,0,0] neg_hi:[1,0,0]
  v_pk_fma_f32 v[68:69], v[52:53], v[52:53], s[50:51] neg_lo:[1,0,0] neg_hi:[1,0,0]
  v_pk_fma_f32 v[70:71], v[54:55], v[54:55], s[50:51] neg_lo:[1,0,0] neg_hi:[1,0,0]
  v_pk_mul_f32 v[56:57], v[56:57], v[40:41]
  v_pk_mul_f32 v[58:59], v[58:59], v[42:43]
  v_pk_mul_f32 v[60:61], v[60:61], v[44:45]
  v_pk_mul_f32 v[62:63], v[62:63], v[46:47]
  v_pk_mul_f32 v[64:65], v[64:65], v[48:49]
  v_pk_mul_f32 v[66:67], v[66:67], v[50:51]
  v_pk_mul_f32 v[68:69], v[68:69], v[52:53]
  v_pk_mul_f32 v[70:71], v[70:71], v[54:55]
  s_waitcnt lgkmcnt(2)
  v_mfma_f32_32x32x16_bf16 v[8:23], a[240:243], a[224:227], 0
  ds_read_b128 a[224:227], v2 offset:28672
  v_exp_f32 v56, v56
  v_rcp_f32 v72, v72
  v_mfma_f32_32x32x16_bf16 v[8:23], a[244:247], a[228:231], v[8:23]
  s_waitcnt lgkmcnt(1)
  ds_read_b128 a[228:231], v2 offset:29696
  v_exp_f32 v57, v57
  v_rcp_f32 v73, v73
  v_mfma_f32_32x32x16_bf16 v[8:23], a[248:251], a[232:235], v[8:23]
  ds_read_b128 a[232:235], v2 offset:30720
  v_exp_f32 v58, v58
  v_rcp_f32 v74, v74
  v_exp_f32 v59, v59
  v_mfma_f32_32x32x16_bf16 v[8:23], a[252:255], a[236:239], v[8:23]
  s_waitcnt lgkmcnt(1)
  ds_read_b128 a[236:239], v2 offset:31744
  v_rcp_f32 v75, v75
  v_exp_f32 v60, v60
  v_mfma_f32_32x32x16_bf16 v[8:23], v[112:115], a[224:227], v[8:23]
  ds_read_b128 a[224:227], v2 offset:32768
  v_rcp_f32 v76, v76
  v_exp_f32 v61, v61
  v_rcp_f32 v77, v77
  v_mfma_f32_32x32x16_bf16 v[8:23], v[116:119], a[228:231], v[8:23]
  s_waitcnt lgkmcnt(1)
  ds_read_b128 a[228:231], v2 offset:33792
  v_exp_f32 v62, v62
  v_rcp_f32 v78, v78
  v_mfma_f32_32x32x16_bf16 v[8:23], v[120:123], a[232:235], v[8:23]
  ds_read_b128 a[232:235], v2 offset:34816
  v_exp_f32 v63, v63
  v_rcp_f32 v79, v79
  v_exp_f32 v64, v64
  v_mfma_f32_32x32x16_bf16 v[8:23], v[124:127], a[236:239], v[8:23]
  s_waitcnt lgkmcnt(1)
  ds_read_b128 a[236:239], v2 offset:35840
  v_rcp_f32 v80, v80
  v_exp_f32 v65, v65
  v_mfma_f32_32x32x16_bf16 v[8:23], v[128:131], a[224:227], v[8:23]
  ds_read_b128 a[224:227], v2 offset:36864
  v_rcp_f32 v81, v81
  v_exp_f32 v66, v66
  v_rcp_f32 v82, v82
  v_mfma_f32_32x32x16_bf16 v[8:23], v[132:135], a[228:231], v[8:23]
  s_waitcnt lgkmcnt(1)
  ds_read_b128 a[228:231], v2 offset:37888
  v_exp_f32 v67, v67
  v_rcp_f32 v83, v83
  v_mfma_f32_32x32x16_bf16 v[8:23], v[136:139], a[232:235], v[8:23]
  ds_read_b128 a[232:235], v2 offset:38912
  v_exp_f32 v68, v68
  v_rcp_f32 v84, v84
  v_exp_f32 v69, v69
  v_mfma_f32_32x32x16_bf16 v[8:23], v[140:143], a[236:239], v[8:23]
  ds_read_b128 a[236:239], v2 offset:39936
  v_rcp_f32 v85, v85
  v_exp_f32 v70, v70
  v_rcp_f32 v86, v86
  v_exp_f32 v71, v71
  v_rcp_f32 v87, v87
  v_pk_mul_f32 v[72:73], v[72:73], v[24:25]
  v_pk_mul_f32 v[74:75], v[74:75], v[26:27]
  v_pk_mul_f32 v[76:77], v[76:77], v[28:29]
  v_pk_mul_f32 v[78:79], v[78:79], v[30:31]
  v_pk_mul_f32 v[80:81], v[80:81], v[32:33]
  v_pk_mul_f32 v[82:83], v[82:83], v[34:35]
  v_pk_mul_f32 v[84:85], v[84:85], v[36:37]
  v_pk_mul_f32 v[86:87], v[86:87], v[38:39]
  v_pk_add_f32 v[56:57], v[56:57], 1.0 op_sel_hi:[1,0]
  v_pk_add_f32 v[58:59], v[58:59], 1.0 op_sel_hi:[1,0]
  v_pk_add_f32 v[60:61], v[60:61], 1.0 op_sel_hi:[1,0]
  v_pk_add_f32 v[62:63], v[62:63], 1.0 op_sel_hi:[1,0]
  v_pk_add_f32 v[64:65], v[64:65], 1.0 op_sel_hi:[1,0]
  v_pk_add_f32 v[66:67], v[66:67], 1.0 op_sel_hi:[1,0]
  v_pk_add_f32 v[68:69], v[68:69], 1.0 op_sel_hi:[1,0]
  v_pk_add_f32 v[70:71], v[70:71], 1.0 op_sel_hi:[1,0]
  v_pk_fma_f32 v[88:89], v[72:73], v[72:73], v[88:89]
  v_pk_fma_f32 v[90:91], v[74:75], v[74:75], v[90:91]
  v_pk_fma_f32 v[92:93], v[76:77], v[76:77], v[92:93]
  v_pk_fma_f32 v[94:95], v[78:79], v[78:79], v[94:95]
  v_pk_fma_f32 v[96:97], v[80:81], v[80:81], v[96:97]
  v_pk_fma_f32 v[98:99], v[82:83], v[82:83], v[98:99]
  v_pk_fma_f32 v[100:101], v[84:85], v[84:85], v[100:101]
  v_pk_fma_f32 v[102:103], v[86:87], v[86:87], v[102:103]
  v_cvt_pk_bf16_f32 v168, v72, v73
  v_cvt_pk_bf16_f32 v169, v74, v75
  v_cvt_pk_bf16_f32 v170, v76, v77
  v_cvt_pk_bf16_f32 v171, v78, v79
  v_cvt_pk_bf16_f32 v172, v80, v81
  v_cvt_pk_bf16_f32 v173, v82, v83
  v_cvt_pk_bf16_f32 v174, v84, v85
  v_cvt_pk_bf16_f32 v175, v86, v87
  v_pk_fma_f32 v[72:73], v[8:9], v[8:9], s[50:51] neg_lo:[1,0,0] neg_hi:[1,0,0]
  v_pk_fma_f32 v[74:75], v[10:11], v[10:11], s[50:51] neg_lo:[1,0,0] neg_hi:[1,0,0]
  v_pk_fma_f32 v[76:77], v[12:13], v[12:13], s[50:51] neg_lo:[1,0,0] neg_hi:[1,0,0]
  v_pk_fma_f32 v[78:79], v[14:15], v[14:15], s[50:51] neg_lo:[1,0,0] neg_hi:[1,0,0]
  v_pk_fma_f32 v[80:81], v[16:17], v[16:17], s[50:51] neg_lo:[1,0,0] neg_hi:[1,0,0]
  v_pk_fma_f32 v[82:83], v[18:19], v[18:19], s[50:51] neg_lo:[1,0,0] neg_hi:[1,0,0]
  v_pk_fma_f32 v[84:85], v[20:21], v[20:21], s[50:51] neg_lo:[1,0,0] neg_hi:[1,0,0]
  v_pk_fma_f32 v[86:87], v[22:23], v[22:23], s[50:51] neg_lo:[1,0,0] neg_hi:[1,0,0]
  v_pk_mul_f32 v[72:73], v[72:73], v[8:9]
  v_pk_mul_f32 v[74:75], v[74:75], v[10:11]
  v_pk_mul_f32 v[76:77], v[76:77], v[12:13]
  v_pk_mul_f32 v[78:79], v[78:79], v[14:15]
  v_pk_mul_f32 v[80:81], v[80:81], v[16:17]
  v_pk_mul_f32 v[82:83], v[82:83], v[18:19]
  v_pk_mul_f32 v[84:85], v[84:85], v[20:21]
  v_pk_mul_f32 v[86:87], v[86:87], v[22:23]
  s_waitcnt vmcnt(0)
  s_waitcnt lgkmcnt(2)
  v_mfma_f32_32x32x16_bf16 v[24:39], a[240:243], a[224:227], 0
  ds_read_b128 a[224:227], v2 offset:40960
  ds_read_b64_tr_b16 a[240:241], v3 offset:0
  ds_read_b64_tr_b16 a[242:243], v3 offset:1024
  v_exp_f32 v72, v72
  v_rcp_f32 v56, v56
  v_mfma_f32_32x32x16_bf16 v[24:39], a[244:247], a[228:231], v[24:39]
  s_waitcnt lgkmcnt(3)
  ds_read_b128 a[228:231], v2 offset:41984
  ds_read_b64_tr_b16 a[244:245], v3 offset:512
  ds_read_b64_tr_b16 a[246:247], v3 offset:1536
  v_exp_f32 v73, v73
  v_rcp_f32 v57, v57
  v_mfma_f32_32x32x16_bf16 v[24:39], a[248:251], a[232:235], v[24:39]
  ds_read_b128 a[232:235], v2 offset:43008
  ds_read_b64_tr_b16 a[248:249], v3 offset:2048
  ds_read_b64_tr_b16 a[250:251], v3 offset:3072
  v_exp_f32 v74, v74
  v_rcp_f32 v58, v58
  v_exp_f32 v75, v75
  v_mfma_f32_32x32x16_bf16 v[24:39], a[252:255], a[236:239], v[24:39]
  s_waitcnt lgkmcnt(5)
  ds_read_b128 a[236:239], v2 offset:44032
  ds_read_b64_tr_b16 a[252:253], v3 offset:2560
  ds_read_b64_tr_b16 a[254:255], v3 offset:3584
  v_rcp_f32 v59, v59
  v_exp_f32 v76, v76
  v_mfma_f32_32x32x16_bf16 v[24:39], v[112:115], a[224:227], v[24:39]
  ds_read_b128 a[224:227], v2 offset:45056
  ds_read_b64_tr_b16 v[112:113], v3 offset:4096
  ds_read_b64_tr_b16 v[114:115], v3 offset:5120
  v_rcp_f32 v60, v60
  v_exp_f32 v77, v77
  v_rcp_f32 v61, v61
  v_mfma_f32_32x32x16_bf16 v[24:39], v[116:119], a[228:231], v[24:39]
  s_waitcnt lgkmcnt(5)
  ds_read_b128 a[228:231], v2 offset:46080
  ds_read_b64_tr_b16 v[116:117], v3 offset:4608
  ds_read_b64_tr_b16 v[118:119], v3 offset:5632
  v_exp_f32 v78, v78
  v_rcp_f32 v62, v62
  v_mfma_f32_32x32x16_bf16 v[24:39], v[120:123], a[232:235], v[24:39]
  ds_read_b128 a[232:235], v2 offset:47104
  ds_read_b64_tr_b16 v[120:121], v3 offset:6144
  ds_read_b64_tr_b16 v[122:123], v3 offset:7168
  v_exp_f32 v79, v79
  v_rcp_f32 v63, v63
  v_exp_f32 v80, v80
  v_mfma_f32_32x32x16_bf16 v[24:39], v[124:127], a[236:239], v[24:39]
  s_waitcnt lgkmcnt(5)
  ds_read_b128 a[236:239], v2 offset:48128
  ds_read_b64_tr_b16 v[124:125], v3 offset:6656
  ds_read_b64_tr_b16 v[126:127], v3 offset:7680
  v_rcp_f32 v64, v64
  v_exp_f32 v81, v81
  v_mfma_f32_32x32x16_bf16 v[24:39], v[128:131], a[224:227], v[24:39]
  ds_read_b128 a[224:227], v1 offset:0
  ds_read_b64_tr_b16 v[128:129], v3 offset:8192
  ds_read_b64_tr_b16 v[130:131], v3 offset:9216
  v_rcp_f32 v65, v65
  v_exp_f32 v82, v82
  v_rcp_f32 v66, v66
  v_mfma_f32_32x32x16_bf16 v[24:39], v[132:135], a[228:231], v[24:39]
  s_waitcnt lgkmcnt(5)
  ds_read_b128 a[228:231], v1 offset:1024
  ds_read_b64_tr_b16 v[132:133], v3 offset:8704
  ds_read_b64_tr_b16 v[134:135], v3 offset:9728
  v_exp_f32 v83, v83
  v_rcp_f32 v67, v67
  v_mfma_f32_32x32x16_bf16 v[24:39], v[136:139], a[232:235], v[24:39]
  ds_read_b128 a[232:235], v1 offset:2048
  ds_read_b64_tr_b16 v[136:137], v3 offset:10240
  ds_read_b64_tr_b16 v[138:139], v3 offset:11264
  v_exp_f32 v84, v84
  v_rcp_f32 v68, v68
  v_exp_f32 v85, v85
  v_mfma_f32_32x32x16_bf16 v[24:39], v[140:143], a[236:239], v[24:39]
  ds_read_b128 a[236:239], v1 offset:3072
  ds_read_b64_tr_b16 v[140:141], v3 offset:10752
  ds_read_b64_tr_b16 v[142:143], v3 offset:11776
  v_rcp_f32 v69, v69
  v_exp_f32 v86, v86
  v_rcp_f32 v70, v70
  v_exp_f32 v87, v87
  v_rcp_f32_e64 v71, v71
  v_pk_mul_f32 v[56:57], v[56:57], v[40:41]
  v_pk_mul_f32 v[58:59], v[58:59], v[42:43]
  v_pk_mul_f32 v[60:61], v[60:61], v[44:45]
  v_pk_mul_f32 v[62:63], v[62:63], v[46:47]
  v_pk_mul_f32 v[64:65], v[64:65], v[48:49]
  v_pk_mul_f32 v[66:67], v[66:67], v[50:51]
  v_pk_mul_f32 v[68:69], v[68:69], v[52:53]
  v_pk_mul_f32 v[70:71], v[70:71], v[54:55]
  v_pk_add_f32 v[72:73], v[72:73], 1.0 op_sel_hi:[1,0]
  v_pk_add_f32 v[74:75], v[74:75], 1.0 op_sel_hi:[1,0]
  v_pk_add_f32 v[76:77], v[76:77], 1.0 op_sel_hi:[1,0]
  v_pk_add_f32 v[78:79], v[78:79], 1.0 op_sel_hi:[1,0]
  v_pk_add_f32 v[80:81], v[80:81], 1.0 op_sel_hi:[1,0]
  v_pk_add_f32 v[82:83], v[82:83], 1.0 op_sel_hi:[1,0]
  v_pk_add_f32 v[84:85], v[84:85], 1.0 op_sel_hi:[1,0]
  v_pk_add_f32 v[86:87], v[86:87], 1.0 op_sel_hi:[1,0]
  v_pk_fma_f32 v[88:89], v[56:57], v[56:57], v[88:89]
  v_pk_fma_f32 v[90:91], v[58:59], v[58:59], v[90:91]
  v_pk_fma_f32 v[92:93], v[60:61], v[60:61], v[92:93]
  v_pk_fma_f32 v[94:95], v[62:63], v[62:63], v[94:95]
  v_pk_fma_f32 v[96:97], v[64:65], v[64:65], v[96:97]
  v_pk_fma_f32 v[98:99], v[66:67], v[66:67], v[98:99]
  v_pk_fma_f32 v[100:101], v[68:69], v[68:69], v[100:101]
  v_pk_fma_f32 v[102:103], v[70:71], v[70:71], v[102:103]
  v_cvt_pk_bf16_f32 v176, v56, v57
  v_cvt_pk_bf16_f32 v177, v58, v59
  v_cvt_pk_bf16_f32 v178, v60, v61
  v_cvt_pk_bf16_f32 v179, v62, v63
  v_cvt_pk_bf16_f32 v180, v64, v65
  v_cvt_pk_bf16_f32 v181, v66, v67
  v_cvt_pk_bf16_f32 v182, v68, v69
  v_cvt_pk_bf16_f32 v183, v70, v71
  v_pk_fma_f32 v[56:57], v[24:25], v[24:25], s[50:51] neg_lo:[1,0,0] neg_hi:[1,0,0]
  v_pk_fma_f32 v[58:59], v[26:27], v[26:27], s[50:51] neg_lo:[1,0,0] neg_hi:[1,0,0]
  v_pk_fma_f32 v[60:61], v[28:29], v[28:29], s[50:51] neg_lo:[1,0,0] neg_hi:[1,0,0]
  v_pk_fma_f32 v[62:63], v[30:31], v[30:31], s[50:51] neg_lo:[1,0,0] neg_hi:[1,0,0]
  v_pk_fma_f32 v[64:65], v[32:33], v[32:33], s[50:51] neg_lo:[1,0,0] neg_hi:[1,0,0]
  v_pk_fma_f32 v[66:67], v[34:35], v[34:35], s[50:51] neg_lo:[1,0,0] neg_hi:[1,0,0]
  v_pk_fma_f32 v[68:69], v[36:37], v[36:37], s[50:51] neg_lo:[1,0,0] neg_hi:[1,0,0]
  v_pk_fma_f32 v[70:71], v[38:39], v[38:39], s[50:51] neg_lo:[1,0,0] neg_hi:[1,0,0]
  v_pk_mul_f32 v[56:57], v[56:57], v[24:25]
  v_pk_mul_f32 v[58:59], v[58:59], v[26:27]
  v_pk_mul_f32 v[60:61], v[60:61], v[28:29]
  v_pk_mul_f32 v[62:63], v[62:63], v[30:31]
  v_pk_mul_f32 v[64:65], v[64:65], v[32:33]
  v_pk_mul_f32 v[66:67], v[66:67], v[34:35]
  v_pk_mul_f32 v[68:69], v[68:69], v[36:37]
  v_pk_mul_f32 v[70:71], v[70:71], v[38:39]
  s_waitcnt lgkmcnt(8)
  v_mfma_f32_32x32x16_bf16 v[40:55], a[240:243], a[224:227], 0
  ds_read_b128 a[224:227], v1 offset:4096
  v_exp_f32 v56, v56
  v_rcp_f32 v72, v72
  v_mfma_f32_32x32x16_bf16 v[40:55], a[244:247], a[228:231], v[40:55]
  s_waitcnt lgkmcnt(3)
  ds_read_b128 a[228:231], v1 offset:5120
  v_exp_f32 v57, v57
  v_rcp_f32 v73, v73
  v_mfma_f32_32x32x16_bf16 v[40:55], a[248:251], a[232:235], v[40:55]
  ds_read_b128 a[232:235], v1 offset:6144
  v_exp_f32 v58, v58
  v_rcp_f32 v74, v74
  v_exp_f32 v59, v59
  v_mfma_f32_32x32x16_bf16 v[40:55], a[252:255], a[236:239], v[40:55]
  s_waitcnt lgkmcnt(1)
  ds_read_b128 a[236:239], v1 offset:7168
  v_rcp_f32 v75, v75
  v_exp_f32 v60, v60
  v_mfma_f32_32x32x16_bf16 v[40:55], v[112:115], a[224:227], v[40:55]
  ds_read_b128 a[224:227], v1 offset:8192
  v_rcp_f32 v76, v76
  v_exp_f32 v61, v61
  v_rcp_f32 v77, v77
  v_mfma_f32_32x32x16_bf16 v[40:55], v[116:119], a[228:231], v[40:55]
  s_waitcnt lgkmcnt(1)
  ds_read_b128 a[228:231], v1 offset:9216
  v_exp_f32 v62, v62
  v_rcp_f32 v78, v78
  v_mfma_f32_32x32x16_bf16 v[40:55], v[120:123], a[232:235], v[40:55]
  ds_read_b128 a[232:235], v1 offset:10240
  v_exp_f32 v63, v63
  v_rcp_f32 v79, v79
  v_exp_f32 v64, v64
  v_mfma_f32_32x32x16_bf16 v[40:55], v[124:127], a[236:239], v[40:55]
  s_waitcnt lgkmcnt(1)
  ds_read_b128 a[236:239], v1 offset:11264
  v_rcp_f32 v80, v80
  v_exp_f32 v65, v65
  v_mfma_f32_32x32x16_bf16 v[40:55], v[128:131], a[224:227], v[40:55]
  ds_read_b128 a[224:227], v1 offset:12288
  v_rcp_f32 v81, v81
  v_exp_f32 v66, v66
  v_rcp_f32 v82, v82
  v_mfma_f32_32x32x16_bf16 v[40:55], v[132:135], a[228:231], v[40:55]
  s_waitcnt lgkmcnt(1)
  ds_read_b128 a[228:231], v1 offset:13312
  v_exp_f32 v67, v67
  v_rcp_f32 v83, v83
  v_mfma_f32_32x32x16_bf16 v[40:55], v[136:139], a[232:235], v[40:55]
  ds_read_b128 a[232:235], v1 offset:14336
  v_exp_f32 v68, v68
  v_rcp_f32 v84, v84
  v_exp_f32 v69, v69
  v_mfma_f32_32x32x16_bf16 v[40:55], v[140:143], a[236:239], v[40:55]
  ds_read_b128 a[236:239], v1 offset:15360
  v_rcp_f32 v85, v85
  v_exp_f32 v70, v70
  v_rcp_f32 v86, v86
  v_exp_f32 v71, v71
  v_rcp_f32 v87, v87
  v_pk_mul_f32 v[72:73], v[72:73], v[8:9]
  v_pk_mul_f32 v[74:75], v[74:75], v[10:11]
  v_pk_mul_f32 v[76:77], v[76:77], v[12:13]
  v_pk_mul_f32 v[78:79], v[78:79], v[14:15]
  v_pk_mul_f32 v[80:81], v[80:81], v[16:17]
  v_pk_mul_f32 v[82:83], v[82:83], v[18:19]
  v_pk_mul_f32 v[84:85], v[84:85], v[20:21]
  v_pk_mul_f32 v[86:87], v[86:87], v[22:23]
  v_pk_add_f32 v[56:57], v[56:57], 1.0 op_sel_hi:[1,0]
  v_pk_add_f32 v[58:59], v[58:59], 1.0 op_sel_hi:[1,0]
  v_pk_add_f32 v[60:61], v[60:61], 1.0 op_sel_hi:[1,0]
  v_pk_add_f32 v[62:63], v[62:63], 1.0 op_sel_hi:[1,0]
  v_pk_add_f32 v[64:65], v[64:65], 1.0 op_sel_hi:[1,0]
  v_pk_add_f32 v[66:67], v[66:67], 1.0 op_sel_hi:[1,0]
  v_pk_add_f32 v[68:69], v[68:69], 1.0 op_sel_hi:[1,0]
  v_pk_add_f32 v[70:71], v[70:71], 1.0 op_sel_hi:[1,0]
  v_pk_fma_f32 v[88:89], v[72:73], v[72:73], v[88:89]
  v_pk_fma_f32 v[90:91], v[74:75], v[74:75], v[90:91]
  v_pk_fma_f32 v[92:93], v[76:77], v[76:77], v[92:93]
  v_pk_fma_f32 v[94:95], v[78:79], v[78:79], v[94:95]
  v_pk_fma_f32 v[96:97], v[80:81], v[80:81], v[96:97]
  v_pk_fma_f32 v[98:99], v[82:83], v[82:83], v[98:99]
  v_pk_fma_f32 v[100:101], v[84:85], v[84:85], v[100:101]
  v_pk_fma_f32 v[102:103], v[86:87], v[86:87], v[102:103]
  v_cvt_pk_bf16_f32 v184, v72, v73
  v_cvt_pk_bf16_f32 v185, v74, v75
  v_cvt_pk_bf16_f32 v186, v76, v77
  v_cvt_pk_bf16_f32 v187, v78, v79
  v_cvt_pk_bf16_f32 v188, v80, v81
  v_cvt_pk_bf16_f32 v189, v82, v83
  v_cvt_pk_bf16_f32 v190, v84, v85
  v_cvt_pk_bf16_f32 v191, v86, v87
  v_pk_fma_f32 v[72:73], v[40:41], v[40:41], s[50:51] neg_lo:[1,0,0] neg_hi:[1,0,0]
  v_pk_fma_f32 v[74:75], v[42:43], v[42:43], s[50:51] neg_lo:[1,0,0] neg_hi:[1,0,0]
  v_pk_fma_f32 v[76:77], v[44:45], v[44:45], s[50:51] neg_lo:[1,0,0] neg_hi:[1,0,0]
  v_pk_fma_f32 v[78:79], v[46:47], v[46:47], s[50:51] neg_lo:[1,0,0] neg_hi:[1,0,0]
  v_pk_fma_f32 v[80:81], v[48:49], v[48:49], s[50:51] neg_lo:[1,0,0] neg_hi:[1,0,0]
  v_pk_fma_f32 v[82:83], v[50:51], v[50:51], s[50:51] neg_lo:[1,0,0] neg_hi:[1,0,0]
  v_pk_fma_f32 v[84:85], v[52:53], v[52:53], s[50:51] neg_lo:[1,0,0] neg_hi:[1,0,0]
  v_pk_fma_f32 v[86:87], v[54:55], v[54:55], s[50:51] neg_lo:[1,0,0] neg_hi:[1,0,0]
  v_pk_mul_f32 v[72:73], v[72:73], v[40:41]
  v_pk_mul_f32 v[74:75], v[74:75], v[42:43]
  v_pk_mul_f32 v[76:77], v[76:77], v[44:45]
  v_pk_mul_f32 v[78:79], v[78:79], v[46:47]
  v_pk_mul_f32 v[80:81], v[80:81], v[48:49]
  v_pk_mul_f32 v[82:83], v[82:83], v[50:51]
  v_pk_mul_f32 v[84:85], v[84:85], v[52:53]
  v_pk_mul_f32 v[86:87], v[86:87], v[54:55]
  s_waitcnt lgkmcnt(2)
  v_mfma_f32_32x32x16_bf16 v[8:23], a[240:243], a[224:227], 0
  ds_read_b128 a[224:227], v1 offset:16384
  v_exp_f32 v72, v72
  v_rcp_f32 v56, v56
  s_add_u32 m0, s56, 0
  v_mfma_f32_32x32x16_bf16 v[8:23], a[244:247], a[228:231], v[8:23]
  s_waitcnt lgkmcnt(1)
  buffer_load_dwordx4 v7, s[32:35], s84 offen offset:0 lds
  ds_read_b128 a[228:231], v1 offset:17408
  v_exp_f32 v73, v73
  v_rcp_f32 v57, v57
  v_mfma_f32_32x32x16_bf16 v[8:23], a[248:251], a[232:235], v[8:23]
  ds_read_b128 a[232:235], v1 offset:18432
  v_exp_f32 v74, v74
  v_rcp_f32 v58, v58
  v_exp_f32 v75, v75
  v_mfma_f32_32x32x16_bf16 v[8:23], a[252:255], a[236:239], v[8:23]
  s_waitcnt lgkmcnt(1)
  ds_read_b128 a[236:239], v1 offset:19456
  v_rcp_f32 v59, v59
  v_exp_f32 v76, v76
  v_mfma_f32_32x32x16_bf16 v[8:23], v[112:115], a[224:227], v[8:23]
  buffer_load_dwordx4 v7, s[32:35], s85 offen offset:1024 lds
  ds_read_b128 a[224:227], v1 offset:20480
  v_rcp_f32 v60, v60
  v_exp_f32 v77, v77
  v_rcp_f32 v61, v61
  v_mfma_f32_32x32x16_bf16 v[8:23], v[116:119], a[228:231], v[8:23]
  s_waitcnt lgkmcnt(1)
  ds_read_b128 a[228:231], v1 offset:21504
  v_exp_f32 v78, v78
  v_rcp_f32 v62, v62
  v_mfma_f32_32x32x16_bf16 v[8:23], v[120:123], a[232:235], v[8:23]
  ds_read_b128 a[232:235], v1 offset:22528
  v_exp_f32 v79, v79
  v_rcp_f32 v63, v63
  v_exp_f32 v80, v80
  v_mfma_f32_32x32x16_bf16 v[8:23], v[124:127], a[236:239], v[8:23]
  s_waitcnt lgkmcnt(1)
  buffer_load_dwordx4 v7, s[32:35], s86 offen offset:2048 lds
  ds_read_b128 a[236:239], v1 offset:23552
  v_rcp_f32 v64, v64
  v_exp_f32 v81, v81
  v_mfma_f32_32x32x16_bf16 v[8:23], v[128:131], a[224:227], v[8:23]
  ds_read_b128 a[224:227], v1 offset:24576
  v_rcp_f32 v65, v65
  v_exp_f32 v82, v82
  v_rcp_f32 v66, v66
  v_mfma_f32_32x32x16_bf16 v[8:23], v[132:135], a[228:231], v[8:23]
  s_waitcnt lgkmcnt(1)
  ds_read_b128 a[228:231], v1 offset:25600
  v_exp_f32 v83, v83
  v_rcp_f32 v67, v67
  v_mfma_f32_32x32x16_bf16 v[8:23], v[136:139], a[232:235], v[8:23]
  buffer_load_dwordx4 v7, s[32:35], s87 offen offset:3072 lds
  ds_read_b128 a[232:235], v1 offset:26624
  v_exp_f32 v84, v84
  v_rcp_f32 v68, v68
  v_exp_f32 v85, v85
  v_mfma_f32_32x32x16_bf16 v[8:23], v[140:143], a[236:239], v[8:23]
  ds_read_b128 a[236:239], v1 offset:27648
  v_rcp_f32 v69, v69
  v_exp_f32 v86, v86
  v_rcp_f32 v70, v70
  v_exp_f32 v87, v87
  v_rcp_f32_e64 v71, v71
  v_pk_mul_f32 v[56:57], v[56:57], v[24:25]
  v_pk_mul_f32 v[58:59], v[58:59], v[26:27]
  v_pk_mul_f32 v[60:61], v[60:61], v[28:29]
  v_pk_mul_f32 v[62:63], v[62:63], v[30:31]
  v_pk_mul_f32 v[64:65], v[64:65], v[32:33]
  v_pk_mul_f32 v[66:67], v[66:67], v[34:35]
  v_pk_mul_f32 v[68:69], v[68:69], v[36:37]
  v_pk_mul_f32 v[70:71], v[70:71], v[38:39]
  v_pk_add_f32 v[72:73], v[72:73], 1.0 op_sel_hi:[1,0]
  v_pk_add_f32 v[74:75], v[74:75], 1.0 op_sel_hi:[1,0]
  v_pk_add_f32 v[76:77], v[76:77], 1.0 op_sel_hi:[1,0]
  v_pk_add_f32 v[78:79], v[78:79], 1.0 op_sel_hi:[1,0]
  v_pk_add_f32 v[80:81], v[80:81], 1.0 op_sel_hi:[1,0]
  v_pk_add_f32 v[82:83], v[82:83], 1.0 op_sel_hi:[1,0]
  v_pk_add_f32 v[84:85], v[84:85], 1.0 op_sel_hi:[1,0]
  v_pk_add_f32 v[86:87], v[86:87], 1.0 op_sel_hi:[1,0]
  v_pk_fma_f32 v[88:89], v[56:57], v[56:57], v[88:89]
  v_pk_fma_f32 v[90:91], v[58:59], v[58:59], v[90:91]
  v_pk_fma_f32 v[92:93], v[60:61], v[60:61], v[92:93]
  v_pk_fma_f32 v[94:95], v[62:63], v[62:63], v[94:95]
  v_pk_fma_f32 v[96:97], v[64:65], v[64:65], v[96:97]
  v_pk_fma_f32 v[98:99], v[66:67], v[66:67], v[98:99]
  v_pk_fma_f32 v[100:101], v[68:69], v[68:69], v[100:101]
  v_pk_fma_f32 v[102:103], v[70:71], v[70:71], v[102:103]
  v_cvt_pk_bf16_f32 v192, v56, v57
  v_cvt_pk_bf16_f32 v193, v58, v59
  v_cvt_pk_bf16_f32 v194, v60, v61
  v_cvt_pk_bf16_f32 v195, v62, v63
  v_cvt_pk_bf16_f32 v196, v64, v65
  v_cvt_pk_bf16_f32 v197, v66, v67
  v_cvt_pk_bf16_f32 v198, v68, v69
  v_cvt_pk_bf16_f32 v199, v70, v71
  v_pk_fma_f32 v[56:57], v[8:9], v[8:9], s[50:51] neg_lo:[1,0,0] neg_hi:[1,0,0]
  v_pk_fma_f32 v[58:59], v[10:11], v[10:11], s[50:51] neg_lo:[1,0,0] neg_hi:[1,0,0]
  v_pk_fma_f32 v[60:61], v[12:13], v[12:13], s[50:51] neg_lo:[1,0,0] neg_hi:[1,0,0]
  v_pk_fma_f32 v[62:63], v[14:15], v[14:15], s[50:51] neg_lo:[1,0,0] neg_hi:[1,0,0]
  v_pk_fma_f32 v[64:65], v[16:17], v[16:17], s[50:51] neg_lo:[1,0,0] neg_hi:[1,0,0]
  v_pk_fma_f32 v[66:67], v[18:19], v[18:19], s[50:51] neg_lo:[1,0,0] neg_hi:[1,0,0]
  v_pk_fma_f32 v[68:69], v[20:21], v[20:21], s[50:51] neg_lo:[1,0,0] neg_hi:[1,0,0]
  v_pk_fma_f32 v[70:71], v[22:23], v[22:23], s[50:51] neg_lo:[1,0,0] neg_hi:[1,0,0]
  v_pk_mul_f32 v[56:57], v[56:57], v[8:9]
  v_pk_mul_f32 v[58:59], v[58:59], v[10:11]
  v_pk_mul_f32 v[60:61], v[60:61], v[12:13]
  v_pk_mul_f32 v[62:63], v[62:63], v[14:15]
  v_pk_mul_f32 v[64:65], v[64:65], v[16:17]
  v_pk_mul_f32 v[66:67], v[66:67], v[18:19]
  v_pk_mul_f32 v[68:69], v[68:69], v[20:21]
  v_pk_mul_f32 v[70:71], v[70:71], v[22:23]
  s_waitcnt lgkmcnt(2)
  v_mfma_f32_32x32x16_bf16 v[24:39], a[240:243], a[224:227], 0
  ds_read_b128 a[224:227], v1 offset:28672
  v_exp_f32 v56, v56
  v_add_f32_dpp v88, v88, v88 row_ror:8 row_mask:0xf bank_mask:0x3
  v_rcp_f32 v72, v72
  v_add_f32_dpp v89, v89, v89 row_ror:8 row_mask:0xf bank_mask:0x3
  v_exp_f32 v57, v57
  s_add_u32 m0, s56, 4096
  v_mfma_f32_32x32x16_bf16 v[24:39], a[244:247], a[228:231], v[24:39]
  s_waitcnt lgkmcnt(1)
  buffer_load_dwordx4 v7, s[32:35], s88 offen offset:0 lds
  ds_read_b128 a[228:231], v1 offset:29696
  v_add_f32_dpp v90, v90, v90 row_ror:8 row_mask:0xf bank_mask:0x3
  v_rcp_f32 v73, v73
  v_add_f32_dpp v91, v91, v91 row_ror:8 row_mask:0xf bank_mask:0x3
  v_exp_f32 v58, v58
  v_add_f32_dpp v92, v92, v92 row_ror:8 row_mask:0xf bank_mask:0x3
  v_rcp_f32 v74, v74
  v_mfma_f32_32x32x16_bf16 v[24:39], a[248:251], a[232:235], v[24:39]
  ds_read_b128 a[232:235], v1 offset:30720
  v_add_f32_dpp v93, v93, v93 row_ror:8 row_mask:0xf bank_mask:0x3
  v_exp_f32 v59, v59
  v_add_f32_dpp v94, v94, v94 row_ror:8 row_mask:0xf bank_mask:0x3
  v_add_f32_dpp v95, v95, v95 row_ror:8 row_mask:0xf bank_mask:0x3
  v_rcp_f32 v75, v75
  v_add_f32_dpp v88, v96, v96 row_ror:8 row_mask:0xf bank_mask:0xc
  v_mfma_f32_32x32x16_bf16 v[24:39], a[252:255], a[236:239], v[24:39]
  s_waitcnt lgkmcnt(1)
  ds_read_b128 a[236:239], v1 offset:31744
  v_exp_f32 v60, v60
  v_add_f32_dpp v89, v97, v97 row_ror:8 row_mask:0xf bank_mask:0xc
  v_rcp_f32 v76, v76
  v_add_f32_dpp v90, v98, v98 row_ror:8 row_mask:0xf bank_mask:0xc
  v_exp_f32 v61, v61
  v_add_f32_dpp v91, v99, v99 row_ror:8 row_mask:0xf bank_mask:0xc
  v_mfma_f32_32x32x16_bf16 v[24:39], v[112:115], a[224:227], v[24:39]
  buffer_load_dwordx4 v7, s[32:35], s89 offen offset:1024 lds
  ds_read_b128 a[224:227], v1 offset:32768
  v_rcp_f32 v77, v77
  v_add_f32_dpp v92, v100, v100 row_ror:8 row_mask:0xf bank_mask:0xc
  v_exp_f32 v62, v62
  v_add_f32_dpp v93, v101, v101 row_ror:8 row_mask:0xf bank_mask:0xc
  v_add_f32_dpp v94, v102, v102 row_ror:8 row_mask:0xf bank_mask:0xc
  v_rcp_f32 v78, v78
  v_mfma_f32_32x32x16_bf16 v[24:39], v[116:119], a[228:231], v[24:39]
  s_waitcnt lgkmcnt(1)
  ds_read_b128 a[228:231], v1 offset:33792
  v_add_f32_dpp v95, v103, v103 row_ror:8 row_mask:0xf bank_mask:0xc
  v_exp_f32 v63, v63
  v_add_f32_dpp v88, v88, v88 row_shl:4 row_mask:0xf bank_mask:0x5
  v_rcp_f32 v79, v79
  v_add_f32_dpp v89, v89, v89 row_shl:4 row_mask:0xf bank_mask:0x5
  v_mfma_f32_32x32x16_bf16 v[24:39], v[120:123], a[232:235], v[24:39]
  ds_read_b128 a[232:235], v1 offset:34816
  v_exp_f32 v64, v64
  v_add_f32_dpp v90, v90, v90 row_shl:4 row_mask:0xf bank_mask:0x5
  v_rcp_f32 v80, v80
  v_add_f32_dpp v91, v91, v91 row_shl:4 row_mask:0xf bank_mask:0x5
  v_exp_f32 v65, v65
  v_add_f32_dpp v88, v92, v92 row_shr:4 row_mask:0xf bank_mask:0xa
  v_mfma_f32_32x32x16_bf16 v[24:39], v[124:127], a[236:239], v[24:39]
  s_waitcnt lgkmcnt(1)
  buffer_load_dwordx4 v7, s[32:35], s90 offen offset:2048 lds
  ds_read_b128 a[236:239], v1 offset:35840
  v_rcp_f32 v81, v81
  v_add_f32_dpp v89, v93, v93 row_shr:4 row_mask:0xf bank_mask:0xa
  v_add_f32_dpp v90, v94, v94 row_shr:4 row_mask:0xf bank_mask:0xa
  v_exp_f32 v66, v66
  v_add_f32_dpp v91, v95, v95 row_shr:4 row_mask:0xf bank_mask:0xa
  v_rcp_f32 v82, v82
  v_mfma_f32_32x32x16_bf16 v[24:39], v[128:131], a[224:227], v[24:39]
  ds_read_b128 a[224:227], v2 offset:0
  v_add_f32_dpp v92, v88, v88 quad_perm:[2,3,0,1] row_mask:0xf bank_mask:0xf
  v_exp_f32 v67, v67
  v_add_f32_dpp v93, v89, v89 quad_perm:[2,3,0,1] row_mask:0xf bank_mask:0xf
  v_rcp_f32 v83, v83
  v_add_f32_dpp v94, v90, v90 quad_perm:[2,3,0,1] row_mask:0xf bank_mask:0xf
  v_exp_f32 v68, v68
  v_mfma_f32_32x32x16_bf16 v[24:39], v[132:135], a[228:231], v[24:39]
  s_waitcnt lgkmcnt(1)
  ds_read_b128 a[228:231], v2 offset:1024
  v_add_f32_dpp v95, v91, v91 quad_perm:[2,3,0,1] row_mask:0xf bank_mask:0xf
  v_rcp_f32 v84, v84
  v_cndmask_b32 v88, v92, v94, s[64:65]
  v_cndmask_b32 v89, v93, v95, s[64:65]
  v_exp_f32 v69, v69
  v_add_f32_dpp v90, v88, v88 quad_perm:[1,0,3,2] row_mask:0xf bank_mask:0xf
  v_mfma_f32_32x32x16_bf16 v[24:39], v[136:139], a[232:235], v[24:39]
  buffer_load_dwordx4 v7, s[32:35], s91 offen offset:3072 lds
  ds_read_b128 a[232:235], v2 offset:2048
  v_rcp_f32 v85, v85
  v_add_f32_dpp v91, v89, v89 quad_perm:[1,0,3,2] row_mask:0xf bank_mask:0xf
  v_exp_f32 v70, v70
  v_cndmask_b32 v92, v90, v91, s[58:59]
  v_rcp_f32 v86, v86
  v_mov_b32 v6, v92
  v_mfma_f32_32x32x16_bf16 v[24:39], v[140:143], a[236:239], v[24:39]
  ds_read_b128 a[236:239], v2 offset:3072
  v_exp_f32 v71, v71
  v_permlane16_swap_b32 v92, v6
  v_rcp_f32 v87, v87
  v_add_f32 v6, v6, v92
  s_mov_b32 exec_lo, 0xffff
  s_mov_b32 exec_hi, 0xffff
  buffer_atomic_add_f32 v6, v5, s[4:7], 0 offen offset:512
  s_mov_b64 exec, -1
  v_pk_mul_f32 v[72:73], v[72:73], v[40:41]
  v_pk_mul_f32 v[74:75], v[74:75], v[42:43]
  v_pk_mul_f32 v[76:77], v[76:77], v[44:45]
  v_pk_mul_f32 v[78:79], v[78:79], v[46:47]
  v_pk_mul_f32 v[80:81], v[80:81], v[48:49]
  v_pk_mul_f32 v[82:83], v[82:83], v[50:51]
  v_pk_mul_f32 v[84:85], v[84:85], v[52:53]
  v_pk_mul_f32 v[86:87], v[86:87], v[54:55]
  v_pk_add_f32 v[56:57], v[56:57], 1.0 op_sel_hi:[1,0]
  v_pk_add_f32 v[58:59], v[58:59], 1.0 op_sel_hi:[1,0]
  v_pk_add_f32 v[60:61], v[60:61], 1.0 op_sel_hi:[1,0]
  v_pk_add_f32 v[62:63], v[62:63], 1.0 op_sel_hi:[1,0]
  v_pk_add_f32 v[64:65], v[64:65], 1.0 op_sel_hi:[1,0]
  v_pk_add_f32 v[66:67], v[66:67], 1.0 op_sel_hi:[1,0]
  v_pk_add_f32 v[68:69], v[68:69], 1.0 op_sel_hi:[1,0]
  v_pk_add_f32 v[70:71], v[70:71], 1.0 op_sel_hi:[1,0]
  v_pk_mul_f32 v[88:89], v[72:73], v[72:73]
  v_pk_mul_f32 v[90:91], v[74:75], v[74:75]
  v_pk_mul_f32 v[92:93], v[76:77], v[76:77]
  v_pk_mul_f32 v[94:95], v[78:79], v[78:79]
  v_pk_mul_f32 v[96:97], v[80:81], v[80:81]
  v_pk_mul_f32 v[98:99], v[82:83], v[82:83]
  v_pk_mul_f32 v[100:101], v[84:85], v[84:85]
  v_pk_mul_f32 v[102:103], v[86:87], v[86:87]
  v_cvt_pk_bf16_f32 v200, v72, v73
  v_cvt_pk_bf16_f32 v201, v74, v75
  v_cvt_pk_bf16_f32 v202, v76, v77
  v_cvt_pk_bf16_f32 v203, v78, v79
  v_cvt_pk_bf16_f32 v204, v80, v81
  v_cvt_pk_bf16_f32 v205, v82, v83
  v_cvt_pk_bf16_f32 v206, v84, v85
  v_cvt_pk_bf16_f32 v207, v86, v87
  v_pk_fma_f32 v[72:73], v[24:25], v[24:25], s[50:51] neg_lo:[1,0,0] neg_hi:[1,0,0]
  v_pk_fma_f32 v[74:75], v[26:27], v[26:27], s[50:51] neg_lo:[1,0,0] neg_hi:[1,0,0]
  v_pk_fma_f32 v[76:77], v[28:29], v[28:29], s[50:51] neg_lo:[1,0,0] neg_hi:[1,0,0]
  v_pk_fma_f32 v[78:79], v[30:31], v[30:31], s[50:51] neg_lo:[1,0,0] neg_hi:[1,0,0]
  v_pk_fma_f32 v[80:81], v[32:33], v[32:33], s[50:51] neg_lo:[1,0,0] neg_hi:[1,0,0]
  v_pk_fma_f32 v[82:83], v[34:35], v[34:35], s[50:51] neg_lo:[1,0,0] neg_hi:[1,0,0]
  v_pk_fma_f32 v[84:85], v[36:37], v[36:37], s[50:51] neg_lo:[1,0,0] neg_hi:[1,0,0]
  v_pk_fma_f32 v[86:87], v[38:39], v[38:39], s[50:51] neg_lo:[1,0,0] neg_hi:[1,0,0]
  v_pk_mul_f32 v[72:73], v[72:73], v[24:25]
  v_pk_mul_f32 v[74:75], v[74:75], v[26:27]
  v_pk_mul_f32 v[76:77], v[76:77], v[28:29]
  v_pk_mul_f32 v[78:79], v[78:79], v[30:31]
  v_pk_mul_f32 v[80:81], v[80:81], v[32:33]
  v_pk_mul_f32 v[82:83], v[82:83], v[34:35]
  v_pk_mul_f32 v[84:85], v[84:85], v[36:37]
  v_pk_mul_f32 v[86:87], v[86:87], v[38:39]
  s_waitcnt lgkmcnt(2)
  v_mfma_f32_32x32x16_bf16 v[40:55], a[240:243], a[224:227], 0
  ds_read_b128 a[224:227], v2 offset:4096
  v_exp_f32 v72, v72
  v_rcp_f32 v56, v56
  s_add_u32 m0, s56, 8192
  v_mfma_f32_32x32x16_bf16 v[40:55], a[244:247], a[228:231], v[40:55]
  s_waitcnt lgkmcnt(1)
  buffer_load_dwordx4 v7, s[32:35], s92 offen offset:0 lds
  ds_read_b128 a[228:231], v2 offset:5120
  v_exp_f32 v73, v73
  v_rcp_f32 v57, v57
  v_mfma_f32_32x32x16_bf16 v[40:55], a[248:251], a[232:235], v[40:55]
  ds_read_b128 a[232:235], v2 offset:6144
  v_exp_f32 v74, v74
  v_rcp_f32 v58, v58
  v_exp_f32 v75, v75
  v_mfma_f32_32x32x16_bf16 v[40:55], a[252:255], a[236:239], v[40:55]
  s_waitcnt lgkmcnt(1)
  ds_read_b128 a[236:239], v2 offset:7168
  v_rcp_f32 v59, v59
  v_exp_f32 v76, v76
  v_mfma_f32_32x32x16_bf16 v[40:55], v[112:115], a[224:227], v[40:55]
  buffer_load_dwordx4 v7, s[32:35], s93 offen offset:1024 lds
  ds_read_b128 a[224:227], v2 offset:8192
  v_rcp_f32 v60, v60
  v_exp_f32 v77, v77
  v_rcp_f32 v61, v61
  v_mfma_f32_32x32x16_bf16 v[40:55], v[116:119], a[228:231], v[40:55]
  s_waitcnt lgkmcnt(1)
  ds_read_b128 a[228:231], v2 offset:9216
  v_exp_f32 v78, v78
  v_rcp_f32 v62, v62
  v_mfma_f32_32x32x16_bf16 v[40:55], v[120:123], a[232:235], v[40:55]
  ds_read_b128 a[232:235], v2 offset:10240
  v_exp_f32 v79, v79
  v_rcp_f32 v63, v63
  v_exp_f32 v80, v80
  v_mfma_f32_32x32x16_bf16 v[40:55], v[124:127], a[236:239], v[40:55]
  s_waitcnt lgkmcnt(1)
  buffer_load_dwordx4 v7, s[32:35], s94 offen offset:2048 lds
  ds_read_b128 a[236:239], v2 offset:11264
  v_rcp_f32 v64, v64
  v_exp_f32 v81, v81
  v_mfma_f32_32x32x16_bf16 v[40:55], v[128:131], a[224:227], v[40:55]
  ds_read_b128 a[224:227], v2 offset:12288
  v_rcp_f32 v65, v65
  v_exp_f32 v82, v82
  v_rcp_f32 v66, v66
  v_mfma_f32_32x32x16_bf16 v[40:55], v[132:135], a[228:231], v[40:55]
  s_waitcnt lgkmcnt(1)
  ds_read_b128 a[228:231], v2 offset:13312
  v_exp_f32 v83, v83
  v_rcp_f32 v67, v67
  v_mfma_f32_32x32x16_bf16 v[40:55], v[136:139], a[232:235], v[40:55]
  buffer_load_dwordx4 v7, s[32:35], s95 offen offset:3072 lds
  ds_read_b128 a[232:235], v2 offset:14336
  v_exp_f32 v84, v84
  v_rcp_f32 v68, v68
  v_exp_f32 v85, v85
  v_mfma_f32_32x32x16_bf16 v[40:55], v[140:143], a[236:239], v[40:55]
  ds_read_b128 a[236:239], v2 offset:15360
  v_rcp_f32 v69, v69
  v_exp_f32 v86, v86
  v_rcp_f32 v70, v70
  v_exp_f32 v87, v87
  v_rcp_f32 v71, v71
  v_pk_mul_f32 v[56:57], v[56:57], v[8:9]
  v_pk_mul_f32 v[58:59], v[58:59], v[10:11]
  v_pk_mul_f32 v[60:61], v[60:61], v[12:13]
  v_pk_mul_f32 v[62:63], v[62:63], v[14:15]
  v_pk_mul_f32 v[64:65], v[64:65], v[16:17]
  v_pk_mul_f32 v[66:67], v[66:67], v[18:19]
  v_pk_mul_f32 v[68:69], v[68:69], v[20:21]
  v_pk_mul_f32 v[70:71], v[70:71], v[22:23]
  v_pk_add_f32 v[72:73], v[72:73], 1.0 op_sel_hi:[1,0]
  v_pk_add_f32 v[74:75], v[74:75], 1.0 op_sel_hi:[1,0]
  v_pk_add_f32 v[76:77], v[76:77], 1.0 op_sel_hi:[1,0]
  v_pk_add_f32 v[78:79], v[78:79], 1.0 op_sel_hi:[1,0]
  v_pk_add_f32 v[80:81], v[80:81], 1.0 op_sel_hi:[1,0]
  v_pk_add_f32 v[82:83], v[82:83], 1.0 op_sel_hi:[1,0]
  v_pk_add_f32 v[84:85], v[84:85], 1.0 op_sel_hi:[1,0]
  v_pk_add_f32 v[86:87], v[86:87], 1.0 op_sel_hi:[1,0]
  v_pk_fma_f32 v[88:89], v[56:57], v[56:57], v[88:89]
  v_pk_fma_f32 v[90:91], v[58:59], v[58:59], v[90:91]
  v_pk_fma_f32 v[92:93], v[60:61], v[60:61], v[92:93]
  v_pk_fma_f32 v[94:95], v[62:63], v[62:63], v[94:95]
  v_pk_fma_f32 v[96:97], v[64:65], v[64:65], v[96:97]
  v_pk_fma_f32 v[98:99], v[66:67], v[66:67], v[98:99]
  v_pk_fma_f32 v[100:101], v[68:69], v[68:69], v[100:101]
  v_pk_fma_f32 v[102:103], v[70:71], v[70:71], v[102:103]
  v_cvt_pk_bf16_f32 v208, v56, v57
  v_cvt_pk_bf16_f32 v209, v58, v59
  v_cvt_pk_bf16_f32 v210, v60, v61
  v_cvt_pk_bf16_f32 v211, v62, v63
  v_cvt_pk_bf16_f32 v212, v64, v65
  v_cvt_pk_bf16_f32 v213, v66, v67
  v_cvt_pk_bf16_f32 v214, v68, v69
  v_cvt_pk_bf16_f32 v215, v70, v71
  v_pk_fma_f32 v[56:57], v[40:41], v[40:41], s[50:51] neg_lo:[1,0,0] neg_hi:[1,0,0]
  v_pk_fma_f32 v[58:59], v[42:43], v[42:43], s[50:51] neg_lo:[1,0,0] neg_hi:[1,0,0]
  v_pk_fma_f32 v[60:61], v[44:45], v[44:45], s[50:51] neg_lo:[1,0,0] neg_hi:[1,0,0]
  v_pk_fma_f32 v[62:63], v[46:47], v[46:47], s[50:51] neg_lo:[1,0,0] neg_hi:[1,0,0]
  v_pk_fma_f32 v[64:65], v[48:49], v[48:49], s[50:51] neg_lo:[1,0,0] neg_hi:[1,0,0]
  v_pk_fma_f32 v[66:67], v[50:51], v[50:51], s[50:51] neg_lo:[1,0,0] neg_hi:[1,0,0]
  v_pk_fma_f32 v[68:69], v[52:53], v[52:53], s[50:51] neg_lo:[1,0,0] neg_hi:[1,0,0]
  v_pk_fma_f32 v[70:71], v[54:55], v[54:55], s[50:51] neg_lo:[1,0,0] neg_hi:[1,0,0]
  v_pk_mul_f32 v[56:57], v[56:57], v[40:41]
  v_pk_mul_f32 v[58:59], v[58:59], v[42:43]
  v_pk_mul_f32 v[60:61], v[60:61], v[44:45]
  v_pk_mul_f32 v[62:63], v[62:63], v[46:47]
  v_pk_mul_f32 v[64:65], v[64:65], v[48:49]
  v_pk_mul_f32 v[66:67], v[66:67], v[50:51]
  v_pk_mul_f32 v[68:69], v[68:69], v[52:53]
  v_pk_mul_f32 v[70:71], v[70:71], v[54:55]
  s_waitcnt lgkmcnt(2)
  v_mfma_f32_32x32x16_bf16 v[8:23], a[240:243], a[224:227], 0
  ds_read_b128 a[224:227], v2 offset:16384
  v_exp_f32 v56, v56
  v_rcp_f32 v72, v72
  v_mfma_f32_32x32x16_bf16 v[8:23], a[244:247], a[228:231], v[8:23]
  s_waitcnt lgkmcnt(1)
  ds_read_b128 a[228:231], v2 offset:17408
  v_exp_f32 v57, v57
  v_rcp_f32 v73, v73
  v_mfma_f32_32x32x16_bf16 v[8:23], a[248:251], a[232:235], v[8:23]
  ds_read_b128 a[232:235], v2 offset:18432
  v_exp_f32 v58, v58
  v_rcp_f32 v74, v74
  v_exp_f32 v59, v59
  v_mfma_f32_32x32x16_bf16 v[8:23], a[252:255], a[236:239], v[8:23]
  s_waitcnt lgkmcnt(1)
  ds_read_b128 a[236:239], v2 offset:19456
  v_rcp_f32 v75, v75
  v_exp_f32 v60, v60
  v_mfma_f32_32x32x16_bf16 v[8:23], v[112:115], a[224:227], v[8:23]
  ds_read_b128 a[224:227], v2 offset:20480
  v_rcp_f32 v76, v76
  v_exp_f32 v61, v61
  v_rcp_f32 v77, v77
  v_mfma_f32_32x32x16_bf16 v[8:23], v[116:119], a[228:231], v[8:23]
  s_waitcnt lgkmcnt(1)
  ds_read_b128 a[228:231], v2 offset:21504
  v_exp_f32 v62, v62
  v_rcp_f32 v78, v78
  v_mfma_f32_32x32x16_bf16 v[8:23], v[120:123], a[232:235], v[8:23]
  ds_read_b128 a[232:235], v2 offset:22528
  v_exp_f32 v63, v63
  v_rcp_f32 v79, v79
  v_exp_f32 v64, v64
  v_mfma_f32_32x32x16_bf16 v[8:23], v[124:127], a[236:239], v[8:23]
  s_waitcnt lgkmcnt(1)
  ds_read_b128 a[236:239], v2 offset:23552
  v_rcp_f32 v80, v80
  v_exp_f32 v65, v65
  v_mfma_f32_32x32x16_bf16 v[8:23], v[128:131], a[224:227], v[8:23]
  ds_read_b128 a[224:227], v2 offset:24576
  v_rcp_f32 v81, v81
  v_exp_f32 v66, v66
  v_rcp_f32 v82, v82
  v_mfma_f32_32x32x16_bf16 v[8:23], v[132:135], a[228:231], v[8:23]
  s_waitcnt lgkmcnt(1)
  ds_read_b128 a[228:231], v2 offset:25600
  v_exp_f32 v67, v67
  v_rcp_f32 v83, v83
  v_mfma_f32_32x32x16_bf16 v[8:23], v[136:139], a[232:235], v[8:23]
  ds_read_b128 a[232:235], v2 offset:26624
  v_exp_f32 v68, v68
  v_rcp_f32 v84, v84
  v_exp_f32 v69, v69
  v_mfma_f32_32x32x16_bf16 v[8:23], v[140:143], a[236:239], v[8:23]
  ds_read_b128 a[236:239], v2 offset:27648
  v_rcp_f32 v85, v85
  v_exp_f32 v70, v70
  v_rcp_f32 v86, v86
  v_exp_f32 v71, v71
  v_rcp_f32 v87, v87
  v_pk_mul_f32 v[72:73], v[72:73], v[24:25]
  v_pk_mul_f32 v[74:75], v[74:75], v[26:27]
  v_pk_mul_f32 v[76:77], v[76:77], v[28:29]
  v_pk_mul_f32 v[78:79], v[78:79], v[30:31]
  v_pk_mul_f32 v[80:81], v[80:81], v[32:33]
  v_pk_mul_f32 v[82:83], v[82:83], v[34:35]
  v_pk_mul_f32 v[84:85], v[84:85], v[36:37]
  v_pk_mul_f32 v[86:87], v[86:87], v[38:39]
  v_pk_add_f32 v[56:57], v[56:57], 1.0 op_sel_hi:[1,0]
  v_pk_add_f32 v[58:59], v[58:59], 1.0 op_sel_hi:[1,0]
  v_pk_add_f32 v[60:61], v[60:61], 1.0 op_sel_hi:[1,0]
  v_pk_add_f32 v[62:63], v[62:63], 1.0 op_sel_hi:[1,0]
  v_pk_add_f32 v[64:65], v[64:65], 1.0 op_sel_hi:[1,0]
  v_pk_add_f32 v[66:67], v[66:67], 1.0 op_sel_hi:[1,0]
  v_pk_add_f32 v[68:69], v[68:69], 1.0 op_sel_hi:[1,0]
  v_pk_add_f32 v[70:71], v[70:71], 1.0 op_sel_hi:[1,0]
  v_pk_fma_f32 v[88:89], v[72:73], v[72:73], v[88:89]
  v_pk_fma_f32 v[90:91], v[74:75], v[74:75], v[90:91]
  v_pk_fma_f32 v[92:93], v[76:77], v[76:77], v[92:93]
  v_pk_fma_f32 v[94:95], v[78:79], v[78:79], v[94:95]
  v_pk_fma_f32 v[96:97], v[80:81], v[80:81], v[96:97]
  v_pk_fma_f32 v[98:99], v[82:83], v[82:83], v[98:99]
  v_pk_fma_f32 v[100:101], v[84:85], v[84:85], v[100:101]
  v_pk_fma_f32 v[102:103], v[86:87], v[86:87], v[102:103]
  v_cvt_pk_bf16_f32 v216, v72, v73
  v_cvt_pk_bf16_f32 v217, v74, v75
  v_cvt_pk_bf16_f32 v218, v76, v77
  v_cvt_pk_bf16_f32 v219, v78, v79
  v_cvt_pk_bf16_f32 v220, v80, v81
  v_cvt_pk_bf16_f32 v221, v82, v83
  v_cvt_pk_bf16_f32 v222, v84, v85
  v_cvt_pk_bf16_f32 v223, v86, v87
  v_pk_fma_f32 v[72:73], v[8:9], v[8:9], s[50:51] neg_lo:[1,0,0] neg_hi:[1,0,0]
  v_pk_fma_f32 v[74:75], v[10:11], v[10:11], s[50:51] neg_lo:[1,0,0] neg_hi:[1,0,0]
  v_pk_fma_f32 v[76:77], v[12:13], v[12:13], s[50:51] neg_lo:[1,0,0] neg_hi:[1,0,0]
  v_pk_fma_f32 v[78:79], v[14:15], v[14:15], s[50:51] neg_lo:[1,0,0] neg_hi:[1,0,0]
  v_pk_fma_f32 v[80:81], v[16:17], v[16:17], s[50:51] neg_lo:[1,0,0] neg_hi:[1,0,0]
  v_pk_fma_f32 v[82:83], v[18:19], v[18:19], s[50:51] neg_lo:[1,0,0] neg_hi:[1,0,0]
  v_pk_fma_f32 v[84:85], v[20:21], v[20:21], s[50:51] neg_lo:[1,0,0] neg_hi:[1,0,0]
  v_pk_fma_f32 v[86:87], v[22:23], v[22:23], s[50:51] neg_lo:[1,0,0] neg_hi:[1,0,0]
  v_pk_mul_f32 v[72:73], v[72:73], v[8:9]
  v_pk_mul_f32 v[74:75], v[74:75], v[10:11]
  v_pk_mul_f32 v[76:77], v[76:77], v[12:13]
  v_pk_mul_f32 v[78:79], v[78:79], v[14:15]
  v_pk_mul_f32 v[80:81], v[80:81], v[16:17]
  v_pk_mul_f32 v[82:83], v[82:83], v[18:19]
  v_pk_mul_f32 v[84:85], v[84:85], v[20:21]
  v_pk_mul_f32 v[86:87], v[86:87], v[22:23]
  s_waitcnt lgkmcnt(2)
  v_mfma_f32_32x32x16_bf16 v[24:39], a[240:243], a[224:227], 0
  ds_read_b128 a[224:227], v2 offset:28672
  v_exp_f32 v72, v72
  v_rcp_f32 v56, v56
  v_mfma_f32_32x32x16_bf16 v[24:39], a[244:247], a[228:231], v[24:39]
  s_waitcnt lgkmcnt(1)
  ds_read_b128 a[228:231], v2 offset:29696
  v_exp_f32 v73, v73
  v_rcp_f32 v57, v57
  v_mfma_f32_32x32x16_bf16 v[24:39], a[248:251], a[232:235], v[24:39]
  ds_read_b128 a[232:235], v2 offset:30720
  v_exp_f32 v74, v74
  v_rcp_f32 v58, v58
  v_exp_f32 v75, v75
  v_mfma_f32_32x32x16_bf16 v[24:39], a[252:255], a[236:239], v[24:39]
  s_waitcnt lgkmcnt(1)
  ds_read_b128 a[236:239], v2 offset:31744
  v_rcp_f32 v59, v59
  v_exp_f32 v76, v76
  v_mfma_f32_32x32x16_bf16 v[24:39], v[112:115], a[224:227], v[24:39]
  ds_read_b128 a[224:227], v2 offset:32768
  v_rcp_f32 v60, v60
  v_exp_f32 v77, v77
  v_rcp_f32 v61, v61
  v_mfma_f32_32x32x16_bf16 v[24:39], v[116:119], a[228:231], v[24:39]
  s_waitcnt lgkmcnt(1)
  ds_read_b128 a[228:231], v2 offset:33792
  v_exp_f32 v78, v78
  v_rcp_f32 v62, v62
  v_mfma_f32_32x32x16_bf16 v[24:39], v[120:123], a[232:235], v[24:39]
  ds_read_b128 a[232:235], v2 offset:34816
  v_exp_f32 v79, v79
  v_rcp_f32 v63, v63
  v_exp_f32 v80, v80
  v_mfma_f32_32x32x16_bf16 v[24:39], v[124:127], a[236:239], v[24:39]
  s_waitcnt lgkmcnt(1)
  ds_read_b128 a[236:239], v2 offset:35840
  v_rcp_f32 v64, v64
  v_exp_f32 v81, v81
  v_mfma_f32_32x32x16_bf16 v[24:39], v[128:131], a[224:227], v[24:39]
  ds_read_b128 a[224:227], v2 offset:36864
  v_rcp_f32 v65, v65
  v_exp_f32 v82, v82
  v_rcp_f32 v66, v66
  v_mfma_f32_32x32x16_bf16 v[24:39], v[132:135], a[228:231], v[24:39]
  s_waitcnt lgkmcnt(1)
  ds_read_b128 a[228:231], v2 offset:37888
  v_exp_f32 v83, v83
  v_rcp_f32 v67, v67
  v_mfma_f32_32x32x16_bf16 v[24:39], v[136:139], a[232:235], v[24:39]
  ds_read_b128 a[232:235], v2 offset:38912
  v_exp_f32 v84, v84
  v_rcp_f32 v68, v68
  v_exp_f32 v85, v85
  v_mfma_f32_32x32x16_bf16 v[24:39], v[140:143], a[236:239], v[24:39]
  ds_read_b128 a[236:239], v2 offset:39936
  v_rcp_f32 v69, v69
  v_exp_f32 v86, v86
  v_rcp_f32 v70, v70
  v_exp_f32 v87, v87
  v_rcp_f32 v71, v71
  v_pk_mul_f32 v[56:57], v[56:57], v[40:41]
  v_pk_mul_f32 v[58:59], v[58:59], v[42:43]
  v_pk_mul_f32 v[60:61], v[60:61], v[44:45]
  v_pk_mul_f32 v[62:63], v[62:63], v[46:47]
  v_pk_mul_f32 v[64:65], v[64:65], v[48:49]
  v_pk_mul_f32 v[66:67], v[66:67], v[50:51]
  v_pk_mul_f32 v[68:69], v[68:69], v[52:53]
  v_pk_mul_f32 v[70:71], v[70:71], v[54:55]
  v_pk_add_f32 v[72:73], v[72:73], 1.0 op_sel_hi:[1,0]
  v_pk_add_f32 v[74:75], v[74:75], 1.0 op_sel_hi:[1,0]
  v_pk_add_f32 v[76:77], v[76:77], 1.0 op_sel_hi:[1,0]
  v_pk_add_f32 v[78:79], v[78:79], 1.0 op_sel_hi:[1,0]
  v_pk_add_f32 v[80:81], v[80:81], 1.0 op_sel_hi:[1,0]
  v_pk_add_f32 v[82:83], v[82:83], 1.0 op_sel_hi:[1,0]
  v_pk_add_f32 v[84:85], v[84:85], 1.0 op_sel_hi:[1,0]
  v_pk_add_f32 v[86:87], v[86:87], 1.0 op_sel_hi:[1,0]
  v_pk_fma_f32 v[88:89], v[56:57], v[56:57], v[88:89]
  v_pk_fma_f32 v[90:91], v[58:59], v[58:59], v[90:91]
  v_pk_fma_f32 v[92:93], v[60:61], v[60:61], v[92:93]
  v_pk_fma_f32 v[94:95], v[62:63], v[62:63], v[94:95]
  v_pk_fma_f32 v[96:97], v[64:65], v[64:65], v[96:97]
  v_pk_fma_f32 v[98:99], v[66:67], v[66:67], v[98:99]
  v_pk_fma_f32 v[100:101], v[68:69], v[68:69], v[100:101]
  v_pk_fma_f32 v[102:103], v[70:71], v[70:71], v[102:103]
  v_cvt_pk_bf16_f32 v224, v56, v57
  v_cvt_pk_bf16_f32 v225, v58, v59
  v_cvt_pk_bf16_f32 v226, v60, v61
  v_cvt_pk_bf16_f32 v227, v62, v63
  v_cvt_pk_bf16_f32 v228, v64, v65
  v_cvt_pk_bf16_f32 v229, v66, v67
  v_cvt_pk_bf16_f32 v230, v68, v69
  v_cvt_pk_bf16_f32 v231, v70, v71
  v_pk_fma_f32 v[56:57], v[24:25], v[24:25], s[50:51] neg_lo:[1,0,0] neg_hi:[1,0,0]
  v_pk_fma_f32 v[58:59], v[26:27], v[26:27], s[50:51] neg_lo:[1,0,0] neg_hi:[1,0,0]
  v_pk_fma_f32 v[60:61], v[28:29], v[28:29], s[50:51] neg_lo:[1,0,0] neg_hi:[1,0,0]
  v_pk_fma_f32 v[62:63], v[30:31], v[30:31], s[50:51] neg_lo:[1,0,0] neg_hi:[1,0,0]
  v_pk_fma_f32 v[64:65], v[32:33], v[32:33], s[50:51] neg_lo:[1,0,0] neg_hi:[1,0,0]
  v_pk_fma_f32 v[66:67], v[34:35], v[34:35], s[50:51] neg_lo:[1,0,0] neg_hi:[1,0,0]
  v_pk_fma_f32 v[68:69], v[36:37], v[36:37], s[50:51] neg_lo:[1,0,0] neg_hi:[1,0,0]
  v_pk_fma_f32 v[70:71], v[38:39], v[38:39], s[50:51] neg_lo:[1,0,0] neg_hi:[1,0,0]
  v_pk_mul_f32 v[56:57], v[56:57], v[24:25]
  v_pk_mul_f32 v[58:59], v[58:59], v[26:27]
  v_pk_mul_f32 v[60:61], v[60:61], v[28:29]
  v_pk_mul_f32 v[62:63], v[62:63], v[30:31]
  v_pk_mul_f32 v[64:65], v[64:65], v[32:33]
  v_pk_mul_f32 v[66:67], v[66:67], v[34:35]
  v_pk_mul_f32 v[68:69], v[68:69], v[36:37]
  v_pk_mul_f32 v[70:71], v[70:71], v[38:39]
  s_waitcnt lgkmcnt(2)
  v_mfma_f32_32x32x16_bf16 v[40:55], a[240:243], a[224:227], 0
  ds_read_b128 a[224:227], v2 offset:40960
  v_exp_f32 v56, v56
  v_rcp_f32 v72, v72
  v_mfma_f32_32x32x16_bf16 v[40:55], a[244:247], a[228:231], v[40:55]
  s_waitcnt lgkmcnt(1)
  ds_read_b128 a[228:231], v2 offset:41984
  v_exp_f32 v57, v57
  v_rcp_f32 v73, v73
  v_mfma_f32_32x32x16_bf16 v[40:55], a[248:251], a[232:235], v[40:55]
  ds_read_b128 a[232:235], v2 offset:43008
  v_exp_f32 v58, v58
  v_rcp_f32 v74, v74
  v_exp_f32 v59, v59
  v_mfma_f32_32x32x16_bf16 v[40:55], a[252:255], a[236:239], v[40:55]
  s_waitcnt lgkmcnt(1)
  ds_read_b128 a[236:239], v2 offset:44032
  v_rcp_f32 v75, v75
  v_exp_f32 v60, v60
  v_mfma_f32_32x32x16_bf16 v[40:55], v[112:115], a[224:227], v[40:55]
  ds_read_b128 a[224:227], v2 offset:45056
  v_rcp_f32 v76, v76
  v_exp_f32 v61, v61
  v_rcp_f32 v77, v77
  v_mfma_f32_32x32x16_bf16 v[40:55], v[116:119], a[228:231], v[40:55]
  s_waitcnt lgkmcnt(1)
  ds_read_b128 a[228:231], v2 offset:46080
  v_exp_f32 v62, v62
  v_rcp_f32 v78, v78
  v_mfma_f32_32x32x16_bf16 v[40:55], v[120:123], a[232:235], v[40:55]
  ds_read_b128 a[232:235], v2 offset:47104
  v_exp_f32 v63, v63
  v_rcp_f32 v79, v79
  v_exp_f32 v64, v64
  v_mfma_f32_32x32x16_bf16 v[40:55], v[124:127], a[236:239], v[40:55]
  s_waitcnt lgkmcnt(1)
  ds_read_b128 a[236:239], v2 offset:48128
  v_rcp_f32 v80, v80
  v_exp_f32 v65, v65
  v_mfma_f32_32x32x16_bf16 v[40:55], v[128:131], a[224:227], v[40:55]
  v_rcp_f32 v81, v81
  v_exp_f32 v66, v66
  v_rcp_f32 v82, v82
  v_mfma_f32_32x32x16_bf16 v[40:55], v[132:135], a[228:231], v[40:55]
  s_waitcnt lgkmcnt(0)
  v_exp_f32 v67, v67
  v_rcp_f32 v83, v83
  v_mfma_f32_32x32x16_bf16 v[40:55], v[136:139], a[232:235], v[40:55]
  v_exp_f32 v68, v68
  v_rcp_f32 v84, v84
  v_exp_f32 v69, v69
  v_mfma_f32_32x32x16_bf16 v[40:55], v[140:143], a[236:239], v[40:55]
  v_rcp_f32 v85, v85
  v_exp_f32 v70, v70
  v_rcp_f32 v86, v86
  v_exp_f32 v71, v71
  v_rcp_f32 v87, v87
  v_pk_mul_f32 v[72:73], v[72:73], v[8:9]
  v_pk_mul_f32 v[74:75], v[74:75], v[10:11]
  v_pk_mul_f32 v[76:77], v[76:77], v[12:13]
  v_pk_mul_f32 v[78:79], v[78:79], v[14:15]
  v_pk_mul_f32 v[80:81], v[80:81], v[16:17]
  v_pk_mul_f32 v[82:83], v[82:83], v[18:19]
  v_pk_mul_f32 v[84:85], v[84:85], v[20:21]
  v_pk_mul_f32 v[86:87], v[86:87], v[22:23]
  v_pk_add_f32 v[56:57], v[56:57], 1.0 op_sel_hi:[1,0]
  v_pk_add_f32 v[58:59], v[58:59], 1.0 op_sel_hi:[1,0]
  v_pk_add_f32 v[60:61], v[60:61], 1.0 op_sel_hi:[1,0]
  v_pk_add_f32 v[62:63], v[62:63], 1.0 op_sel_hi:[1,0]
  v_pk_add_f32 v[64:65], v[64:65], 1.0 op_sel_hi:[1,0]
  v_pk_add_f32 v[66:67], v[66:67], 1.0 op_sel_hi:[1,0]
  v_pk_add_f32 v[68:69], v[68:69], 1.0 op_sel_hi:[1,0]
  v_pk_add_f32 v[70:71], v[70:71], 1.0 op_sel_hi:[1,0]
  v_pk_fma_f32 v[88:89], v[72:73], v[72:73], v[88:89]
  v_pk_fma_f32 v[90:91], v[74:75], v[74:75], v[90:91]
  v_pk_fma_f32 v[92:93], v[76:77], v[76:77], v[92:93]
  v_pk_fma_f32 v[94:95], v[78:79], v[78:79], v[94:95]
  v_pk_fma_f32 v[96:97], v[80:81], v[80:81], v[96:97]
  v_pk_fma_f32 v[98:99], v[82:83], v[82:83], v[98:99]
  v_pk_fma_f32 v[100:101], v[84:85], v[84:85], v[100:101]
  v_pk_fma_f32 v[102:103], v[86:87], v[86:87], v[102:103]
  v_cvt_pk_bf16_f32 v232, v72, v73
  v_cvt_pk_bf16_f32 v233, v74, v75
  v_cvt_pk_bf16_f32 v234, v76, v77
  v_cvt_pk_bf16_f32 v235, v78, v79
  v_cvt_pk_bf16_f32 v236, v80, v81
  v_cvt_pk_bf16_f32 v237, v82, v83
  v_cvt_pk_bf16_f32 v238, v84, v85
  v_cvt_pk_bf16_f32 v239, v86, v87
  v_pk_fma_f32 v[72:73], v[40:41], v[40:41], s[50:51] neg_lo:[1,0,0] neg_hi:[1,0,0]
  v_pk_fma_f32 v[74:75], v[42:43], v[42:43], s[50:51] neg_lo:[1,0,0] neg_hi:[1,0,0]
  v_pk_fma_f32 v[76:77], v[44:45], v[44:45], s[50:51] neg_lo:[1,0,0] neg_hi:[1,0,0]
  v_pk_fma_f32 v[78:79], v[46:47], v[46:47], s[50:51] neg_lo:[1,0,0] neg_hi:[1,0,0]
  v_pk_fma_f32 v[80:81], v[48:49], v[48:49], s[50:51] neg_lo:[1,0,0] neg_hi:[1,0,0]
  v_pk_fma_f32 v[82:83], v[50:51], v[50:51], s[50:51] neg_lo:[1,0,0] neg_hi:[1,0,0]
  v_pk_fma_f32 v[84:85], v[52:53], v[52:53], s[50:51] neg_lo:[1,0,0] neg_hi:[1,0,0]
  v_pk_fma_f32 v[86:87], v[54:55], v[54:55], s[50:51] neg_lo:[1,0,0] neg_hi:[1,0,0]
  v_pk_mul_f32 v[72:73], v[72:73], v[40:41]
  v_pk_mul_f32 v[74:75], v[74:75], v[42:43]
  v_pk_mul_f32 v[76:77], v[76:77], v[44:45]
  v_pk_mul_f32 v[78:79], v[78:79], v[46:47]
  v_pk_mul_f32 v[80:81], v[80:81], v[48:49]
  v_pk_mul_f32 v[82:83], v[82:83], v[50:51]
  v_pk_mul_f32 v[84:85], v[84:85], v[52:53]
  v_pk_mul_f32 v[86:87], v[86:87], v[54:55]
  v_exp_f32 v72, v72
  v_rcp_f32 v56, v56
  v_exp_f32 v73, v73
  v_rcp_f32 v57, v57
  v_exp_f32 v74, v74
  v_rcp_f32 v58, v58
  v_exp_f32 v75, v75
  v_rcp_f32 v59, v59
  v_exp_f32 v76, v76
  v_rcp_f32 v60, v60
  v_exp_f32 v77, v77
  v_rcp_f32 v61, v61
  v_exp_f32 v78, v78
  v_rcp_f32 v62, v62
  v_exp_f32 v79, v79
  v_rcp_f32 v63, v63
  v_exp_f32 v80, v80
  v_rcp_f32 v64, v64
  v_exp_f32 v81, v81
  v_rcp_f32 v65, v65
  v_exp_f32 v82, v82
  v_rcp_f32 v66, v66
  v_exp_f32 v83, v83
  v_rcp_f32 v67, v67
  v_exp_f32 v84, v84
  v_rcp_f32 v68, v68
  v_exp_f32 v85, v85
  v_rcp_f32 v69, v69
  v_exp_f32 v86, v86
  v_rcp_f32 v70, v70
  v_exp_f32 v87, v87
  v_rcp_f32 v71, v71
  v_pk_mul_f32 v[56:57], v[56:57], v[24:25]
  v_pk_mul_f32 v[58:59], v[58:59], v[26:27]
  v_pk_mul_f32 v[60:61], v[60:61], v[28:29]
  v_pk_mul_f32 v[62:63], v[62:63], v[30:31]
  v_pk_mul_f32 v[64:65], v[64:65], v[32:33]
  v_pk_mul_f32 v[66:67], v[66:67], v[34:35]
  v_pk_mul_f32 v[68:69], v[68:69], v[36:37]
  v_pk_mul_f32 v[70:71], v[70:71], v[38:39]
  v_pk_add_f32 v[72:73], v[72:73], 1.0 op_sel_hi:[1,0]
  v_pk_add_f32 v[74:75], v[74:75], 1.0 op_sel_hi:[1,0]
  v_pk_add_f32 v[76:77], v[76:77], 1.0 op_sel_hi:[1,0]
  v_pk_add_f32 v[78:79], v[78:79], 1.0 op_sel_hi:[1,0]
  v_pk_add_f32 v[80:81], v[80:81], 1.0 op_sel_hi:[1,0]
  v_pk_add_f32 v[82:83], v[82:83], 1.0 op_sel_hi:[1,0]
  v_pk_add_f32 v[84:85], v[84:85], 1.0 op_sel_hi:[1,0]
  v_pk_add_f32 v[86:87], v[86:87], 1.0 op_sel_hi:[1,0]
  v_pk_fma_f32 v[88:89], v[56:57], v[56:57], v[88:89]
  v_pk_fma_f32 v[90:91], v[58:59], v[58:59], v[90:91]
  v_pk_fma_f32 v[92:93], v[60:61], v[60:61], v[92:93]
  v_pk_fma_f32 v[94:95], v[62:63], v[62:63], v[94:95]
  v_pk_fma_f32 v[96:97], v[64:65], v[64:65], v[96:97]
  v_pk_fma_f32 v[98:99], v[66:67], v[66:67], v[98:99]
  v_pk_fma_f32 v[100:101], v[68:69], v[68:69], v[100:101]
  v_pk_fma_f32 v[102:103], v[70:71], v[70:71], v[102:103]
  v_cvt_pk_bf16_f32 v240, v56, v57
  v_cvt_pk_bf16_f32 v241, v58, v59
  v_cvt_pk_bf16_f32 v242, v60, v61
  v_cvt_pk_bf16_f32 v243, v62, v63
  v_cvt_pk_bf16_f32 v244, v64, v65
  v_cvt_pk_bf16_f32 v245, v66, v67
  v_cvt_pk_bf16_f32 v246, v68, v69
  v_cvt_pk_bf16_f32 v247, v70, v71
  v_rcp_f32 v72, v72
  v_rcp_f32 v73, v73
  v_rcp_f32 v74, v74
  v_rcp_f32 v75, v75
  v_rcp_f32 v76, v76
  v_rcp_f32 v77, v77
  v_rcp_f32 v78, v78
  v_rcp_f32 v79, v79
  v_rcp_f32 v80, v80
  v_rcp_f32 v81, v81
  v_rcp_f32 v82, v82
  v_rcp_f32 v83, v83
  v_rcp_f32 v84, v84
  v_rcp_f32 v85, v85
  v_rcp_f32 v86, v86
  v_rcp_f32 v87, v87
  v_pk_mul_f32 v[72:73], v[72:73], v[40:41]
  v_pk_mul_f32 v[74:75], v[74:75], v[42:43]
  v_pk_mul_f32 v[76:77], v[76:77], v[44:45]
  v_pk_mul_f32 v[78:79], v[78:79], v[46:47]
  v_pk_mul_f32 v[80:81], v[80:81], v[48:49]
  v_pk_mul_f32 v[82:83], v[82:83], v[50:51]
  v_pk_mul_f32 v[84:85], v[84:85], v[52:53]
  v_pk_mul_f32 v[86:87], v[86:87], v[54:55]
  v_pk_fma_f32 v[88:89], v[72:73], v[72:73], v[88:89]
  v_pk_fma_f32 v[90:91], v[74:75], v[74:75], v[90:91]
  v_pk_fma_f32 v[92:93], v[76:77], v[76:77], v[92:93]
  v_pk_fma_f32 v[94:95], v[78:79], v[78:79], v[94:95]
  v_pk_fma_f32 v[96:97], v[80:81], v[80:81], v[96:97]
  v_pk_fma_f32 v[98:99], v[82:83], v[82:83], v[98:99]
  v_pk_fma_f32 v[100:101], v[84:85], v[84:85], v[100:101]
  v_pk_fma_f32 v[102:103], v[86:87], v[86:87], v[102:103]
  v_cvt_pk_bf16_f32 v248, v72, v73
  v_cvt_pk_bf16_f32 v249, v74, v75
  v_cvt_pk_bf16_f32 v250, v76, v77
  v_cvt_pk_bf16_f32 v251, v78, v79
  v_cvt_pk_bf16_f32 v252, v80, v81
  v_cvt_pk_bf16_f32 v253, v82, v83
  v_cvt_pk_bf16_f32 v254, v84, v85
  v_cvt_pk_bf16_f32 v255, v86, v87
  v_add_f32_dpp v88, v88, v88 row_ror:8 row_mask:0xf bank_mask:0x3
  v_add_f32_dpp v89, v89, v89 row_ror:8 row_mask:0xf bank_mask:0x3
  v_add_f32_dpp v90, v90, v90 row_ror:8 row_mask:0xf bank_mask:0x3
  v_add_f32_dpp v91, v91, v91 row_ror:8 row_mask:0xf bank_mask:0x3
  v_add_f32_dpp v92, v92, v92 row_ror:8 row_mask:0xf bank_mask:0x3
  v_add_f32_dpp v93, v93, v93 row_ror:8 row_mask:0xf bank_mask:0x3
  v_add_f32_dpp v94, v94, v94 row_ror:8 row_mask:0xf bank_mask:0x3
  v_add_f32_dpp v95, v95, v95 row_ror:8 row_mask:0xf bank_mask:0x3
  v_add_f32_dpp v88, v96, v96 row_ror:8 row_mask:0xf bank_mask:0xc
  v_add_f32_dpp v89, v97, v97 row_ror:8 row_mask:0xf bank_mask:0xc
  v_add_f32_dpp v90, v98, v98 row_ror:8 row_mask:0xf bank_mask:0xc
  v_add_f32_dpp v91, v99, v99 row_ror:8 row_mask:0xf bank_mask:0xc
  v_add_f32_dpp v92, v100, v100 row_ror:8 row_mask:0xf bank_mask:0xc
  v_add_f32_dpp v93, v101, v101 row_ror:8 row_mask:0xf bank_mask:0xc
  v_add_f32_dpp v94, v102, v102 row_ror:8 row_mask:0xf bank_mask:0xc
  v_add_f32_dpp v95, v103, v103 row_ror:8 row_mask:0xf bank_mask:0xc
  v_add_f32_dpp v88, v88, v88 row_shl:4 row_mask:0xf bank_mask:0x5
  v_add_f32_dpp v89, v89, v89 row_shl:4 row_mask:0xf bank_mask:0x5
  v_add_f32_dpp v90, v90, v90 row_shl:4 row_mask:0xf bank_mask:0x5
  v_add_f32_dpp v91, v91, v91 row_shl:4 row_mask:0xf bank_mask:0x5
  v_add_f32_dpp v88, v92, v92 row_shr:4 row_mask:0xf bank_mask:0xa
  v_add_f32_dpp v89, v93, v93 row_shr:4 row_mask:0xf bank_mask:0xa
  v_add_f32_dpp v90, v94, v94 row_shr:4 row_mask:0xf bank_mask:0xa
  v_add_f32_dpp v91, v95, v95 row_shr:4 row_mask:0xf bank_mask:0xa
  v_add_f32_dpp v92, v88, v88 quad_perm:[2,3,0,1] row_mask:0xf bank_mask:0xf
  v_add_f32_dpp v93, v89, v89 quad_perm:[2,3,0,1] row_mask:0xf bank_mask:0xf
  v_add_f32_dpp v94, v90, v90 quad_perm:[2,3,0,1] row_mask:0xf bank_mask:0xf
  v_add_f32_dpp v95, v91, v91 quad_perm:[2,3,0,1] row_mask:0xf bank_mask:0xf
  v_cndmask_b32 v88, v92, v94, s[64:65]
  v_cndmask_b32 v89, v93, v95, s[64:65]
  s_nop 0
  v_add_f32_dpp v90, v88, v88 quad_perm:[1,0,3,2] row_mask:0xf bank_mask:0xf
  v_add_f32_dpp v91, v89, v89 quad_perm:[1,0,3,2] row_mask:0xf bank_mask:0xf
  v_cndmask_b32 v92, v90, v91, s[58:59]
  v_mov_b32 v6, v92
  s_nop 1
  v_permlane16_swap_b32 v92, v6
  v_add_f32 v6, v6, v92
  s_mov_b32 exec_lo, 0xffff
  s_mov_b32 exec_hi, 0xffff
  buffer_atomic_add_f32 v6, v5, s[4:7], 0 offen offset:640
  s_mov_b64 exec, -1
  v_mov_b32 v47, v0
  s_mul_i32 s47, s44, 192
  v_mul_u32_u24 v35, 3, v0
  v_add_u32 v35, s47, v35
  v_lshlrev_b32 v35, 1, v35
  global_load_ushort v19, v35, s[12:13] offset:0
  global_load_ushort v23, v35, s[12:13] offset:2
  global_load_ushort v27, v35, s[12:13] offset:4
  v_lshrrev_b32 v33, 5, v47
  v_lshlrev_b32 v33, 8, v33
  v_bfe_u32 v36, v47, 2, 2
  v_lshl_add_u32 v33, v36, 6, v33
  v_bfe_u32 v36, v47, 4, 1
  v_lshl_add_u32 v33, v36, 5, v33
  v_and_b32 v36, 3, v47
  v_lshl_add_u32 v33, v36, 3, v33
  v_add_u32 v11, s56, v33
  s_waitcnt vmcnt(4)
  ds_read_b64_tr_b16 v[52:53], v11 offset:0
  ds_read_b64_tr_b16 v[54:55], v11 offset:512
  ds_read_b64_tr_b16 v[60:61], v11 offset:1024
  ds_read_b64_tr_b16 v[62:63], v11 offset:1536
  ds_read_b64_tr_b16 v[68:69], v11 offset:2048
  ds_read_b64_tr_b16 v[70:71], v11 offset:2560
  ds_read_b64_tr_b16 v[76:77], v11 offset:3072
  ds_read_b64_tr_b16 v[78:79], v11 offset:3584
  ds_read_b64_tr_b16 v[84:85], v11 offset:4096
  ds_read_b64_tr_b16 v[86:87], v11 offset:4608
  ds_read_b64_tr_b16 v[92:93], v11 offset:5120
  ds_read_b64_tr_b16 v[94:95], v11 offset:5632
  ds_read_b64_tr_b16 v[100:101], v11 offset:6144
  ds_read_b64_tr_b16 v[102:103], v11 offset:6656
  ds_read_b64_tr_b16 v[108:109], v11 offset:7168
  ds_read_b64_tr_b16 v[110:111], v11 offset:7680
  ds_read_b64_tr_b16 v[116:117], v11 offset:8192
  ds_read_b64_tr_b16 v[118:119], v11 offset:8704
  ds_read_b64_tr_b16 v[124:125], v11 offset:9216
  ds_read_b64_tr_b16 v[126:127], v11 offset:9728
  ds_read_b64_tr_b16 v[132:133], v11 offset:10240
  ds_read_b64_tr_b16 v[134:135], v11 offset:10752
  ds_read_b64_tr_b16 v[140:141], v11 offset:11264
  ds_read_b64_tr_b16 v[142:143], v11 offset:11776
  v_and_b32 v32, 31, v47
  v_and_b32 v33, 7, v32
  v_bfe_u32 v34, v32, 4, 1
  v_xor_b32 v33, v33, v34
  v_lshrrev_b32 v34, 5, v47
  s_lshr_b32 s47, s44, 1
  s_mul_i32 s47, s47, 28672
  s_and_b32 s48, s44, 1
  s_mul_i32 s49, s48, 16384
  s_add_u32 s49, s49, s47
  s_mul_i32 s57, s48, 12288
  s_sub_u32 s57, s47, s57
  v_lshlrev_b32 v32, 7, v32
  v_add_u32 v36, 0, v34
  v_xor_b32 v36, v36, v33
  v_lshl_add_u32 v36, v36, 4, v32
  v_add_u32 v1, s49, v36
  v_add_u32 v5, s57, v36
  v_add_u32 v36, 2, v34
  v_xor_b32 v36, v36, v33
  v_lshl_add_u32 v36, v36, 4, v32
  v_add_u32 v2, s49, v36
  v_add_u32 v6, s57, v36
  v_add_u32 v36, 4, v34
  v_xor_b32 v36, v36, v33
  v_lshl_add_u32 v36, v36, 4, v32
  v_add_u32 v3, s49, v36
  v_add_u32 v7, s57, v36
  v_add_u32 v36, 6, v34
  v_xor_b32 v36, v36, v33
  v_lshl_add_u32 v36, v36, 4, v32
  v_add_u32 v4, s49, v36
  v_add_u32 v8, s57, v36
  s_mul_i32 s47, s44, 1536
  s_add_u32 s47, s47, 90112
  v_lshl_add_u32 v12, v34, 4, s47
  v_lshrrev_b32 v13, 2, v47
  s_mul_i32 s47, s44, 192
  v_add_u32 v13, s47, v13
  v_mul_u32_u24 v13, 384, v13
  v_and_b32 v36, 3, v47
  v_lshl_add_u32 v13, v36, 4, v13
  s_lshl_b32 s47, s44, 3
  v_lshrrev_b32 v36, 3, v47
  v_add_u32 v32, s47, v36
  v_and_b32 v33, 7, v32
  v_bfe_u32 v34, v32, 4, 1
  v_xor_b32 v33, v33, v34
  v_and_b32 v34, 7, v47
  v_xor_b32 v33, v33, v34
  v_lshlrev_b32 v33, 4, v33
  v_lshl_add_u32 v0, v32, 7, v33
  s_lshl_b32 s62, s44, 13
  s_add_u32 s62, s62, 57344
  v_lshlrev_b32 v33, 3, v34
  v_lshl_add_u32 v33, v36, 6, v33
  v_add_u32 v14, s62, v33
  s_lshr_b32 s47, s44, 1
  s_add_u32 s47, s47, s45
  s_mul_i32 s47, s47, 224
  s_add_u32 s47, s47, s46
  s_and_b32 s48, s44, 1
  s_lshl_b32 s48, s48, 3
  s_add_u32 s47, s47, s48
  v_add_u32 v32, s47, v36
  v_mul_u32_u24 v32, 384, v32
  v_lshl_add_u32 v10, v34, 3, v32
  v_bfe_u32 v32, v47, 2, 3
  v_add_u32 v32, s47, v32
  v_mul_u32_u24 v32, 384, v32
  v_and_b32 v33, 3, v47
  v_lshl_add_u32 v32, v33, 4, v32
  v_lshrrev_b32 v33, 5, v47
  v_mul_u32_u24 v33, 172032, v33
  v_add_u32 v15, v32, v33
  s_mov_b32 s73, 172032
  s_mov_b32 s74, 344064
  s_mov_b32 s75, 516096
  s_mov_b32 s76, 688128
  s_mov_b32 s77, 860160
  s_mov_b32 s78, 1032192
  s_and_b32 s48, s44, 1
  s_sub_u32 s64, 0, s48
  s_mov_b32 s65, s64
  s_waitcnt vmcnt(3)
  s_barrier
  s_cmp_lg_u32 s44, 0
  s_cbranch_scc1 L_arrived
  s_add_u32 s47, s60, 3968
  v_mov_b32 v35, s47
  v_mov_b32 v39, 1
  s_mov_b64 exec, 1
  buffer_atomic_add v39, v35, s[4:7], 0 offen
  s_mov_b64 exec, -1
L_arrived:
  s_mul_i32 s47, s2, 1366
  s_lshr_b32 s47, s47, 16
  s_mul_i32 s48, s47, 48
  s_sub_u32 s48, s2, s48
  s_mul_i32 s49, s48, 5462
  s_lshr_b32 s49, s49, 16
  s_mul_i32 s57, s49, 12
  s_sub_u32 s57, s48, s57
  s_lshl_b32 s22, s57, 6
  s_cmp_eq_u32 s49, s44
  s_cselect_b32 s3, 1, 0
  s_cmp_lt_u32 s2, 192
  s_cselect_b32 s3, s3, 0
  s_min_u32 s47, s47, 3
  s_lshl_b32 s47, s47, 6
  s_mul_i32 s57, s57, 6144
  s_add_u32 s47, s47, s57
  s_add_u32 s47, s47, 128
  s_lshl_b32 s48, s44, 10
  s_add_u32 m0, s48, 98304
  s_nop 0
  buffer_load_dwordx4 v13, s[32:35], s47 offen lds
  s_add_u32 s40, s20, 65536
  s_addc_u32 s41, s21, 0
  s_and_b32 s41, s41, 0xffff
  s_mov_b32 s42, 196608
  s_mov_b32 s43, 0x00020000
  s_mul_i32 s23, s44, 12288
  s_waitcnt lgkmcnt(15)
  v_lshlrev_b32 v48, 16, v52
  v_and_b32 v49, s52, v52
  v_lshlrev_b32 v50, 16, v53
  v_and_b32 v51, s52, v53
  v_lshlrev_b32 v52, 16, v54
  v_and_b32 v53, s52, v54
  v_lshlrev_b32 v54, 16, v55
  v_and_b32 v55, s52, v55
  v_lshlrev_b32 v56, 16, v60
  v_and_b32 v57, s52, v60
  v_lshlrev_b32 v58, 16, v61
  v_and_b32 v59, s52, v61
  v_lshlrev_b32 v60, 16, v62
  v_and_b32 v61, s52, v62
  v_lshlrev_b32 v62, 16, v63
  v_and_b32 v63, s52, v63
  v_lshlrev_b32 v64, 16, v68
  v_and_b32 v65, s52, v68
  v_lshlrev_b32 v66, 16, v69
  v_and_b32 v67, s52, v69
  v_lshlrev_b32 v68, 16, v70
  v_and_b32 v69, s52, v70
  v_lshlrev_b32 v70, 16, v71
  v_and_b32 v71, s52, v71
  v_lshlrev_b32 v72, 16, v76
  v_and_b32 v73, s52, v76
  v_lshlrev_b32 v74, 16, v77
  v_and_b32 v75, s52, v77
  v_lshlrev_b32 v76, 16, v78
  v_and_b32 v77, s52, v78
  v_lshlrev_b32 v78, 16, v79
  v_and_b32 v79, s52, v79
  v_lshlrev_b32 v80, 16, v84
  v_and_b32 v81, s52, v84
  v_lshlrev_b32 v82, 16, v85
  v_and_b32 v83, s52, v85
  s_waitcnt lgkmcnt(14)
  v_lshlrev_b32 v84, 16, v86
  v_and_b32 v85, s52, v86
  v_lshlrev_b32 v86, 16, v87
  v_and_b32 v87, s52, v87
  s_waitcnt lgkmcnt(13)
  v_lshlrev_b32 v88, 16, v92
  v_and_b32 v89, s52, v92
  v_lshlrev_b32 v90, 16, v93
  v_and_b32 v91, s52, v93
  s_waitcnt lgkmcnt(12)
  v_lshlrev_b32 v92, 16, v94
  v_and_b32 v93, s52, v94
  v_lshlrev_b32 v94, 16, v95
  v_and_b32 v95, s52, v95
  s_waitcnt lgkmcnt(11)
  v_lshlrev_b32 v96, 16, v100
  v_and_b32 v97, s52, v100
  v_lshlrev_b32 v98, 16, v101
  v_and_b32 v99, s52, v101
  s_waitcnt lgkmcnt(10)
  v_lshlrev_b32 v100, 16, v102
  v_and_b32 v101, s52, v102
  v_lshlrev_b32 v102, 16, v103
  v_and_b32 v103, s52, v103
  s_waitcnt lgkmcnt(9)
  v_lshlrev_b32 v104, 16, v108
  v_and_b32 v105, s52, v108
  v_lshlrev_b32 v106, 16, v109
  v_and_b32 v107, s52, v109
  s_waitcnt lgkmcnt(8)
  v_lshlrev_b32 v108, 16, v110
  v_and_b32 v109, s52, v110
  v_lshlrev_b32 v110, 16, v111
  v_and_b32 v111, s52, v111
  s_waitcnt lgkmcnt(7)
  v_lshlrev_b32 v112, 16, v116
  v_and_b32 v113, s52, v116
  v_lshlrev_b32 v114, 16, v117
  v_and_b32 v115, s52, v117
  s_waitcnt lgkmcnt(6)
  v_lshlrev_b32 v116, 16, v118
  v_and_b32 v117, s52, v118
  v_lshlrev_b32 v118, 16, v119
  v_and_b32 v119, s52, v119
  s_waitcnt lgkmcnt(5)
  v_lshlrev_b32 v120, 16, v124
  v_and_b32 v121, s52, v124
  v_lshlrev_b32 v122, 16, v125
  v_and_b32 v123, s52, v125
  s_waitcnt lgkmcnt(4)
  v_lshlrev_b32 v124, 16, v126
  v_and_b32 v125, s52, v126
  v_lshlrev_b32 v126, 16, v127
  v_and_b32 v127, s52, v127
  s_waitcnt lgkmcnt(3)
  v_lshlrev_b32 v128, 16, v132
  v_and_b32 v129, s52, v132
  v_lshlrev_b32 v130, 16, v133
  v_and_b32 v131, s52, v133
  s_waitcnt lgkmcnt(2)
  v_lshlrev_b32 v132, 16, v134
  v_and_b32 v133, s52, v134
  v_lshlrev_b32 v134, 16, v135
  v_and_b32 v135, s52, v135
  s_waitcnt lgkmcnt(1)
  v_lshlrev_b32 v136, 16, v140
  v_and_b32 v137, s52, v140
  v_lshlrev_b32 v138, 16, v141
  v_and_b32 v139, s52, v141
  s_waitcnt lgkmcnt(0)
  v_lshlrev_b32 v140, 16, v142
  v_and_b32 v141, s52, v142
  v_lshlrev_b32 v142, 16, v143
  v_and_b32 v143, s52, v143
  v_add_u32 v13, 64, v13
  s_add_u32 m0, s56, 0
  s_nop 0
  buffer_load_dwordx4 v13, s[32:35], s84 offen offset:0 lds
  buffer_load_dwordx4 v13, s[32:35], s85 offen offset:1024 lds
  buffer_load_dwordx4 v13, s[32:35], s86 offen offset:2048 lds
  buffer_load_dwordx4 v13, s[32:35], s87 offen offset:3072 lds
  s_add_u32 m0, s56, 4096
  s_nop 0
  buffer_load_dwordx4 v13, s[32:35], s88 offen offset:0 lds
  buffer_load_dwordx4 v13, s[32:35], s89 offen offset:1024 lds
  buffer_load_dwordx4 v13, s[32:35], s90 offen offset:2048 lds
  buffer_load_dwordx4 v13, s[32:35], s91 offen offset:3072 lds
  s_add_u32 m0, s56, 8192
  s_nop 0
  buffer_load_dwordx4 v13, s[32:35], s92 offen offset:0 lds
  buffer_load_dwordx4 v13, s[32:35], s93 offen offset:1024 lds
  buffer_load_dwordx4 v13, s[32:35], s94 offen offset:2048 lds
  buffer_load_dwordx4 v13, s[32:35], s95 offen offset:3072 lds
  v_lshlrev_b32 v13, 4, v47
  s_mul_i32 s47, s44, 768
  v_mul_u32_u24 v39, 12, v47
  v_add_u32 v43, s47, v39
  s_cmp_lg_u32 s44, 0
  s_cbranch_scc1 L_polled
  v_lshlrev_b32 v35, 12, v47
  v_add_u32 v35, 3968, v35
  s_mov_b64 exec, 0xff
  s_mov_b32 s61, 0
L_poll:
  buffer_load_dword v16, v35, s[4:7], 0 offen sc1
  s_waitcnt vmcnt(0)
  v_cmp_gt_u32 vcc, 28, v16
  s_nop 1
  s_and_b64 vcc, vcc, exec
  s_cbranch_vccz L_pollok
  s_sleep 1
  s_add_u32 s61, s61, 1
  s_cmp_lt_u32 s61, 0x40000
  s_cbranch_scc1 L_poll
L_pollok:
  s_mov_b64 exec, -1
L_polled:
  s_barrier
  buffer_load_dwordx3 v[16:18], v43, s[4:7], 0 offen sc1
  v_add_u32 v43, 4096, v43
  buffer_load_dwordx3 v[20:22], v43, s[4:7], 0 offen sc1
  v_add_u32 v43, 4096, v43
  buffer_load_dwordx3 v[24:26], v43, s[4:7], 0 offen sc1
  v_add_u32 v43, 4096, v43
  buffer_load_dwordx3 v[28:30], v43, s[4:7], 0 offen sc1
  v_add_u32 v43, 4096, v43
  buffer_load_dwordx3 v[32:34], v43, s[4:7], 0 offen sc1
  v_add_u32 v43, 4096, v43
  buffer_load_dwordx3 v[36:38], v43, s[4:7], 0 offen sc1
  v_add_u32 v43, 4096, v43
  buffer_load_dwordx3 v[40:42], v43, s[4:7], 0 offen sc1
  v_add_u32 v43, 4096, v43
  buffer_load_dwordx3 v[44:46], v43, s[4:7], 0 offen sc1
  v_add_u32 v43, 3072, v39
  buffer_load_dword v31, v43, s[4:7], 0 offen sc1
  buffer_load_dword v9, v43, s[4:7], 0 offen offset:4 sc1
  buffer_load_dword v43, v43, s[4:7], 0 offen offset:8 sc1
  s_lshl_b32 s48, s44, 10
  s_add_u32 s48, s48, 98304
  s_sub_u32 s48, s48, s56
  v_add_u32 v35, s48, v11
  s_waitcnt vmcnt(23)
  ds_read_b64_tr_b16 a[240:241], v35
  ds_read_b64_tr_b16 a[242:243], v35 offset:512
  v_lshlrev_b32 v19, 16, v19
  v_lshlrev_b32 v23, 16, v23
  v_lshlrev_b32 v27, 16, v27
  s_mul_i32 s47, s44, 1536
  s_add_u32 s47, s47, 90112
  v_add_u32 v39, s47, v39
  v_mov_b32 v35, 0x358637bd
  s_mov_b32 s48, 0x4091afa4
  s_waitcnt vmcnt(3)
  v_add_f32 v16, v16, v20
  v_add_f32 v17, v17, v21
  v_add_f32 v18, v18, v22
  v_add_f32 v24, v24, v28
  v_add_f32 v25, v25, v29
  v_add_f32 v26, v26, v30
  v_add_f32 v32, v32, v36
  v_add_f32 v33, v33, v37
  v_add_f32 v34, v34, v38
  v_add_f32 v40, v40, v44
  v_add_f32 v41, v41, v45
  v_add_f32 v42, v42, v46
  v_add_f32 v16, v16, v24
  v_add_f32 v17, v17, v25
  v_add_f32 v18, v18, v26
  v_add_f32 v32, v32, v40
  v_add_f32 v33, v33, v41
  v_add_f32 v34, v34, v42
  v_add_f32 v16, v16, v32
  v_add_f32 v17, v17, v33
  v_add_f32 v18, v18, v34
  v_fma_f32 v16, v16, s48, v35
  v_fma_f32 v17, v17, s48, v35
  v_fma_f32 v18, v18, s48, v35
  v_sqrt_f32 v16, v16
  v_sqrt_f32 v17, v17
  v_sqrt_f32 v18, v18
  v_add_f32 v35, v16, v17
  v_add_f32 v35, v35, v18
  s_nop 1
  v_add_f32_dpp v35, v35, v35 row_ror:8 row_mask:0xf bank_mask:0xf
  s_nop 1
  v_add_f32_dpp v35, v35, v35 row_ror:4 row_mask:0xf bank_mask:0xf
  s_nop 1
  v_add_f32_dpp v35, v35, v35 row_ror:2 row_mask:0xf bank_mask:0xf
  s_nop 1
  v_add_f32_dpp v35, v35, v35 row_ror:1 row_mask:0xf bank_mask:0xf
  v_mov_b32 v32, v35
  s_nop 1
  v_permlane16_swap_b32 v35, v32
  v_add_f32 v35, v35, v32
  v_mov_b32 v32, v35
  s_nop 1
  v_permlane32_swap_b32 v35, v32
  v_add_f32 v35, v35, v32
  s_lshl_b32 s47, s44, 2
  s_add_u32 s47, s47, 163584
  v_mov_b32 v33, s47
  ds_write_b32 v33, v35
  v_mul_f32 v19, v19, v16
  v_mul_f32 v23, v23, v17
  v_mul_f32 v27, v27, v18
  v_mov_b32 v34, 163584
  v_mov_b32 v37, 0x358637bd
  v_mov_b32 v38, 0x40088e99
  s_waitcnt lgkmcnt(0)
  s_barrier
  ds_read2_b32 v[32:33], v34 offset0:0 offset1:1
  ds_read2_b32 v[40:41], v34 offset0:2 offset1:3
  s_waitcnt vmcnt(2)
  v_mul_f32 v31, 0.5, v31
  s_waitcnt vmcnt(1)
  v_mul_f32 v9, 0.5, v9
  s_waitcnt vmcnt(0)
  v_mul_f32 v43, 0.5, v43
  s_waitcnt lgkmcnt(1)
  v_add_f32 v32, v32, v33
  s_waitcnt lgkmcnt(0)
  v_add_f32 v40, v40, v41
  v_add_f32 v32, v32, v40
  v_fmac_f32 v37, 0x3aaaaaab, v32
  v_rcp_f32 v37, v37
  s_nop 0
  v_mul_f32 v37, 0x40088e99, v37
  v_fma_f32 v19, v19, v37, v38
  ds_write_b32 v39, v19 offset:0
  v_fma_f32 v23, v23, v37, v38
  ds_write_b32 v39, v23 offset:4
  v_fma_f32 v27, v27, v37, v38
  ds_write_b32 v39, v27 offset:8
  ds_write_b32 v39, v31 offset:768
  ds_write_b32 v39, v9 offset:772
  ds_write_b32 v39, v43 offset:776
  v_bfe_u32 v16, v47, 2, 2
  v_lshlrev_b32 v16, 5, v16
  v_and_b32 v17, 3, v47
  v_lshl_add_u32 v16, v17, 2, v16
  v_lshrrev_b32 v17, 5, v47
  v_lshl_add_u32 v16, v17, 4, v16
  s_mul_i32 s47, s44, 1536
  s_add_u32 s47, s47, 90112
  v_add_u32 v16, s47, v16
  ds_read_b32 v20, v16 offset:0
  ds_read_b32 v21, v16 offset:128
  ds_read_b32 v22, v16 offset:256
  ds_read_b32 v23, v16 offset:384
  ds_read_b32 v24, v16 offset:512
  ds_read_b32 v25, v16 offset:640
  ds_read_b128 a[224:227], v12 offset:768
  ds_read_b128 a[228:231], v12 offset:800
  ds_read_b128 a[232:235], v12 offset:832
  ds_read_b128 a[236:239], v12 offset:864
  v_accvgpr_read_b32 v44, a240
  v_accvgpr_read_b32 v45, a241
  v_accvgpr_read_b32 v46, a242
  v_accvgpr_read_b32 v47, a243
  s_waitcnt lgkmcnt(9)
  v_mul_f32_dpp v48, v20, v48 row_newbcast:0 row_mask:0xf bank_mask:0xf
  v_mul_f32_dpp v49, v20, v49 row_newbcast:1 row_mask:0xf bank_mask:0xf
  v_mul_f32_dpp v50, v20, v50 row_newbcast:2 row_mask:0xf bank_mask:0xf
  v_mul_f32_dpp v51, v20, v51 row_newbcast:3 row_mask:0xf bank_mask:0xf
  v_mul_f32_dpp v52, v20, v52 row_newbcast:4 row_mask:0xf bank_mask:0xf
  v_mul_f32_dpp v53, v20, v53 row_newbcast:5 row_mask:0xf bank_mask:0xf
  v_mul_f32_dpp v54, v20, v54 row_newbcast:6 row_mask:0xf bank_mask:0xf
  v_mul_f32_dpp v55, v20, v55 row_newbcast:7 row_mask:0xf bank_mask:0xf
  v_cvt_pk_bf16_f32 v48, v48, v49
  v_cvt_pk_bf16_f32 v49, v50, v51
  v_cvt_pk_bf16_f32 v50, v52, v53
  v_cvt_pk_bf16_f32 v51, v54, v55
  v_mul_f32_dpp v56, v20, v56 row_newbcast:8 row_mask:0xf bank_mask:0xf
  v_mul_f32_dpp v57, v20, v57 row_newbcast:9 row_mask:0xf bank_mask:0xf
  v_mul_f32_dpp v58, v20, v58 row_newbcast:10 row_mask:0xf bank_mask:0xf
  v_mul_f32_dpp v59, v20, v59 row_newbcast:11 row_mask:0xf bank_mask:0xf
  v_mul_f32_dpp v60, v20, v60 row_newbcast:12 row_mask:0xf bank_mask:0xf
  v_mul_f32_dpp v61, v20, v61 row_newbcast:13 row_mask:0xf bank_mask:0xf
  v_mul_f32_dpp v62, v20, v62 row_newbcast:14 row_mask:0xf bank_mask:0xf
  v_mul_f32_dpp v63, v20, v63 row_newbcast:15 row_mask:0xf bank_mask:0xf
  v_cvt_pk_bf16_f32 v52, v56, v57
  v_cvt_pk_bf16_f32 v53, v58, v59
  v_cvt_pk_bf16_f32 v54, v60, v61
  v_cvt_pk_bf16_f32 v55, v62, v63
  s_waitcnt lgkmcnt(0)
  v_mfma_f32_32x32x16_bf16 a[224:239], v[48:51], a[0:3], a[224:239]
  v_mul_f32_dpp v64, v21, v64 row_newbcast:0 row_mask:0xf bank_mask:0xf
  v_mul_f32_dpp v65, v21, v65 row_newbcast:1 row_mask:0xf bank_mask:0xf
  v_mul_f32_dpp v66, v21, v66 row_newbcast:2 row_mask:0xf bank_mask:0xf
  v_mul_f32_dpp v67, v21, v67 row_newbcast:3 row_mask:0xf bank_mask:0xf
  v_mul_f32_dpp v68, v21, v68 row_newbcast:4 row_mask:0xf bank_mask:0xf
  v_mul_f32_dpp v69, v21, v69 row_newbcast:5 row_mask:0xf bank_mask:0xf
  v_mul_f32_dpp v70, v21, v70 row_newbcast:6 row_mask:0xf bank_mask:0xf
  v_mul_f32_dpp v71, v21, v71 row_newbcast:7 row_mask:0xf bank_mask:0xf
  v_cvt_pk_bf16_f32 v56, v64, v65
  v_cvt_pk_bf16_f32 v57, v66, v67
  v_cvt_pk_bf16_f32 v58, v68, v69
  v_cvt_pk_bf16_f32 v59, v70, v71
  v_mfma_f32_32x32x16_bf16 a[224:239], v[52:55], a[4:7], a[224:239]
  v_mul_f32_dpp v72, v21, v72 row_newbcast:8 row_mask:0xf bank_mask:0xf
  v_mul_f32_dpp v73, v21, v73 row_newbcast:9 row_mask:0xf bank_mask:0xf
  v_mul_f32_dpp v74, v21, v74 row_newbcast:10 row_mask:0xf bank_mask:0xf
  v_mul_f32_dpp v75, v21, v75 row_newbcast:11 row_mask:0xf bank_mask:0xf
  v_mul_f32_dpp v76, v21, v76 row_newbcast:12 row_mask:0xf bank_mask:0xf
  v_mul_f32_dpp v77, v21, v77 row_newbcast:13 row_mask:0xf bank_mask:0xf
  v_mul_f32_dpp v78, v21, v78 row_newbcast:14 row_mask:0xf bank_mask:0xf
  v_mul_f32_dpp v79, v21, v79 row_newbcast:15 row_mask:0xf bank_mask:0xf
  v_cvt_pk_bf16_f32 v60, v72, v73
  v_cvt_pk_bf16_f32 v61, v74, v75
  v_cvt_pk_bf16_f32 v62, v76, v77
  v_cvt_pk_bf16_f32 v63, v78, v79
  s_add_u32 m0, s62, 0
  v_mfma_f32_32x32x16_bf16 a[224:239], v[56:59], a[56:59], a[224:239]
  buffer_load_dwordx4 v15, s[24:27], 0 offen offset:0 lds
  v_mul_f32_dpp v80, v22, v80 row_newbcast:0 row_mask:0xf bank_mask:0xf
  v_mul_f32_dpp v81, v22, v81 row_newbcast:1 row_mask:0xf bank_mask:0xf
  v_mul_f32_dpp v82, v22, v82 row_newbcast:2 row_mask:0xf bank_mask:0xf
  v_mul_f32_dpp v83, v22, v83 row_newbcast:3 row_mask:0xf bank_mask:0xf
  v_mul_f32_dpp v84, v22, v84 row_newbcast:4 row_mask:0xf bank_mask:0xf
  v_mul_f32_dpp v85, v22, v85 row_newbcast:5 row_mask:0xf bank_mask:0xf
  v_mul_f32_dpp v86, v22, v86 row_newbcast:6 row_mask:0xf bank_mask:0xf
  v_mul_f32_dpp v87, v22, v87 row_newbcast:7 row_mask:0xf bank_mask:0xf
  v_cvt_pk_bf16_f32 v64, v80, v81
  v_cvt_pk_bf16_f32 v65, v82, v83
  v_cvt_pk_bf16_f32 v66, v84, v85
  v_cvt_pk_bf16_f32 v67, v86, v87
  v_mfma_f32_32x32x16_bf16 a[224:239], v[60:63], a[60:63], a[224:239]
  v_mul_f32_dpp v88, v22, v88 row_newbcast:8 row_mask:0xf bank_mask:0xf
  v_mul_f32_dpp v89, v22, v89 row_newbcast:9 row_mask:0xf bank_mask:0xf
  v_mul_f32_dpp v90, v22, v90 row_newbcast:10 row_mask:0xf bank_mask:0xf
  v_mul_f32_dpp v91, v22, v91 row_newbcast:11 row_mask:0xf bank_mask:0xf
  v_mul_f32_dpp v92, v22, v92 row_newbcast:12 row_mask:0xf bank_mask:0xf
  v_mul_f32_dpp v93, v22, v93 row_newbcast:13 row_mask:0xf bank_mask:0xf
  v_mul_f32_dpp v94, v22, v94 row_newbcast:14 row_mask:0xf bank_mask:0xf
  v_mul_f32_dpp v95, v22, v95 row_newbcast:15 row_mask:0xf bank_mask:0xf
  v_cvt_pk_bf16_f32 v68, v88, v89
  v_cvt_pk_bf16_f32 v69, v90, v91
  v_cvt_pk_bf16_f32 v70, v92, v93
  v_cvt_pk_bf16_f32 v71, v94, v95
  v_mfma_f32_32x32x16_bf16 a[224:239], v[64:67], a[112:115], a[224:239]
  buffer_load_dwordx4 v15, s[24:27], s96 offen offset:1024 lds
  v_mul_f32_dpp v96, v23, v96 row_newbcast:0 row_mask:0xf bank_mask:0xf
  v_mul_f32_dpp v97, v23, v97 row_newbcast:1 row_mask:0xf bank_mask:0xf
  v_mul_f32_dpp v98, v23, v98 row_newbcast:2 row_mask:0xf bank_mask:0xf
  v_mul_f32_dpp v99, v23, v99 row_newbcast:3 row_mask:0xf bank_mask:0xf
  v_mul_f32_dpp v100, v23, v100 row_newbcast:4 row_mask:0xf bank_mask:0xf
  v_mul_f32_dpp v101, v23, v101 row_newbcast:5 row_mask:0xf bank_mask:0xf
  v_mul_f32_dpp v102, v23, v102 row_newbcast:6 row_mask:0xf bank_mask:0xf
  v_mul_f32_dpp v103, v23, v103 row_newbcast:7 row_mask:0xf bank_mask:0xf
  v_cvt_pk_bf16_f32 v72, v96, v97
  v_cvt_pk_bf16_f32 v73, v98, v99
  v_cvt_pk_bf16_f32 v74, v100, v101
  v_cvt_pk_bf16_f32 v75, v102, v103
  v_mfma_f32_32x32x16_bf16 a[224:239], v[68:71], a[116:119], a[224:239]
  ds_read_b64_tr_b16 v[96:97], v11 offset:0
  ds_read_b64_tr_b16 v[98:99], v11 offset:512
  ds_read_b64_tr_b16 v[100:101], v11 offset:1024
  ds_read_b64_tr_b16 v[102:103], v11 offset:1536
  v_mul_f32_dpp v104, v23, v104 row_newbcast:8 row_mask:0xf bank_mask:0xf
  v_mul_f32_dpp v105, v23, v105 row_newbcast:9 row_mask:0xf bank_mask:0xf
  v_mul_f32_dpp v106, v23, v106 row_newbcast:10 row_mask:0xf bank_mask:0xf
  v_mul_f32_dpp v107, v23, v107 row_newbcast:11 row_mask:0xf bank_mask:0xf
  v_mul_f32_dpp v108, v23, v108 row_newbcast:12 row_mask:0xf bank_mask:0xf
  v_mul_f32_dpp v109, v23, v109 row_newbcast:13 row_mask:0xf bank_mask:0xf
  v_mul_f32_dpp v110, v23, v110 row_newbcast:14 row_mask:0xf bank_mask:0xf
  v_mul_f32_dpp v111, v23, v111 row_newbcast:15 row_mask:0xf bank_mask:0xf
  v_cvt_pk_bf16_f32 v76, v104, v105
  v_cvt_pk_bf16_f32 v77, v106, v107
  v_cvt_pk_bf16_f32 v78, v108, v109
  v_cvt_pk_bf16_f32 v79, v110, v111
  v_mfma_f32_32x32x16_bf16 a[224:239], v[72:75], a[168:171], a[224:239]
  buffer_load_dwordx4 v15, s[24:27], s98 offen offset:3072 lds
  ds_read_b64_tr_b16 v[104:105], v11 offset:2048
  ds_read_b64_tr_b16 v[106:107], v11 offset:2560
  ds_read_b64_tr_b16 v[108:109], v11 offset:3072
  ds_read_b64_tr_b16 v[110:111], v11 offset:3584
  v_mul_f32_dpp v112, v24, v112 row_newbcast:0 row_mask:0xf bank_mask:0xf
  v_mul_f32_dpp v113, v24, v113 row_newbcast:1 row_mask:0xf bank_mask:0xf
  v_mul_f32_dpp v114, v24, v114 row_newbcast:2 row_mask:0xf bank_mask:0xf
  v_mul_f32_dpp v115, v24, v115 row_newbcast:3 row_mask:0xf bank_mask:0xf
  v_mul_f32_dpp v116, v24, v116 row_newbcast:4 row_mask:0xf bank_mask:0xf
  v_mul_f32_dpp v117, v24, v117 row_newbcast:5 row_mask:0xf bank_mask:0xf
  v_mul_f32_dpp v118, v24, v118 row_newbcast:6 row_mask:0xf bank_mask:0xf
  v_mul_f32_dpp v119, v24, v119 row_newbcast:7 row_mask:0xf bank_mask:0xf
  v_cvt_pk_bf16_f32 v80, v112, v113
  v_cvt_pk_bf16_f32 v81, v114, v115
  v_cvt_pk_bf16_f32 v82, v116, v117
  v_cvt_pk_bf16_f32 v83, v118, v119
  v_mfma_f32_32x32x16_bf16 a[224:239], v[76:79], a[172:175], a[224:239]
  ds_read_b64_tr_b16 v[112:113], v11 offset:4096
  ds_read_b64_tr_b16 v[114:115], v11 offset:4608
  ds_read_b64_tr_b16 v[116:117], v11 offset:5120
  ds_read_b64_tr_b16 v[118:119], v11 offset:5632
  v_mul_f32_dpp v120, v24, v120 row_newbcast:8 row_mask:0xf bank_mask:0xf
  v_mul_f32_dpp v121, v24, v121 row_newbcast:9 row_mask:0xf bank_mask:0xf
  v_mul_f32_dpp v122, v24, v122 row_newbcast:10 row_mask:0xf bank_mask:0xf
  v_mul_f32_dpp v123, v24, v123 row_newbcast:11 row_mask:0xf bank_mask:0xf
  v_mul_f32_dpp v124, v24, v124 row_newbcast:12 row_mask:0xf bank_mask:0xf
  v_mul_f32_dpp v125, v24, v125 row_newbcast:13 row_mask:0xf bank_mask:0xf
  v_mul_f32_dpp v126, v24, v126 row_newbcast:14 row_mask:0xf bank_mask:0xf
  v_mul_f32_dpp v127, v24, v127 row_newbcast:15 row_mask:0xf bank_mask:0xf
  v_cvt_pk_bf16_f32 v84, v120, v121
  v_cvt_pk_bf16_f32 v85, v122, v123
  v_cvt_pk_bf16_f32 v86, v124, v125
  v_cvt_pk_bf16_f32 v87, v126, v127
  v_mfma_f32_32x32x16_bf16 a[224:239], v[80:83], v[144:147], a[224:239]
  ds_read_b64_tr_b16 v[120:121], v11 offset:6144
  ds_read_b64_tr_b16 v[122:123], v11 offset:6656
  ds_read_b64_tr_b16 v[124:125], v11 offset:7168
  ds_read_b64_tr_b16 v[126:127], v11 offset:7680
  v_mul_f32_dpp v128, v25, v128 row_newbcast:0 row_mask:0xf bank_mask:0xf
  v_mul_f32_dpp v129, v25, v129 row_newbcast:1 row_mask:0xf bank_mask:0xf
  v_mul_f32_dpp v130, v25, v130 row_newbcast:2 row_mask:0xf bank_mask:0xf
  v_mul_f32_dpp v131, v25, v131 row_newbcast:3 row_mask:0xf bank_mask:0xf
  v_mul_f32_dpp v132, v25, v132 row_newbcast:4 row_mask:0xf bank_mask:0xf
  v_mul_f32_dpp v133, v25, v133 row_newbcast:5 row_mask:0xf bank_mask:0xf
  v_mul_f32_dpp v134, v25, v134 row_newbcast:6 row_mask:0xf bank_mask:0xf
  v_mul_f32_dpp v135, v25, v135 row_newbcast:7 row_mask:0xf bank_mask:0xf
  v_cvt_pk_bf16_f32 v88, v128, v129
  v_cvt_pk_bf16_f32 v89, v130, v131
  v_cvt_pk_bf16_f32 v90, v132, v133
  v_cvt_pk_bf16_f32 v91, v134, v135
  v_mfma_f32_32x32x16_bf16 a[224:239], v[84:87], v[148:151], a[224:239]
  ds_read_b128 a[240:243], v12 offset:768
  ds_read_b64_tr_b16 v[128:129], v11 offset:8192
  ds_read_b64_tr_b16 v[130:131], v11 offset:8704
  ds_read_b64_tr_b16 v[132:133], v11 offset:9216
  ds_read_b64_tr_b16 v[134:135], v11 offset:9728
  ds_read_b128 a[244:247], v12 offset:800
  v_mul_f32_dpp v136, v25, v136 row_newbcast:8 row_mask:0xf bank_mask:0xf
  v_mul_f32_dpp v137, v25, v137 row_newbcast:9 row_mask:0xf bank_mask:0xf
  v_mul_f32_dpp v138, v25, v138 row_newbcast:10 row_mask:0xf bank_mask:0xf
  v_mul_f32_dpp v139, v25, v139 row_newbcast:11 row_mask:0xf bank_mask:0xf
  v_mul_f32_dpp v140, v25, v140 row_newbcast:12 row_mask:0xf bank_mask:0xf
  v_mul_f32_dpp v141, v25, v141 row_newbcast:13 row_mask:0xf bank_mask:0xf
  v_mul_f32_dpp v142, v25, v142 row_newbcast:14 row_mask:0xf bank_mask:0xf
  v_mul_f32_dpp v143, v25, v143 row_newbcast:15 row_mask:0xf bank_mask:0xf
  v_cvt_pk_bf16_f32 v92, v136, v137
  v_cvt_pk_bf16_f32 v93, v138, v139
  v_cvt_pk_bf16_f32 v94, v140, v141
  v_cvt_pk_bf16_f32 v95, v142, v143
  v_mfma_f32_32x32x16_bf16 a[224:239], v[88:91], v[200:203], a[224:239]
  ds_read_b128 a[248:251], v12 offset:832
  ds_read_b64_tr_b16 v[136:137], v11 offset:10240
  ds_read_b64_tr_b16 v[138:139], v11 offset:10752
  ds_read_b64_tr_b16 v[140:141], v11 offset:11264
  ds_read_b64_tr_b16 v[142:143], v11 offset:11776
  ds_read_b128 a[252:255], v12 offset:864
  v_mfma_f32_32x32x16_bf16 a[224:239], v[92:95], v[204:207], a[224:239]
  buffer_load_dwordx4 v15, s[24:27], s97 offen offset:2048 lds
  s_barrier
  s_waitcnt lgkmcnt(0)
  v_mfma_f32_32x32x16_bf16 a[240:255], v[48:51], a[8:11], a[240:255]
  v_lshlrev_b32 v16, 16, v96
  v_and_b32 v17, s52, v96
  v_lshlrev_b32 v18, 16, v97
  v_and_b32 v19, s52, v97
  v_mul_f32_dpp v16, v20, v16 row_newbcast:0 row_mask:0xf bank_mask:0xf
  v_mul_f32_dpp v17, v20, v17 row_newbcast:1 row_mask:0xf bank_mask:0xf
  v_mfma_f32_32x32x16_bf16 a[240:255], v[52:55], a[12:15], a[240:255]
  s_nop 0
  ds_write_b128 v1, a[224:227] offset:0
  v_mul_f32_dpp v18, v20, v18 row_newbcast:2 row_mask:0xf bank_mask:0xf
  v_mfma_f32_32x32x16_bf16 a[240:255], v[56:59], a[64:67], a[240:255]
  v_mul_f32_dpp v19, v20, v19 row_newbcast:3 row_mask:0xf bank_mask:0xf
  v_cvt_pk_bf16_f32 v96, v16, v17
  v_cvt_pk_bf16_f32 v97, v18, v19
  v_lshlrev_b32 v16, 16, v98
  v_and_b32 v17, s52, v98
  v_lshlrev_b32 v18, 16, v99
  v_mfma_f32_32x32x16_bf16 a[240:255], v[60:63], a[68:71], a[240:255]
  ds_write_b128 v2, a[228:231] offset:0
  v_and_b32 v19, s52, v99
  v_mfma_f32_32x32x16_bf16 a[240:255], v[64:67], a[120:123], a[240:255]
  v_mul_f32_dpp v16, v20, v16 row_newbcast:4 row_mask:0xf bank_mask:0xf
  v_mul_f32_dpp v17, v20, v17 row_newbcast:5 row_mask:0xf bank_mask:0xf
  v_mul_f32_dpp v18, v20, v18 row_newbcast:6 row_mask:0xf bank_mask:0xf
  v_mul_f32_dpp v19, v20, v19 row_newbcast:7 row_mask:0xf bank_mask:0xf
  v_cvt_pk_bf16_f32 v98, v16, v17
  v_cvt_pk_bf16_f32 v99, v18, v19
  v_mfma_f32_32x32x16_bf16 a[240:255], v[68:71], a[124:127], a[240:255]
  ds_write_b128 v3, a[232:235] offset:0
  v_lshlrev_b32 v16, 16, v100
  v_mfma_f32_32x32x16_bf16 a[240:255], v[72:75], a[176:179], a[240:255]
  v_and_b32 v17, s52, v100
  v_lshlrev_b32 v18, 16, v101
  v_and_b32 v19, s52, v101
  v_mul_f32_dpp v16, v20, v16 row_newbcast:8 row_mask:0xf bank_mask:0xf
  v_mul_f32_dpp v17, v20, v17 row_newbcast:9 row_mask:0xf bank_mask:0xf
  v_mul_f32_dpp v18, v20, v18 row_newbcast:10 row_mask:0xf bank_mask:0xf
  v_mfma_f32_32x32x16_bf16 a[240:255], v[76:79], a[180:183], a[240:255]
  ds_write_b128 v4, a[236:239] offset:0
  v_mul_f32_dpp v19, v20, v19 row_newbcast:11 row_mask:0xf bank_mask:0xf
  v_mfma_f32_32x32x16_bf16 a[240:255], v[80:83], v[152:155], a[240:255]
  s_cmp_eq_u32 s3, 0
  s_cbranch_scc1 L_nocoop
  v_add_u32 v9, s22, v12
  ds_read_b128 v[28:31], v9
  ds_read_b128 v[32:35], v9 offset:32
  v_lshlrev_b32 v36, 16, v44
  v_and_b32 v37, s52, v44
  v_lshlrev_b32 v38, 16, v45
  v_and_b32 v39, s52, v45
  v_lshlrev_b32 v40, 16, v46
  v_and_b32 v41, s52, v46
  v_lshlrev_b32 v42, 16, v47
  v_and_b32 v43, s52, v47
  s_waitcnt lgkmcnt(1)
  v_mul_f32 v36, v36, v28
  v_mul_f32 v37, v37, v29
  v_mul_f32 v38, v38, v30
  v_mul_f32 v39, v39, v31
  s_waitcnt lgkmcnt(0)
  v_mul_f32 v40, v40, v32
  v_mul_f32 v41, v41, v33
  v_mul_f32 v42, v42, v34
  v_mul_f32 v43, v43, v35
  v_cvt_pk_bf16_f32 v44, v36, v37
  v_cvt_pk_bf16_f32 v45, v38, v39
  v_cvt_pk_bf16_f32 v46, v40, v41
  v_cvt_pk_bf16_f32 v47, v42, v43
  s_lshl_b32 s47, s2, 10
  buffer_store_dwordx4 v[44:47], v13, s[40:43], s47 offen sc0 sc1
L_nocoop:
  v_cvt_pk_bf16_f32 v100, v16, v17
  v_cvt_pk_bf16_f32 v101, v18, v19
  v_lshlrev_b32 v16, 16, v102
  v_and_b32 v17, s52, v102
  v_lshlrev_b32 v18, 16, v103
  v_and_b32 v19, s52, v103
  v_mfma_f32_32x32x16_bf16 a[240:255], v[84:87], v[156:159], a[240:255]
  ds_read_b128 a[224:227], v12 offset:768
  ds_read_b128 a[228:231], v12 offset:800
  v_mul_f32_dpp v16, v20, v16 row_newbcast:12 row_mask:0xf bank_mask:0xf
  v_mul_f32_dpp v17, v20, v17 row_newbcast:13 row_mask:0xf bank_mask:0xf
  v_mul_f32_dpp v18, v20, v18 row_newbcast:14 row_mask:0xf bank_mask:0xf
  v_mul_f32_dpp v19, v20, v19 row_newbcast:15 row_mask:0xf bank_mask:0xf
  v_mfma_f32_32x32x16_bf16 a[240:255], v[88:91], v[208:211], a[240:255]
  ds_read_b128 a[232:235], v12 offset:832
  ds_read_b128 a[236:239], v12 offset:864
  v_cvt_pk_bf16_f32 v102, v16, v17
  v_cvt_pk_bf16_f32 v103, v18, v19
  v_mfma_f32_32x32x16_bf16 a[240:255], v[92:95], v[212:215], a[240:255]
  s_waitcnt lgkmcnt(4)
  s_barrier
  s_waitcnt lgkmcnt(0)
  v_mfma_f32_32x32x16_bf16 a[224:239], v[48:51], a[16:19], a[224:239]
  v_lshlrev_b32 v16, 16, v104
  v_and_b32 v17, s52, v104
  v_lshlrev_b32 v18, 16, v105
  v_and_b32 v19, s52, v105
  v_mul_f32_dpp v16, v21, v16 row_newbcast:0 row_mask:0xf bank_mask:0xf
  v_mul_f32_dpp v17, v21, v17 row_newbcast:1 row_mask:0xf bank_mask:0xf
  v_mfma_f32_32x32x16_bf16 a[224:239], v[52:55], a[20:23], a[224:239]
  s_nop 0
  ds_write_b128 v1, a[240:243] offset:4096
  v_mul_f32_dpp v18, v21, v18 row_newbcast:2 row_mask:0xf bank_mask:0xf
  v_mfma_f32_32x32x16_bf16 a[224:239], v[56:59], a[72:75], a[224:239]
  v_mul_f32_dpp v19, v21, v19 row_newbcast:3 row_mask:0xf bank_mask:0xf
  v_cvt_pk_bf16_f32 v104, v16, v17
  v_cvt_pk_bf16_f32 v105, v18, v19
  v_lshlrev_b32 v16, 16, v106
  v_and_b32 v17, s52, v106
  v_lshlrev_b32 v18, 16, v107
  v_mfma_f32_32x32x16_bf16 a[224:239], v[60:63], a[76:79], a[224:239]
  ds_write_b128 v2, a[244:247] offset:4096
  v_and_b32 v19, s52, v107
  v_mfma_f32_32x32x16_bf16 a[224:239], v[64:67], a[128:131], a[224:239]
  v_mul_f32_dpp v16, v21, v16 row_newbcast:4 row_mask:0xf bank_mask:0xf
  v_mul_f32_dpp v17, v21, v17 row_newbcast:5 row_mask:0xf bank_mask:0xf
  v_mul_f32_dpp v18, v21, v18 row_newbcast:6 row_mask:0xf bank_mask:0xf
  v_mul_f32_dpp v19, v21, v19 row_newbcast:7 row_mask:0xf bank_mask:0xf
  v_cvt_pk_bf16_f32 v106, v16, v17
  v_cvt_pk_bf16_f32 v107, v18, v19
  v_mfma_f32_32x32x16_bf16 a[224:239], v[68:71], a[132:135], a[224:239]
  ds_write_b128 v3, a[248:251] offset:4096
  v_lshlrev_b32 v16, 16, v108
  v_mfma_f32_32x32x16_bf16 a[224:239], v[72:75], a[184:187], a[224:239]
  v_and_b32 v17, s52, v108
  v_lshlrev_b32 v18, 16, v109
  v_and_b32 v19, s52, v109
  v_mul_f32_dpp v16, v21, v16 row_newbcast:8 row_mask:0xf bank_mask:0xf
  v_mul_f32_dpp v17, v21, v17 row_newbcast:9 row_mask:0xf bank_mask:0xf
  v_mul_f32_dpp v18, v21, v18 row_newbcast:10 row_mask:0xf bank_mask:0xf
  v_mfma_f32_32x32x16_bf16 a[224:239], v[76:79], a[188:191], a[224:239]
  ds_write_b128 v4, a[252:255] offset:4096
  v_mul_f32_dpp v19, v21, v19 row_newbcast:11 row_mask:0xf bank_mask:0xf
  v_mfma_f32_32x32x16_bf16 a[224:239], v[80:83], v[160:163], a[224:239]
  v_cvt_pk_bf16_f32 v108, v16, v17
  v_cvt_pk_bf16_f32 v109, v18, v19
  v_lshlrev_b32 v16, 16, v110
  v_and_b32 v17, s52, v110
  v_lshlrev_b32 v18, 16, v111
  v_and_b32 v19, s52, v111
  v_add_u32 v9, 0xffffd300, v12
  v_cndmask_b32 v9, v9, v5, s[64:65]
  v_mfma_f32_32x32x16_bf16 a[224:239], v[84:87], v[164:167], a[224:239]
  ds_read_b128 a[240:243], v9 offset:12288
  v_add_u32 v9, 0xffffd320, v12
  v_cndmask_b32 v9, v9, v6, s[64:65]
  ds_read_b128 a[244:247], v9 offset:12288
  v_mul_f32_dpp v16, v21, v16 row_newbcast:12 row_mask:0xf bank_mask:0xf
  v_mul_f32_dpp v17, v21, v17 row_newbcast:13 row_mask:0xf bank_mask:0xf
  v_mul_f32_dpp v18, v21, v18 row_newbcast:14 row_mask:0xf bank_mask:0xf
  v_mul_f32_dpp v19, v21, v19 row_newbcast:15 row_mask:0xf bank_mask:0xf
  v_add_u32 v9, 0xffffd340, v12
  v_cndmask_b32 v9, v9, v7, s[64:65]
  v_mfma_f32_32x32x16_bf16 a[224:239], v[88:91], v[216:219], a[224:239]
  ds_read_b128 a[248:251], v9 offset:12288
  v_add_u32 v9, 0xffffd360, v12
  v_cndmask_b32 v9, v9, v8, s[64:65]
  ds_read_b128 a[252:255], v9 offset:12288
  v_cvt_pk_bf16_f32 v110, v16, v17
  v_cvt_pk_bf16_f32 v111, v18, v19
  v_mfma_f32_32x32x16_bf16 a[224:239], v[92:95], v[220:223], a[224:239]
  s_waitcnt lgkmcnt(4)
  s_barrier
  s_waitcnt lgkmcnt(0)
  v_mfma_f32_32x32x16_bf16 a[240:255], v[48:51], a[24:27], a[240:255]
  v_lshlrev_b32 v16, 16, v112
  v_and_b32 v17, s52, v112
  v_lshlrev_b32 v18, 16, v113
  v_and_b32 v19, s52, v113
  v_mul_f32_dpp v16, v22, v16 row_newbcast:0 row_mask:0xf bank_mask:0xf
  v_mul_f32_dpp v17, v22, v17 row_newbcast:1 row_mask:0xf bank_mask:0xf
  v_mfma_f32_32x32x16_bf16 a[240:255], v[52:55], a[28:31], a[240:255]
  s_nop 0
  ds_write_b128 v1, a[224:227] offset:8192
  v_mul_f32_dpp v18, v22, v18 row_newbcast:2 row_mask:0xf bank_mask:0xf
  v_mfma_f32_32x32x16_bf16 a[240:255], v[56:59], a[80:83], a[240:255]
  v_mul_f32_dpp v19, v22, v19 row_newbcast:3 row_mask:0xf bank_mask:0xf
  v_cvt_pk_bf16_f32 v112, v16, v17
  v_cvt_pk_bf16_f32 v113, v18, v19
  v_lshlrev_b32 v16, 16, v114
  v_and_b32 v17, s52, v114
  v_lshlrev_b32 v18, 16, v115
  v_mfma_f32_32x32x16_bf16 a[240:255], v[60:63], a[84:87], a[240:255]
  ds_write_b128 v2, a[228:231] offset:8192
  v_and_b32 v19, s52, v115
  v_mfma_f32_32x32x16_bf16 a[240:255], v[64:67], a[136:139], a[240:255]
  v_mul_f32_dpp v16, v22, v16 row_newbcast:4 row_mask:0xf bank_mask:0xf
  v_mul_f32_dpp v17, v22, v17 row_newbcast:5 row_mask:0xf bank_mask:0xf
  v_mul_f32_dpp v18, v22, v18 row_newbcast:6 row_mask:0xf bank_mask:0xf
  v_mul_f32_dpp v19, v22, v19 row_newbcast:7 row_mask:0xf bank_mask:0xf
  v_cvt_pk_bf16_f32 v114, v16, v17
  v_cvt_pk_bf16_f32 v115, v18, v19
  v_mfma_f32_32x32x16_bf16 a[240:255], v[68:71], a[140:143], a[240:255]
  ds_write_b128 v3, a[232:235] offset:8192
  v_lshlrev_b32 v16, 16, v116
  v_mfma_f32_32x32x16_bf16 a[240:255], v[72:75], a[192:195], a[240:255]
  v_and_b32 v17, s52, v116
  v_lshlrev_b32 v18, 16, v117
  v_and_b32 v19, s52, v117
  v_mul_f32_dpp v16, v22, v16 row_newbcast:8 row_mask:0xf bank_mask:0xf
  v_mul_f32_dpp v17, v22, v17 row_newbcast:9 row_mask:0xf bank_mask:0xf
  v_mul_f32_dpp v18, v22, v18 row_newbcast:10 row_mask:0xf bank_mask:0xf
  v_mfma_f32_32x32x16_bf16 a[240:255], v[76:79], a[196:199], a[240:255]
  ds_write_b128 v4, a[236:239] offset:8192
  v_mul_f32_dpp v19, v22, v19 row_newbcast:11 row_mask:0xf bank_mask:0xf
  v_mfma_f32_32x32x16_bf16 a[240:255], v[80:83], v[168:171], a[240:255]
  v_cvt_pk_bf16_f32 v116, v16, v17
  v_cvt_pk_bf16_f32 v117, v18, v19
  v_lshlrev_b32 v16, 16, v118
  v_and_b32 v17, s52, v118
  v_lshlrev_b32 v18, 16, v119
  v_and_b32 v19, s52, v119
  v_mfma_f32_32x32x16_bf16 a[240:255], v[84:87], v[172:175], a[240:255]
  ds_read_b128 a[224:227], v5 offset:16384
  ds_read_b128 a[228:231], v6 offset:16384
  v_mul_f32_dpp v16, v22, v16 row_newbcast:12 row_mask:0xf bank_mask:0xf
  v_mul_f32_dpp v17, v22, v17 row_newbcast:13 row_mask:0xf bank_mask:0xf
  v_mul_f32_dpp v18, v22, v18 row_newbcast:14 row_mask:0xf bank_mask:0xf
  v_mul_f32_dpp v19, v22, v19 row_newbcast:15 row_mask:0xf bank_mask:0xf
  v_mfma_f32_32x32x16_bf16 a[240:255], v[88:91], v[224:227], a[240:255]
  ds_read_b128 a[232:235], v7 offset:16384
  ds_read_b128 a[236:239], v8 offset:16384
  v_cvt_pk_bf16_f32 v118, v16, v17
  v_cvt_pk_bf16_f32 v119, v18, v19
  v_mfma_f32_32x32x16_bf16 a[240:255], v[92:95], v[228:231], a[240:255]
  s_waitcnt lgkmcnt(4)
  s_barrier
  s_waitcnt lgkmcnt(0)
  v_mfma_f32_32x32x16_bf16 a[224:239], v[48:51], a[32:35], a[224:239]
  v_lshlrev_b32 v16, 16, v120
  v_and_b32 v17, s52, v120
  v_lshlrev_b32 v18, 16, v121
  v_and_b32 v19, s52, v121
  v_mul_f32_dpp v16, v23, v16 row_newbcast:0 row_mask:0xf bank_mask:0xf
  v_mul_f32_dpp v17, v23, v17 row_newbcast:1 row_mask:0xf bank_mask:0xf
  v_mfma_f32_32x32x16_bf16 a[224:239], v[52:55], a[36:39], a[224:239]
  s_nop 0
  ds_write_b128 v5, a[240:243] offset:12288
  v_mul_f32_dpp v18, v23, v18 row_newbcast:2 row_mask:0xf bank_mask:0xf
  v_mfma_f32_32x32x16_bf16 a[224:239], v[56:59], a[88:91], a[224:239]
  s_waitcnt vmcnt(0)
  s_cmp_eq_u32 s3, 0
  s_cbranch_scc1 L_nosig
  s_add_u32 s47, s60, 3840
  v_mov_b32 v28, s47
  v_mov_b32 v29, 1
  s_mov_b64 exec, 1
  buffer_atomic_add v29, v28, s[4:7], 0 offen
  s_mov_b64 exec, -1
L_nosig:
  s_nop 1
  v_mul_f32_dpp v19, v23, v19 row_newbcast:3 row_mask:0xf bank_mask:0xf
  v_cvt_pk_bf16_f32 v120, v16, v17
  v_cvt_pk_bf16_f32 v121, v18, v19
  v_lshlrev_b32 v16, 16, v122
  v_and_b32 v17, s52, v122
  v_lshlrev_b32 v18, 16, v123
  v_mfma_f32_32x32x16_bf16 a[224:239], v[60:63], a[92:95], a[224:239]
  ds_write_b128 v6, a[244:247] offset:12288
  v_and_b32 v19, s52, v123
  v_mfma_f32_32x32x16_bf16 a[224:239], v[64:67], a[144:147], a[224:239]
  v_mul_f32_dpp v16, v23, v16 row_newbcast:4 row_mask:0xf bank_mask:0xf
  v_mul_f32_dpp v17, v23, v17 row_newbcast:5 row_mask:0xf bank_mask:0xf
  v_mul_f32_dpp v18, v23, v18 row_newbcast:6 row_mask:0xf bank_mask:0xf
  v_mul_f32_dpp v19, v23, v19 row_newbcast:7 row_mask:0xf bank_mask:0xf
  v_cvt_pk_bf16_f32 v122, v16, v17
  v_cvt_pk_bf16_f32 v123, v18, v19
  v_mfma_f32_32x32x16_bf16 a[224:239], v[68:71], a[148:151], a[224:239]
  ds_write_b128 v7, a[248:251] offset:12288
  v_lshlrev_b32 v16, 16, v124
  v_mfma_f32_32x32x16_bf16 a[224:239], v[72:75], a[200:203], a[224:239]
  v_and_b32 v17, s52, v124
  v_lshlrev_b32 v18, 16, v125
  v_and_b32 v19, s52, v125
  v_mul_f32_dpp v16, v23, v16 row_newbcast:8 row_mask:0xf bank_mask:0xf
  v_mul_f32_dpp v17, v23, v17 row_newbcast:9 row_mask:0xf bank_mask:0xf
  v_mul_f32_dpp v18, v23, v18 row_newbcast:10 row_mask:0xf bank_mask:0xf
  v_mfma_f32_32x32x16_bf16 a[224:239], v[76:79], a[204:207], a[224:239]
  ds_write_b128 v8, a[252:255] offset:12288
  v_mul_f32_dpp v19, v23, v19 row_newbcast:11 row_mask:0xf bank_mask:0xf
  v_mfma_f32_32x32x16_bf16 a[224:239], v[80:83], v[176:179], a[224:239]
  v_cvt_pk_bf16_f32 v124, v16, v17
  v_cvt_pk_bf16_f32 v125, v18, v19
  v_lshlrev_b32 v16, 16, v126
  v_and_b32 v17, s52, v126
  v_lshlrev_b32 v18, 16, v127
  v_and_b32 v19, s52, v127
  v_mfma_f32_32x32x16_bf16 a[224:239], v[84:87], v[180:183], a[224:239]
  ds_read_b128 a[240:243], v5 offset:20480
  ds_read_b128 a[244:247], v6 offset:20480
  v_mul_f32_dpp v16, v23, v16 row_newbcast:12 row_mask:0xf bank_mask:0xf
  v_mul_f32_dpp v17, v23, v17 row_newbcast:13 row_mask:0xf bank_mask:0xf
  v_mul_f32_dpp v18, v23, v18 row_newbcast:14 row_mask:0xf bank_mask:0xf
  v_mul_f32_dpp v19, v23, v19 row_newbcast:15 row_mask:0xf bank_mask:0xf
  v_mfma_f32_32x32x16_bf16 a[224:239], v[88:91], v[232:235], a[224:239]
  ds_read_b128 a[248:251], v7 offset:20480
  ds_read_b128 a[252:255], v8 offset:20480
  v_cvt_pk_bf16_f32 v126, v16, v17
  v_cvt_pk_bf16_f32 v127, v18, v19
  v_mfma_f32_32x32x16_bf16 a[224:239], v[92:95], v[236:239], a[224:239]
  s_waitcnt lgkmcnt(4)
  s_barrier
  s_waitcnt lgkmcnt(0)
  v_mfma_f32_32x32x16_bf16 a[240:255], v[48:51], a[40:43], a[240:255]
  ds_read_b128 v[28:31], v0 offset:0
  ds_read_b128 v[32:35], v0 offset:28672
  ds_read_b64 v[44:45], v14 offset:0
  v_lshlrev_b32 v16, 16, v128
  v_and_b32 v17, s52, v128
  v_lshlrev_b32 v18, 16, v129
  v_and_b32 v19, s52, v129
  v_mul_f32_dpp v16, v24, v16 row_newbcast:0 row_mask:0xf bank_mask:0xf
  v_mul_f32_dpp v17, v24, v17 row_newbcast:1 row_mask:0xf bank_mask:0xf
  v_mfma_f32_32x32x16_bf16 a[240:255], v[52:55], a[44:47], a[240:255]
  ds_write_b128 v5, a[224:227] offset:16384
  v_add_u32 v15, 64, v15
  s_add_u32 m0, s62, 4096
  v_mfma_f32_32x32x16_bf16 a[240:255], v[56:59], a[96:99], a[240:255]
  buffer_load_dwordx4 v15, s[24:27], 0 offen offset:0 lds
  v_mul_f32_dpp v18, v24, v18 row_newbcast:2 row_mask:0xf bank_mask:0xf
  v_mul_f32_dpp v19, v24, v19 row_newbcast:3 row_mask:0xf bank_mask:0xf
  v_cvt_pk_bf16_f32 v128, v16, v17
  v_cvt_pk_bf16_f32 v129, v18, v19
  s_waitcnt lgkmcnt(2)
  v_add_f32 v28, v28, v32
  v_add_f32 v29, v29, v33
  v_add_f32 v30, v30, v34
  v_mfma_f32_32x32x16_bf16 a[240:255], v[60:63], a[100:103], a[240:255]
  ds_write_b128 v6, a[228:231] offset:16384
  v_add_f32 v31, v31, v35
  v_mfma_f32_32x32x16_bf16 a[240:255], v[64:67], a[152:155], a[240:255]
  buffer_load_dwordx4 v15, s[24:27], s96 offen offset:1024 lds
  s_waitcnt lgkmcnt(2)
  v_lshlrev_b32 v32, 16, v44
  v_and_b32 v33, s52, v44
  v_lshlrev_b32 v34, 16, v45
  v_and_b32 v35, s52, v45
  v_add_f32 v28, v28, v32
  v_add_f32 v29, v29, v33
  v_add_f32 v30, v30, v34
  v_mfma_f32_32x32x16_bf16 a[240:255], v[68:71], a[156:159], a[240:255]
  ds_write_b128 v7, a[232:235] offset:16384
  v_add_f32 v31, v31, v35
  v_mfma_f32_32x32x16_bf16 a[240:255], v[72:75], a[208:211], a[240:255]
  buffer_load_dwordx4 v15, s[24:27], s98 offen offset:3072 lds
  v_cvt_pk_bf16_f32 v32, v28, v29
  v_cvt_pk_bf16_f32 v33, v30, v31
  v_lshlrev_b32 v16, 16, v130
  v_and_b32 v17, s52, v130
  v_lshlrev_b32 v18, 16, v131
  v_and_b32 v19, s52, v131
  v_mul_f32_dpp v16, v24, v16 row_newbcast:4 row_mask:0xf bank_mask:0xf
  v_mfma_f32_32x32x16_bf16 a[240:255], v[76:79], a[212:215], a[240:255]
  ds_write_b128 v8, a[236:239] offset:16384
  v_mul_f32_dpp v17, v24, v17 row_newbcast:5 row_mask:0xf bank_mask:0xf
  v_mfma_f32_32x32x16_bf16 a[240:255], v[80:83], v[184:187], a[240:255]
  buffer_store_dwordx2 v[32:33], v10, s[36:39], 0 offen nt
  v_mul_f32_dpp v18, v24, v18 row_newbcast:6 row_mask:0xf bank_mask:0xf
  v_mul_f32_dpp v19, v24, v19 row_newbcast:7 row_mask:0xf bank_mask:0xf
  v_cvt_pk_bf16_f32 v130, v16, v17
  v_cvt_pk_bf16_f32 v131, v18, v19
  v_lshlrev_b32 v16, 16, v132
  v_and_b32 v17, s52, v132
  v_lshlrev_b32 v18, 16, v133
  v_mfma_f32_32x32x16_bf16 a[240:255], v[84:87], v[188:191], a[240:255]
  ds_read_b128 a[224:227], v5 offset:24576
  ds_read_b128 a[228:231], v6 offset:24576
  v_and_b32 v19, s52, v133
  v_mul_f32_dpp v16, v24, v16 row_newbcast:8 row_mask:0xf bank_mask:0xf
  v_mul_f32_dpp v17, v24, v17 row_newbcast:9 row_mask:0xf bank_mask:0xf
  v_mul_f32_dpp v18, v24, v18 row_newbcast:10 row_mask:0xf bank_mask:0xf
  v_mul_f32_dpp v19, v24, v19 row_newbcast:11 row_mask:0xf bank_mask:0xf
  v_mfma_f32_32x32x16_bf16 a[240:255], v[88:91], v[240:243], a[240:255]
  ds_read_b128 a[232:235], v7 offset:24576
  ds_read_b128 a[236:239], v8 offset:24576
  v_cvt_pk_bf16_f32 v132, v16, v17
  v_cvt_pk_bf16_f32 v133, v18, v19
  v_lshlrev_b32 v16, 16, v134
  v_and_b32 v17, s52, v134
  v_lshlrev_b32 v18, 16, v135
  v_mfma_f32_32x32x16_bf16 a[240:255], v[92:95], v[244:247], a[240:255]
  buffer_load_dwordx4 v15, s[24:27], s97 offen offset:2048 lds
  v_and_b32 v19, s52, v135
  v_mul_f32_dpp v16, v24, v16 row_newbcast:12 row_mask:0xf bank_mask:0xf
  v_mul_f32_dpp v17, v24, v17 row_newbcast:13 row_mask:0xf bank_mask:0xf
  v_mul_f32_dpp v18, v24, v18 row_newbcast:14 row_mask:0xf bank_mask:0xf
  v_mul_f32_dpp v19, v24, v19 row_newbcast:15 row_mask:0xf bank_mask:0xf
  v_cvt_pk_bf16_f32 v134, v16, v17
  v_cvt_pk_bf16_f32 v135, v18, v19
  s_waitcnt lgkmcnt(4)
  s_barrier
  s_waitcnt lgkmcnt(0)
  v_mfma_f32_32x32x16_bf16 a[224:239], v[48:51], a[48:51], a[224:239]
  ds_read_b128 v[36:39], v0 offset:16384
  ds_read_b128 v[40:43], v0 offset:45056
  ds_read_b64 v[46:47], v14 offset:2048
  ds_read_b128 v[28:31], v0 offset:4096
  ds_read_b128 v[32:35], v0 offset:32768
  ds_read_b64 v[44:45], v14 offset:512
  v_lshlrev_b32 v16, 16, v136
  v_and_b32 v17, s52, v136
  v_lshlrev_b32 v18, 16, v137
  v_mfma_f32_32x32x16_bf16 a[224:239], v[52:55], a[52:55], a[224:239]
  ds_write_b128 v5, a[240:243] offset:20480
  v_and_b32 v19, s52, v137
  v_mfma_f32_32x32x16_bf16 a[224:239], v[56:59], a[104:107], a[224:239]
  v_mul_f32_dpp v16, v25, v16 row_newbcast:0 row_mask:0xf bank_mask:0xf
  v_mul_f32_dpp v17, v25, v17 row_newbcast:1 row_mask:0xf bank_mask:0xf
  v_mul_f32_dpp v18, v25, v18 row_newbcast:2 row_mask:0xf bank_mask:0xf
  v_mul_f32_dpp v19, v25, v19 row_newbcast:3 row_mask:0xf bank_mask:0xf
  v_cvt_pk_bf16_f32 v136, v16, v17
  v_cvt_pk_bf16_f32 v137, v18, v19
  s_waitcnt lgkmcnt(5)
  v_add_f32 v36, v36, v40
  v_add_f32 v37, v37, v41
  v_mfma_f32_32x32x16_bf16 a[224:239], v[60:63], a[108:111], a[224:239]
  ds_write_b128 v6, a[244:247] offset:20480
  v_add_f32 v38, v38, v42
  v_mfma_f32_32x32x16_bf16 a[224:239], v[64:67], a[160:163], a[224:239]
  v_add_f32 v39, v39, v43
  s_waitcnt lgkmcnt(5)
  v_lshlrev_b32 v40, 16, v46
  v_and_b32 v41, s52, v46
  v_lshlrev_b32 v42, 16, v47
  v_and_b32 v43, s52, v47
  v_add_f32 v36, v36, v40
  v_add_f32 v37, v37, v41
  v_add_f32 v38, v38, v42
  v_mfma_f32_32x32x16_bf16 a[224:239], v[68:71], a[164:167], a[224:239]
  ds_write_b128 v7, a[248:251] offset:20480
  v_add_f32 v39, v39, v43
  v_mfma_f32_32x32x16_bf16 a[224:239], v[72:75], a[216:219], a[224:239]
  v_cvt_pk_bf16_f32 v40, v36, v37
  v_cvt_pk_bf16_f32 v41, v38, v39
  v_lshlrev_b32 v16, 16, v138
  v_and_b32 v17, s52, v138
  v_lshlrev_b32 v18, 16, v139
  v_and_b32 v19, s52, v139
  v_mul_f32_dpp v16, v25, v16 row_newbcast:4 row_mask:0xf bank_mask:0xf
  v_mfma_f32_32x32x16_bf16 a[224:239], v[76:79], a[220:223], a[224:239]
  ds_write_b128 v8, a[252:255] offset:20480
  v_mul_f32_dpp v17, v25, v17 row_newbcast:5 row_mask:0xf bank_mask:0xf
  v_mfma_f32_32x32x16_bf16 a[224:239], v[80:83], v[192:195], a[224:239]
  buffer_store_dwordx2 v[40:41], v10, s[36:39], s76 offen nt
  v_mul_f32_dpp v18, v25, v18 row_newbcast:6 row_mask:0xf bank_mask:0xf
  v_mul_f32_dpp v19, v25, v19 row_newbcast:7 row_mask:0xf bank_mask:0xf
  v_cvt_pk_bf16_f32 v138, v16, v17
  v_cvt_pk_bf16_f32 v139, v18, v19
  v_lshlrev_b32 v16, 16, v140
  v_and_b32 v17, s52, v140
  v_lshlrev_b32 v18, 16, v141
  v_mfma_f32_32x32x16_bf16 a[224:239], v[84:87], v[196:199], a[224:239]
  ds_read_b128 a[240:243], v12 offset:896
  ds_read_b128 a[244:247], v12 offset:928
  v_and_b32 v19, s52, v141
  v_mul_f32_dpp v16, v25, v16 row_newbcast:8 row_mask:0xf bank_mask:0xf
  v_mul_f32_dpp v17, v25, v17 row_newbcast:9 row_mask:0xf bank_mask:0xf
  v_mul_f32_dpp v18, v25, v18 row_newbcast:10 row_mask:0xf bank_mask:0xf
  v_mul_f32_dpp v19, v25, v19 row_newbcast:11 row_mask:0xf bank_mask:0xf
  v_mfma_f32_32x32x16_bf16 a[224:239], v[88:91], v[248:251], a[224:239]
  ds_read_b128 a[248:251], v12 offset:960
  ds_read_b128 a[252:255], v12 offset:992
  v_cvt_pk_bf16_f32 v140, v16, v17
  v_cvt_pk_bf16_f32 v141, v18, v19
  v_lshlrev_b32 v16, 16, v142
  v_and_b32 v17, s52, v142
  v_lshlrev_b32 v18, 16, v143
  v_mfma_f32_32x32x16_bf16 a[224:239], v[92:95], v[252:255], a[224:239]
  v_and_b32 v19, s52, v143
  v_mul_f32_dpp v16, v25, v16 row_newbcast:12 row_mask:0xf bank_mask:0xf
  v_mul_f32_dpp v17, v25, v17 row_newbcast:13 row_mask:0xf bank_mask:0xf
  v_mul_f32_dpp v18, v25, v18 row_newbcast:14 row_mask:0xf bank_mask:0xf
  v_mul_f32_dpp v19, v25, v19 row_newbcast:15 row_mask:0xf bank_mask:0xf
  v_cvt_pk_bf16_f32 v142, v16, v17
  v_cvt_pk_bf16_f32 v143, v18, v19
  s_waitcnt lgkmcnt(4)
  s_barrier
  s_waitcnt lgkmcnt(0)
  v_mfma_f32_32x32x16_bf16 a[240:255], v[96:99], a[0:3], a[240:255]
  ds_read_b128 v[36:39], v0 offset:20480
  ds_read_b128 v[40:43], v0 offset:49152
  ds_read_b64 v[46:47], v14 offset:2560
  v_mfma_f32_32x32x16_bf16 a[240:255], v[100:103], a[4:7], a[240:255]
  ds_write_b128 v5, a[224:227] offset:24576
  v_mfma_f32_32x32x16_bf16 a[240:255], v[104:107], a[56:59], a[240:255]
  v_bfe_u32 v9, v14, 3, 3
  v_lshlrev_b32 v9, 12, v9
  v_add_u32 v9, 3840, v9
  buffer_load_dword v9, v9, s[4:7], 0 offen sc1
  v_mfma_f32_32x32x16_bf16 a[240:255], v[108:111], a[60:63], a[240:255]
  ds_write_b128 v6, a[228:231] offset:24576
  v_add_f32 v28, v28, v32
  v_mfma_f32_32x32x16_bf16 a[240:255], v[112:115], a[112:115], a[240:255]
  v_add_f32 v29, v29, v33
  v_add_f32 v30, v30, v34
  v_add_f32 v31, v31, v35
  v_lshlrev_b32 v32, 16, v44
  v_and_b32 v33, s52, v44
  v_lshlrev_b32 v34, 16, v45
  v_mfma_f32_32x32x16_bf16 a[240:255], v[116:119], a[116:119], a[240:255]
  ds_write_b128 v7, a[232:235] offset:24576
  v_and_b32 v35, s52, v45
  v_mfma_f32_32x32x16_bf16 a[240:255], v[120:123], a[168:171], a[240:255]
  v_add_f32 v28, v28, v32
  v_add_f32 v29, v29, v33
  v_add_f32 v30, v30, v34
  v_add_f32 v31, v31, v35
  v_cvt_pk_bf16_f32 v32, v28, v29
  v_cvt_pk_bf16_f32 v33, v30, v31
  v_mfma_f32_32x32x16_bf16 a[240:255], v[124:127], a[172:175], a[240:255]
  ds_write_b128 v8, a[236:239] offset:24576
  v_mfma_f32_32x32x16_bf16 a[240:255], v[128:131], v[144:147], a[240:255]
  buffer_store_dwordx2 v[32:33], v10, s[36:39], s73 offen nt
  v_mfma_f32_32x32x16_bf16 a[240:255], v[132:135], v[148:151], a[240:255]
  ds_read_b128 a[224:227], v12 offset:896
  ds_read_b128 a[228:231], v12 offset:928
  v_mfma_f32_32x32x16_bf16 a[240:255], v[136:139], v[200:203], a[240:255]
  ds_read_b128 a[232:235], v12 offset:960
  ds_read_b128 a[236:239], v12 offset:992
  v_mfma_f32_32x32x16_bf16 a[240:255], v[140:143], v[204:207], a[240:255]
  s_waitcnt lgkmcnt(4)
  s_barrier
  s_waitcnt vmcnt(1)
  v_cmp_gt_u32 vcc, 24, v9
  s_nop 1
  s_cbranch_vccz L_coopok
  s_mov_b32 s61, 0
L_coopwait:
  s_sleep 1
  v_bfe_u32 v9, v14, 3, 3
  v_lshlrev_b32 v9, 12, v9
  v_add_u32 v9, 3840, v9
  buffer_load_dword v9, v9, s[4:7], 0 offen sc1
  s_waitcnt vmcnt(0)
  v_cmp_gt_u32 vcc, 24, v9
  s_nop 1
  s_cbranch_vccz L_coopok2
  s_add_u32 s61, s61, 1
  s_cmp_lt_u32 s61, 0x40000
  s_cbranch_scc1 L_coopwait
L_coopok2:
L_coopok:
  s_waitcnt lgkmcnt(0)
  v_mfma_f32_32x32x16_bf16 a[224:239], v[96:99], a[8:11], a[224:239]
  ds_read_b128 v[28:31], v0 offset:8192
  ds_read_b128 v[32:35], v0 offset:36864
  ds_read_b64 v[44:45], v14 offset:1024
  v_mfma_f32_32x32x16_bf16 a[224:239], v[100:103], a[12:15], a[224:239]
  ds_write_b128 v1, a[240:243] offset:0
  s_add_u32 s55, s23, 0
  v_mfma_f32_32x32x16_bf16 a[224:239], v[104:107], a[64:67], a[224:239]
  buffer_load_dwordx4 v[48:51], v13, s[40:43], s55 offen offset:0 sc1
  v_mfma_f32_32x32x16_bf16 a[224:239], v[108:111], a[68:71], a[224:239]
  ds_write_b128 v2, a[244:247] offset:0
  v_add_f32 v36, v36, v40
  v_mfma_f32_32x32x16_bf16 a[224:239], v[112:115], a[120:123], a[224:239]
  buffer_load_dwordx4 v[52:55], v13, s[40:43], s55 offen offset:1024 sc1
  v_add_f32 v37, v37, v41
  v_add_f32 v38, v38, v42
  v_add_f32 v39, v39, v43
  v_mfma_f32_32x32x16_bf16 a[224:239], v[116:119], a[124:127], a[224:239]
  ds_write_b128 v3, a[248:251] offset:0
  v_lshlrev_b32 v40, 16, v46
  v_mfma_f32_32x32x16_bf16 a[224:239], v[120:123], a[176:179], a[224:239]
  v_and_b32 v41, s52, v46
  v_lshlrev_b32 v42, 16, v47
  v_and_b32 v43, s52, v47
  v_add_f32 v36, v36, v40
  v_add_f32 v37, v37, v41
  v_add_f32 v38, v38, v42
  v_add_f32 v39, v39, v43
  v_cvt_pk_bf16_f32 v40, v36, v37
  v_mfma_f32_32x32x16_bf16 a[224:239], v[124:127], a[180:183], a[224:239]
  ds_write_b128 v4, a[252:255] offset:0
  v_cvt_pk_bf16_f32 v41, v38, v39
  v_mfma_f32_32x32x16_bf16 a[224:239], v[128:131], v[152:155], a[224:239]
  buffer_store_dwordx2 v[40:41], v10, s[36:39], s77 offen nt
  v_mfma_f32_32x32x16_bf16 a[224:239], v[132:135], v[156:159], a[224:239]
  ds_read_b128 a[240:243], v12 offset:896
  ds_read_b128 a[244:247], v12 offset:928
  v_mfma_f32_32x32x16_bf16 a[224:239], v[136:139], v[208:211], a[224:239]
  ds_read_b128 a[248:251], v12 offset:960
  ds_read_b128 a[252:255], v12 offset:992
  v_mfma_f32_32x32x16_bf16 a[224:239], v[140:143], v[212:215], a[224:239]
  buffer_load_dwordx4 v[56:59], v13, s[40:43], s55 offen offset:2048 sc1
  s_waitcnt lgkmcnt(4)
  s_barrier
  s_waitcnt lgkmcnt(0)
  v_mfma_f32_32x32x16_bf16 a[240:255], v[96:99], a[16:19], a[240:255]
  ds_read_b128 v[36:39], v0 offset:24576
  ds_read_b128 v[40:43], v0 offset:53248
  ds_read_b64 v[46:47], v14 offset:3072
  v_mfma_f32_32x32x16_bf16 a[240:255], v[100:103], a[20:23], a[240:255]
  s_nop 2
  ds_write_b128 v1, a[224:227] offset:4096
  v_mfma_f32_32x32x16_bf16 a[240:255], v[104:107], a[72:75], a[240:255]
  buffer_load_dwordx4 v[60:63], v13, s[40:43], s55 offen offset:3072 sc1
  v_mfma_f32_32x32x16_bf16 a[240:255], v[108:111], a[76:79], a[240:255]
  ds_write_b128 v2, a[228:231] offset:4096
  s_add_u32 s55, s23, 4096
  v_mfma_f32_32x32x16_bf16 a[240:255], v[112:115], a[128:131], a[240:255]
  buffer_load_dwordx4 v[64:67], v13, s[40:43], s55 offen offset:0 sc1
  v_add_f32 v28, v28, v32
  v_add_f32 v29, v29, v33
  v_add_f32 v30, v30, v34
  v_add_f32 v31, v31, v35
  v_mfma_f32_32x32x16_bf16 a[240:255], v[116:119], a[132:135], a[240:255]
  ds_write_b128 v3, a[232:235] offset:4096
  v_lshlrev_b32 v32, 16, v44
  v_mfma_f32_32x32x16_bf16 a[240:255], v[120:123], a[184:187], a[240:255]
  v_and_b32 v33, s52, v44
  v_lshlrev_b32 v34, 16, v45
  v_and_b32 v35, s52, v45
  v_add_f32 v28, v28, v32
  v_add_f32 v29, v29, v33
  v_add_f32 v30, v30, v34
  v_add_f32 v31, v31, v35
  v_cvt_pk_bf16_f32 v32, v28, v29
  v_mfma_f32_32x32x16_bf16 a[240:255], v[124:127], a[188:191], a[240:255]
  ds_write_b128 v4, a[236:239] offset:4096
  v_cvt_pk_bf16_f32 v33, v30, v31
  v_mfma_f32_32x32x16_bf16 a[240:255], v[128:131], v[160:163], a[240:255]
  buffer_store_dwordx2 v[32:33], v10, s[36:39], s74 offen nt
  v_add_u32 v9, 0xffffd380, v12
  v_cndmask_b32 v9, v9, v5, s[64:65]
  v_mfma_f32_32x32x16_bf16 a[240:255], v[132:135], v[164:167], a[240:255]
  ds_read_b128 a[224:227], v9 offset:12288
  v_add_u32 v9, 0xffffd3a0, v12
  v_cndmask_b32 v9, v9, v6, s[64:65]
  ds_read_b128 a[228:231], v9 offset:12288
  v_add_u32 v9, 0xffffd3c0, v12
  v_cndmask_b32 v9, v9, v7, s[64:65]
  v_mfma_f32_32x32x16_bf16 a[240:255], v[136:139], v[216:219], a[240:255]
  ds_read_b128 a[232:235], v9 offset:12288
  v_add_u32 v9, 0xffffd3e0, v12
  v_cndmask_b32 v9, v9, v8, s[64:65]
  ds_read_b128 a[236:239], v9 offset:12288
  v_mfma_f32_32x32x16_bf16 a[240:255], v[140:143], v[220:223], a[240:255]
  buffer_load_dwordx4 v[68:71], v13, s[40:43], s55 offen offset:1024 sc1
  s_waitcnt lgkmcnt(4)
  s_barrier
  s_waitcnt lgkmcnt(0)
  v_mfma_f32_32x32x16_bf16 a[224:239], v[96:99], a[24:27], a[224:239]
  ds_read_b128 v[28:31], v0 offset:12288
  ds_read_b128 v[32:35], v0 offset:40960
  ds_read_b64 v[44:45], v14 offset:1536
  v_mfma_f32_32x32x16_bf16 a[224:239], v[100:103], a[28:31], a[224:239]
  s_nop 2
  ds_write_b128 v1, a[240:243] offset:8192
  v_mfma_f32_32x32x16_bf16 a[224:239], v[104:107], a[80:83], a[224:239]
  buffer_load_dwordx4 v[72:75], v13, s[40:43], s55 offen offset:2048 sc1
  v_mfma_f32_32x32x16_bf16 a[224:239], v[108:111], a[84:87], a[224:239]
  ds_write_b128 v2, a[244:247] offset:8192
  v_add_f32 v36, v36, v40
  v_mfma_f32_32x32x16_bf16 a[224:239], v[112:115], a[136:139], a[224:239]
  buffer_load_dwordx4 v[76:79], v13, s[40:43], s55 offen offset:3072 sc1
  v_add_f32 v37, v37, v41
  v_add_f32 v38, v38, v42
  v_add_f32 v39, v39, v43
  v_mfma_f32_32x32x16_bf16 a[224:239], v[116:119], a[140:143], a[224:239]
  ds_write_b128 v3, a[248:251] offset:8192
  v_lshlrev_b32 v40, 16, v46
  v_mfma_f32_32x32x16_bf16 a[224:239], v[120:123], a[192:195], a[224:239]
  v_and_b32 v41, s52, v46
  v_lshlrev_b32 v42, 16, v47
  v_and_b32 v43, s52, v47
  v_add_f32 v36, v36, v40
  v_add_f32 v37, v37, v41
  v_add_f32 v38, v38, v42
  v_add_f32 v39, v39, v43
  v_cvt_pk_bf16_f32 v40, v36, v37
  v_mfma_f32_32x32x16_bf16 a[224:239], v[124:127], a[196:199], a[224:239]
  ds_write_b128 v4, a[252:255] offset:8192
  v_cvt_pk_bf16_f32 v41, v38, v39
  v_mfma_f32_32x32x16_bf16 a[224:239], v[128:131], v[168:171], a[224:239]
  buffer_store_dwordx2 v[40:41], v10, s[36:39], s78 offen nt
  v_mfma_f32_32x32x16_bf16 a[224:239], v[132:135], v[172:175], a[224:239]
  ds_read_b128 a[240:243], v5 offset:16384
  ds_read_b128 a[244:247], v6 offset:16384
  v_mfma_f32_32x32x16_bf16 a[224:239], v[136:139], v[224:227], a[224:239]
  ds_read_b128 a[248:251], v7 offset:16384
  ds_read_b128 a[252:255], v8 offset:16384
  s_add_u32 s55, s23, 8192
  v_mfma_f32_32x32x16_bf16 a[224:239], v[140:143], v[228:231], a[224:239]
  buffer_load_dwordx4 v[80:83], v13, s[40:43], s55 offen offset:0 sc1
  s_waitcnt lgkmcnt(4)
  s_barrier
  s_waitcnt lgkmcnt(0)
  v_mfma_f32_32x32x16_bf16 a[240:255], v[96:99], a[32:35], a[240:255]
  v_mfma_f32_32x32x16_bf16 a[240:255], v[100:103], a[36:39], a[240:255]
  s_nop 5
  ds_write_b128 v5, a[224:227] offset:12288
  v_mfma_f32_32x32x16_bf16 a[240:255], v[104:107], a[88:91], a[240:255]
  buffer_load_dwordx4 v[84:87], v13, s[40:43], s55 offen offset:1024 sc1
  v_mfma_f32_32x32x16_bf16 a[240:255], v[108:111], a[92:95], a[240:255]
  ds_write_b128 v6, a[228:231] offset:12288
  v_add_f32 v28, v28, v32
  v_mfma_f32_32x32x16_bf16 a[240:255], v[112:115], a[144:147], a[240:255]
  buffer_load_dwordx4 v[88:91], v13, s[40:43], s55 offen offset:2048 sc1
  v_add_f32 v29, v29, v33
  v_add_f32 v30, v30, v34
  v_add_f32 v31, v31, v35
  v_mfma_f32_32x32x16_bf16 a[240:255], v[116:119], a[148:151], a[240:255]
  ds_write_b128 v7, a[232:235] offset:12288
  v_lshlrev_b32 v32, 16, v44
  v_mfma_f32_32x32x16_bf16 a[240:255], v[120:123], a[200:203], a[240:255]
  v_and_b32 v33, s52, v44
  v_lshlrev_b32 v34, 16, v45
  v_and_b32 v35, s52, v45
  v_add_f32 v28, v28, v32
  v_add_f32 v29, v29, v33
  v_add_f32 v30, v30, v34
  v_add_f32 v31, v31, v35
  v_cvt_pk_bf16_f32 v32, v28, v29
  v_mfma_f32_32x32x16_bf16 a[240:255], v[124:127], a[204:207], a[240:255]
  ds_write_b128 v8, a[236:239] offset:12288
  v_cvt_pk_bf16_f32 v33, v30, v31
  v_mfma_f32_32x32x16_bf16 a[240:255], v[128:131], v[176:179], a[240:255]
  buffer_store_dwordx2 v[32:33], v10, s[36:39], s75 offen nt
  v_add_u32 v10, 64, v10
  v_mfma_f32_32x32x16_bf16 a[240:255], v[132:135], v[180:183], a[240:255]
  ds_read_b128 a[224:227], v5 offset:20480
  ds_read_b128 a[228:231], v6 offset:20480
  v_mfma_f32_32x32x16_bf16 a[240:255], v[136:139], v[232:235], a[240:255]
  ds_read_b128 a[232:235], v7 offset:20480
  ds_read_b128 a[236:239], v8 offset:20480
  v_mfma_f32_32x32x16_bf16 a[240:255], v[140:143], v[236:239], a[240:255]
  buffer_load_dwordx4 v[92:95], v13, s[40:43], s55 offen offset:3072 sc1
  s_waitcnt lgkmcnt(4)
  s_barrier
  s_waitcnt lgkmcnt(0)
  v_mfma_f32_32x32x16_bf16 a[224:239], v[96:99], a[40:43], a[224:239]
  ds_read_b128 v[36:39], v0 offset:0
  ds_read_b128 v[40:43], v0 offset:28672
  ds_read_b64 v[46:47], v14 offset:4096
  v_mfma_f32_32x32x16_bf16 a[224:239], v[100:103], a[44:47], a[224:239]
  s_nop 2
  ds_write_b128 v5, a[240:243] offset:16384
  v_add_u32 v15, 64, v15
  s_add_u32 m0, s62, 0
  v_mfma_f32_32x32x16_bf16 a[224:239], v[104:107], a[96:99], a[224:239]
  buffer_load_dwordx4 v15, s[24:27], 0 offen offset:0 lds
  v_mfma_f32_32x32x16_bf16 a[224:239], v[108:111], a[100:103], a[224:239]
  ds_write_b128 v6, a[244:247] offset:16384
  s_waitcnt lgkmcnt(3)
  v_add_f32 v36, v36, v40
  v_mfma_f32_32x32x16_bf16 a[224:239], v[112:115], a[152:155], a[224:239]
  buffer_load_dwordx4 v15, s[24:27], s96 offen offset:1024 lds
  v_add_f32 v37, v37, v41
  v_add_f32 v38, v38, v42
  v_add_f32 v39, v39, v43
  s_waitcnt lgkmcnt(2)
  v_lshlrev_b32 v40, 16, v46
  v_and_b32 v41, s52, v46
  v_lshlrev_b32 v42, 16, v47
  v_mfma_f32_32x32x16_bf16 a[224:239], v[116:119], a[156:159], a[224:239]
  ds_write_b128 v7, a[248:251] offset:16384
  v_and_b32 v43, s52, v47
  v_mfma_f32_32x32x16_bf16 a[224:239], v[120:123], a[208:211], a[224:239]
  buffer_load_dwordx4 v15, s[24:27], s98 offen offset:3072 lds
  v_add_f32 v36, v36, v40
  v_add_f32 v37, v37, v41
  v_add_f32 v38, v38, v42
  v_add_f32 v39, v39, v43
  v_cvt_pk_bf16_f32 v40, v36, v37
  v_mfma_f32_32x32x16_bf16 a[224:239], v[124:127], a[212:215], a[224:239]
  ds_write_b128 v8, a[252:255] offset:16384
  v_cvt_pk_bf16_f32 v41, v38, v39
  v_mfma_f32_32x32x16_bf16 a[224:239], v[128:131], v[184:187], a[224:239]
  buffer_store_dwordx2 v[40:41], v10, s[36:39], 0 offen nt
  v_mfma_f32_32x32x16_bf16 a[224:239], v[132:135], v[188:191], a[224:239]
  ds_read_b128 a[240:243], v5 offset:24576
  ds_read_b128 a[244:247], v6 offset:24576
  v_mfma_f32_32x32x16_bf16 a[224:239], v[136:139], v[240:243], a[224:239]
  ds_read_b128 a[248:251], v7 offset:24576
  ds_read_b128 a[252:255], v8 offset:24576
  v_mfma_f32_32x32x16_bf16 a[224:239], v[140:143], v[244:247], a[224:239]
  buffer_load_dwordx4 v15, s[24:27], s97 offen offset:2048 lds
  s_waitcnt lgkmcnt(4)
  s_barrier
  s_waitcnt lgkmcnt(0)
  v_mfma_f32_32x32x16_bf16 a[240:255], v[96:99], a[48:51], a[240:255]
  ds_read_b128 v[28:31], v0 offset:16384
  ds_read_b128 v[32:35], v0 offset:45056
  ds_read_b64 v[44:45], v14 offset:6144
  ds_read_b128 v[36:39], v0 offset:4096
  ds_read_b128 v[40:43], v0 offset:32768
  ds_read_b64 v[46:47], v14 offset:4608
  v_mfma_f32_32x32x16_bf16 a[240:255], v[100:103], a[52:55], a[240:255]
  ds_write_b128 v5, a[224:227] offset:20480
  v_mfma_f32_32x32x16_bf16 a[240:255], v[104:107], a[104:107], a[240:255]
  v_mfma_f32_32x32x16_bf16 a[240:255], v[108:111], a[108:111], a[240:255]
  ds_write_b128 v6, a[228:231] offset:20480
  s_waitcnt lgkmcnt(6)
  v_add_f32 v28, v28, v32
  v_mfma_f32_32x32x16_bf16 a[240:255], v[112:115], a[160:163], a[240:255]
  v_add_f32 v29, v29, v33
  v_add_f32 v30, v30, v34
  v_add_f32 v31, v31, v35
  s_waitcnt lgkmcnt(5)
  v_lshlrev_b32 v32, 16, v44
  v_and_b32 v33, s52, v44
  v_lshlrev_b32 v34, 16, v45
  v_mfma_f32_32x32x16_bf16 a[240:255], v[116:119], a[164:167], a[240:255]
  ds_write_b128 v7, a[232:235] offset:20480
  v_and_b32 v35, s52, v45
  v_mfma_f32_32x32x16_bf16 a[240:255], v[120:123], a[216:219], a[240:255]
  v_add_f32 v28, v28, v32
  v_add_f32 v29, v29, v33
  v_add_f32 v30, v30, v34
  v_add_f32 v31, v31, v35
  v_cvt_pk_bf16_f32 v32, v28, v29
  v_cvt_pk_bf16_f32 v33, v30, v31
  v_mfma_f32_32x32x16_bf16 a[240:255], v[124:127], a[220:223], a[240:255]
  ds_write_b128 v8, a[236:239] offset:20480
  v_mfma_f32_32x32x16_bf16 a[240:255], v[128:131], v[192:195], a[240:255]
  buffer_store_dwordx2 v[32:33], v10, s[36:39], s76 offen nt
  v_mfma_f32_32x32x16_bf16 a[240:255], v[132:135], v[196:199], a[240:255]
  ds_read_b128 a[224:227], v12 offset:1024
  ds_read_b128 a[228:231], v12 offset:1056
  v_mfma_f32_32x32x16_bf16 a[240:255], v[136:139], v[248:251], a[240:255]
  ds_read_b128 a[232:235], v12 offset:1088
  ds_read_b128 a[236:239], v12 offset:1120
  v_mfma_f32_32x32x16_bf16 a[240:255], v[140:143], v[252:255], a[240:255]
  s_waitcnt lgkmcnt(4)
  s_barrier
  s_waitcnt vmcnt(6)
  s_waitcnt lgkmcnt(0)
  v_mfma_f32_32x32x16_bf16 a[224:239], v[48:51], a[0:3], a[224:239]
  ds_read_b128 v[28:31], v0 offset:20480
  ds_read_b128 v[32:35], v0 offset:49152
  ds_read_b64 v[44:45], v14 offset:6656
  v_mfma_f32_32x32x16_bf16 a[224:239], v[52:55], a[4:7], a[224:239]
  s_nop 2
  ds_write_b128 v5, a[240:243] offset:24576
  s_add_u32 s55, s23, 49152
  v_mfma_f32_32x32x16_bf16 a[224:239], v[56:59], a[56:59], a[224:239]
  buffer_load_dwordx4 v[96:99], v13, s[40:43], s55 offen offset:0 sc1
  v_mfma_f32_32x32x16_bf16 a[224:239], v[60:63], a[60:63], a[224:239]
  ds_write_b128 v6, a[244:247] offset:24576
  v_add_f32 v36, v36, v40
  v_mfma_f32_32x32x16_bf16 a[224:239], v[64:67], a[112:115], a[224:239]
  buffer_load_dwordx4 v[100:103], v13, s[40:43], s55 offen offset:1024 sc1
  v_add_f32 v37, v37, v41
  v_add_f32 v38, v38, v42
  v_add_f32 v39, v39, v43
  v_mfma_f32_32x32x16_bf16 a[224:239], v[68:71], a[116:119], a[224:239]
  ds_write_b128 v7, a[248:251] offset:24576
  v_lshlrev_b32 v40, 16, v46
  v_mfma_f32_32x32x16_bf16 a[224:239], v[72:75], a[168:171], a[224:239]
  v_and_b32 v41, s52, v46
  v_lshlrev_b32 v42, 16, v47
  v_and_b32 v43, s52, v47
  v_add_f32 v36, v36, v40
  v_add_f32 v37, v37, v41
  v_add_f32 v38, v38, v42
  v_add_f32 v39, v39, v43
  v_cvt_pk_bf16_f32 v40, v36, v37
  v_mfma_f32_32x32x16_bf16 a[224:239], v[76:79], a[172:175], a[224:239]
  ds_write_b128 v8, a[252:255] offset:24576
  v_cvt_pk_bf16_f32 v41, v38, v39
  v_mfma_f32_32x32x16_bf16 a[224:239], v[80:83], v[144:147], a[224:239]
  buffer_store_dwordx2 v[40:41], v10, s[36:39], s73 offen nt
  v_mfma_f32_32x32x16_bf16 a[224:239], v[84:87], v[148:151], a[224:239]
  ds_read_b128 a[240:243], v12 offset:1024
  ds_read_b128 a[244:247], v12 offset:1056
  v_mfma_f32_32x32x16_bf16 a[224:239], v[88:91], v[200:203], a[224:239]
  ds_read_b128 a[248:251], v12 offset:1088
  ds_read_b128 a[252:255], v12 offset:1120
  v_mfma_f32_32x32x16_bf16 a[224:239], v[92:95], v[204:207], a[224:239]
  buffer_load_dwordx4 v[104:107], v13, s[40:43], s55 offen offset:2048 sc1
  s_waitcnt lgkmcnt(4)
  s_barrier
  s_waitcnt lgkmcnt(0)
  v_mfma_f32_32x32x16_bf16 a[240:255], v[48:51], a[8:11], a[240:255]
  ds_read_b128 v[36:39], v0 offset:8192
  ds_read_b128 v[40:43], v0 offset:36864
  ds_read_b64 v[46:47], v14 offset:5120
  v_mfma_f32_32x32x16_bf16 a[240:255], v[52:55], a[12:15], a[240:255]
  s_nop 2
  ds_write_b128 v1, a[224:227] offset:0
  v_mfma_f32_32x32x16_bf16 a[240:255], v[56:59], a[64:67], a[240:255]
  buffer_load_dwordx4 v[108:111], v13, s[40:43], s55 offen offset:3072 sc1
  v_mfma_f32_32x32x16_bf16 a[240:255], v[60:63], a[68:71], a[240:255]
  ds_write_b128 v2, a[228:231] offset:0
  s_add_u32 s55, s23, 53248
  v_mfma_f32_32x32x16_bf16 a[240:255], v[64:67], a[120:123], a[240:255]
  buffer_load_dwordx4 v[112:115], v13, s[40:43], s55 offen offset:0 sc1
  v_add_f32 v28, v28, v32
  v_add_f32 v29, v29, v33
  v_add_f32 v30, v30, v34
  v_add_f32 v31, v31, v35
  v_mfma_f32_32x32x16_bf16 a[240:255], v[68:71], a[124:127], a[240:255]
  ds_write_b128 v3, a[232:235] offset:0
  v_lshlrev_b32 v32, 16, v44
  v_mfma_f32_32x32x16_bf16 a[240:255], v[72:75], a[176:179], a[240:255]
  v_and_b32 v33, s52, v44
  v_lshlrev_b32 v34, 16, v45
  v_and_b32 v35, s52, v45
  v_add_f32 v28, v28, v32
  v_add_f32 v29, v29, v33
  v_add_f32 v30, v30, v34
  v_add_f32 v31, v31, v35
  v_cvt_pk_bf16_f32 v32, v28, v29
  v_mfma_f32_32x32x16_bf16 a[240:255], v[76:79], a[180:183], a[240:255]
  ds_write_b128 v4, a[236:239] offset:0
  v_cvt_pk_bf16_f32 v33, v30, v31
  v_mfma_f32_32x32x16_bf16 a[240:255], v[80:83], v[152:155], a[240:255]
  buffer_store_dwordx2 v[32:33], v10, s[36:39], s77 offen nt
  v_mfma_f32_32x32x16_bf16 a[240:255], v[84:87], v[156:159], a[240:255]
  ds_read_b128 a[224:227], v12 offset:1024
  ds_read_b128 a[228:231], v12 offset:1056
  v_mfma_f32_32x32x16_bf16 a[240:255], v[88:91], v[208:211], a[240:255]
  ds_read_b128 a[232:235], v12 offset:1088
  ds_read_b128 a[236:239], v12 offset:1120
  v_mfma_f32_32x32x16_bf16 a[240:255], v[92:95], v[212:215], a[240:255]
  buffer_load_dwordx4 v[116:119], v13, s[40:43], s55 offen offset:1024 sc1
  s_waitcnt lgkmcnt(4)
  s_barrier
  s_waitcnt lgkmcnt(0)
  v_mfma_f32_32x32x16_bf16 a[224:239], v[48:51], a[16:19], a[224:239]
  ds_read_b128 v[28:31], v0 offset:24576
  ds_read_b128 v[32:35], v0 offset:53248
  ds_read_b64 v[44:45], v14 offset:7168
  v_mfma_f32_32x32x16_bf16 a[224:239], v[52:55], a[20:23], a[224:239]
  s_nop 2
  ds_write_b128 v1, a[240:243] offset:4096
  v_mfma_f32_32x32x16_bf16 a[224:239], v[56:59], a[72:75], a[224:239]
  buffer_load_dwordx4 v[120:123], v13, s[40:43], s55 offen offset:2048 sc1
  v_mfma_f32_32x32x16_bf16 a[224:239], v[60:63], a[76:79], a[224:239]
  ds_write_b128 v2, a[244:247] offset:4096
  v_add_f32 v36, v36, v40
  v_mfma_f32_32x32x16_bf16 a[224:239], v[64:67], a[128:131], a[224:239]
  buffer_load_dwordx4 v[124:127], v13, s[40:43], s55 offen offset:3072 sc1
  v_add_f32 v37, v37, v41
  v_add_f32 v38, v38, v42
  v_add_f32 v39, v39, v43
  v_mfma_f32_32x32x16_bf16 a[224:239], v[68:71], a[132:135], a[224:239]
  ds_write_b128 v3, a[248:251] offset:4096
  v_lshlrev_b32 v40, 16, v46
  v_mfma_f32_32x32x16_bf16 a[224:239], v[72:75], a[184:187], a[224:239]
  v_and_b32 v41, s52, v46
  v_lshlrev_b32 v42, 16, v47
  v_and_b32 v43, s52, v47
  v_add_f32 v36, v36, v40
  v_add_f32 v37, v37, v41
  v_add_f32 v38, v38, v42
  v_add_f32 v39, v39, v43
  v_cvt_pk_bf16_f32 v40, v36, v37
  v_mfma_f32_32x32x16_bf16 a[224:239], v[76:79], a[188:191], a[224:239]
  ds_write_b128 v4, a[252:255] offset:4096
  v_cvt_pk_bf16_f32 v41, v38, v39
  v_mfma_f32_32x32x16_bf16 a[224:239], v[80:83], v[160:163], a[224:239]
  buffer_store_dwordx2 v[40:41], v10, s[36:39], s74 offen nt
  v_add_u32 v9, 0xffffd400, v12
  v_cndmask_b32 v9, v9, v5, s[64:65]
  v_mfma_f32_32x32x16_bf16 a[224:239], v[84:87], v[164:167], a[224:239]
  ds_read_b128 a[240:243], v9 offset:12288
  v_add_u32 v9, 0xffffd420, v12
  v_cndmask_b32 v9, v9, v6, s[64:65]
  ds_read_b128 a[244:247], v9 offset:12288
  v_add_u32 v9, 0xffffd440, v12
  v_cndmask_b32 v9, v9, v7, s[64:65]
  v_mfma_f32_32x32x16_bf16 a[224:239], v[88:91], v[216:219], a[224:239]
  ds_read_b128 a[248:251], v9 offset:12288
  v_add_u32 v9, 0xffffd460, v12
  v_cndmask_b32 v9, v9, v8, s[64:65]
  ds_read_b128 a[252:255], v9 offset:12288
  s_add_u32 s55, s23, 57344
  v_mfma_f32_32x32x16_bf16 a[224:239], v[92:95], v[220:223], a[224:239]
  buffer_load_dwordx4 v[128:131], v13, s[40:43], s55 offen offset:0 sc1
  s_waitcnt lgkmcnt(4)
  s_barrier
  s_waitcnt lgkmcnt(0)
  v_mfma_f32_32x32x16_bf16 a[240:255], v[48:51], a[24:27], a[240:255]
  ds_read_b128 v[36:39], v0 offset:12288
  ds_read_b128 v[40:43], v0 offset:40960
  ds_read_b64 v[46:47], v14 offset:5632
  v_mfma_f32_32x32x16_bf16 a[240:255], v[52:55], a[28:31], a[240:255]
  s_nop 2
  ds_write_b128 v1, a[224:227] offset:8192
  v_mfma_f32_32x32x16_bf16 a[240:255], v[56:59], a[80:83], a[240:255]
  buffer_load_dwordx4 v[132:135], v13, s[40:43], s55 offen offset:1024 sc1
  v_mfma_f32_32x32x16_bf16 a[240:255], v[60:63], a[84:87], a[240:255]
  ds_write_b128 v2, a[228:231] offset:8192
  v_add_f32 v28, v28, v32
  v_mfma_f32_32x32x16_bf16 a[240:255], v[64:67], a[136:139], a[240:255]
  buffer_load_dwordx4 v[136:139], v13, s[40:43], s55 offen offset:2048 sc1
  v_add_f32 v29, v29, v33
  v_add_f32 v30, v30, v34
  v_add_f32 v31, v31, v35
  v_mfma_f32_32x32x16_bf16 a[240:255], v[68:71], a[140:143], a[240:255]
  ds_write_b128 v3, a[232:235] offset:8192
  v_lshlrev_b32 v32, 16, v44
  v_mfma_f32_32x32x16_bf16 a[240:255], v[72:75], a[192:195], a[240:255]
  v_and_b32 v33, s52, v44
  v_lshlrev_b32 v34, 16, v45
  v_and_b32 v35, s52, v45
  v_add_f32 v28, v28, v32
  v_add_f32 v29, v29, v33
  v_add_f32 v30, v30, v34
  v_add_f32 v31, v31, v35
  v_cvt_pk_bf16_f32 v32, v28, v29
  v_mfma_f32_32x32x16_bf16 a[240:255], v[76:79], a[196:199], a[240:255]
  ds_write_b128 v4, a[236:239] offset:8192
  v_cvt_pk_bf16_f32 v33, v30, v31
  v_mfma_f32_32x32x16_bf16 a[240:255], v[80:83], v[168:171], a[240:255]
  buffer_store_dwordx2 v[32:33], v10, s[36:39], s78 offen nt
  v_mfma_f32_32x32x16_bf16 a[240:255], v[84:87], v[172:175], a[240:255]
  ds_read_b128 a[224:227], v5 offset:16384
  ds_read_b128 a[228:231], v6 offset:16384
  v_mfma_f32_32x32x16_bf16 a[240:255], v[88:91], v[224:227], a[240:255]
  ds_read_b128 a[232:235], v7 offset:16384
  ds_read_b128 a[236:239], v8 offset:16384
  v_mfma_f32_32x32x16_bf16 a[240:255], v[92:95], v[228:231], a[240:255]
  buffer_load_dwordx4 v[140:143], v13, s[40:43], s55 offen offset:3072 sc1
  s_waitcnt lgkmcnt(4)
  s_barrier
  s_waitcnt lgkmcnt(0)
  v_mfma_f32_32x32x16_bf16 a[224:239], v[48:51], a[32:35], a[224:239]
  v_mfma_f32_32x32x16_bf16 a[224:239], v[52:55], a[36:39], a[224:239]
  s_nop 5
  ds_write_b128 v5, a[240:243] offset:12288
  v_mfma_f32_32x32x16_bf16 a[224:239], v[56:59], a[88:91], a[224:239]
  v_mfma_f32_32x32x16_bf16 a[224:239], v[60:63], a[92:95], a[224:239]
  ds_write_b128 v6, a[244:247] offset:12288
  v_add_f32 v36, v36, v40
  v_mfma_f32_32x32x16_bf16 a[224:239], v[64:67], a[144:147], a[224:239]
  v_add_f32 v37, v37, v41
  v_add_f32 v38, v38, v42
  v_add_f32 v39, v39, v43
  v_lshlrev_b32 v40, 16, v46
  v_and_b32 v41, s52, v46
  v_lshlrev_b32 v42, 16, v47
  v_mfma_f32_32x32x16_bf16 a[224:239], v[68:71], a[148:151], a[224:239]
  ds_write_b128 v7, a[248:251] offset:12288
  v_and_b32 v43, s52, v47
  v_mfma_f32_32x32x16_bf16 a[224:239], v[72:75], a[200:203], a[224:239]
  v_add_f32 v36, v36, v40
  v_add_f32 v37, v37, v41
  v_add_f32 v38, v38, v42
  v_add_f32 v39, v39, v43
  v_cvt_pk_bf16_f32 v40, v36, v37
  v_cvt_pk_bf16_f32 v41, v38, v39
  v_mfma_f32_32x32x16_bf16 a[224:239], v[76:79], a[204:207], a[224:239]
  ds_write_b128 v8, a[252:255] offset:12288
  v_mfma_f32_32x32x16_bf16 a[224:239], v[80:83], v[176:179], a[224:239]
  buffer_store_dwordx2 v[40:41], v10, s[36:39], s75 offen nt
  v_add_u32 v10, 64, v10
  v_mfma_f32_32x32x16_bf16 a[224:239], v[84:87], v[180:183], a[224:239]
  ds_read_b128 a[240:243], v5 offset:20480
  ds_read_b128 a[244:247], v6 offset:20480
  v_mfma_f32_32x32x16_bf16 a[224:239], v[88:91], v[232:235], a[224:239]
  ds_read_b128 a[248:251], v7 offset:20480
  ds_read_b128 a[252:255], v8 offset:20480
  v_mfma_f32_32x32x16_bf16 a[224:239], v[92:95], v[236:239], a[224:239]
  s_waitcnt lgkmcnt(4)
  s_barrier
  s_waitcnt vmcnt(18)
  s_waitcnt lgkmcnt(0)
  v_mfma_f32_32x32x16_bf16 a[240:255], v[48:51], a[40:43], a[240:255]
  ds_read_b128 v[28:31], v0 offset:0
  ds_read_b128 v[32:35], v0 offset:28672
  ds_read_b64 v[44:45], v14 offset:0
  v_mfma_f32_32x32x16_bf16 a[240:255], v[52:55], a[44:47], a[240:255]
  s_nop 2
  ds_write_b128 v5, a[224:227] offset:16384
  v_add_u32 v15, 64, v15
  s_add_u32 m0, s62, 4096
  v_mfma_f32_32x32x16_bf16 a[240:255], v[56:59], a[96:99], a[240:255]
  buffer_load_dwordx4 v15, s[24:27], 0 offen offset:0 lds
  v_mfma_f32_32x32x16_bf16 a[240:255], v[60:63], a[100:103], a[240:255]
  ds_write_b128 v6, a[228:231] offset:16384
  s_waitcnt lgkmcnt(3)
  v_add_f32 v28, v28, v32
  v_mfma_f32_32x32x16_bf16 a[240:255], v[64:67], a[152:155], a[240:255]
  buffer_load_dwordx4 v15, s[24:27], s96 offen offset:1024 lds
  v_add_f32 v29, v29, v33
  v_add_f32 v30, v30, v34
  v_add_f32 v31, v31, v35
  s_waitcnt lgkmcnt(2)
  v_lshlrev_b32 v32, 16, v44
  v_and_b32 v33, s52, v44
  v_lshlrev_b32 v34, 16, v45
  v_mfma_f32_32x32x16_bf16 a[240:255], v[68:71], a[156:159], a[240:255]
  ds_write_b128 v7, a[232:235] offset:16384
  v_and_b32 v35, s52, v45
  v_mfma_f32_32x32x16_bf16 a[240:255], v[72:75], a[208:211], a[240:255]
  buffer_load_dwordx4 v15, s[24:27], s98 offen offset:3072 lds
  v_add_f32 v28, v28, v32
  v_add_f32 v29, v29, v33
  v_add_f32 v30, v30, v34
  v_add_f32 v31, v31, v35
  v_cvt_pk_bf16_f32 v32, v28, v29
  v_mfma_f32_32x32x16_bf16 a[240:255], v[76:79], a[212:215], a[240:255]
  ds_write_b128 v8, a[236:239] offset:16384
  v_cvt_pk_bf16_f32 v33, v30, v31
  v_mfma_f32_32x32x16_bf16 a[240:255], v[80:83], v[184:187], a[240:255]
  buffer_store_dwordx2 v[32:33], v10, s[36:39], 0 offen nt
  v_mfma_f32_32x32x16_bf16 a[240:255], v[84:87], v[188:191], a[240:255]
  ds_read_b128 a[224:227], v5 offset:24576
  ds_read_b128 a[228:231], v6 offset:24576
  v_mfma_f32_32x32x16_bf16 a[240:255], v[88:91], v[240:243], a[240:255]
  ds_read_b128 a[232:235], v7 offset:24576
  ds_read_b128 a[236:239], v8 offset:24576
  v_mfma_f32_32x32x16_bf16 a[240:255], v[92:95], v[244:247], a[240:255]
  buffer_load_dwordx4 v15, s[24:27], s97 offen offset:2048 lds
  s_waitcnt lgkmcnt(4)
  s_barrier
  s_waitcnt lgkmcnt(0)
  v_mfma_f32_32x32x16_bf16 a[224:239], v[48:51], a[48:51], a[224:239]
  ds_read_b128 v[36:39], v0 offset:16384
  ds_read_b128 v[40:43], v0 offset:45056
  ds_read_b64 v[46:47], v14 offset:2048
  ds_read_b128 v[28:31], v0 offset:4096
  ds_read_b128 v[32:35], v0 offset:32768
  ds_read_b64 v[44:45], v14 offset:512
  v_mfma_f32_32x32x16_bf16 a[224:239], v[52:55], a[52:55], a[224:239]
  ds_write_b128 v5, a[240:243] offset:20480
  v_mfma_f32_32x32x16_bf16 a[224:239], v[56:59], a[104:107], a[224:239]
  v_mfma_f32_32x32x16_bf16 a[224:239], v[60:63], a[108:111], a[224:239]
  ds_write_b128 v6, a[244:247] offset:20480
  s_waitcnt lgkmcnt(6)
  v_add_f32 v36, v36, v40
  v_mfma_f32_32x32x16_bf16 a[224:239], v[64:67], a[160:163], a[224:239]
  v_add_f32 v37, v37, v41
  v_add_f32 v38, v38, v42
  v_add_f32 v39, v39, v43
  s_waitcnt lgkmcnt(5)
  v_lshlrev_b32 v40, 16, v46
  v_and_b32 v41, s52, v46
  v_lshlrev_b32 v42, 16, v47
  v_mfma_f32_32x32x16_bf16 a[224:239], v[68:71], a[164:167], a[224:239]
  ds_write_b128 v7, a[248:251] offset:20480
  v_and_b32 v43, s52, v47
  v_mfma_f32_32x32x16_bf16 a[224:239], v[72:75], a[216:219], a[224:239]
  v_add_f32 v36, v36, v40
  v_add_f32 v37, v37, v41
  v_add_f32 v38, v38, v42
  v_add_f32 v39, v39, v43
  v_cvt_pk_bf16_f32 v40, v36, v37
  v_cvt_pk_bf16_f32 v41, v38, v39
  v_mfma_f32_32x32x16_bf16 a[224:239], v[76:79], a[220:223], a[224:239]
  ds_write_b128 v8, a[252:255] offset:20480
  v_mfma_f32_32x32x16_bf16 a[224:239], v[80:83], v[192:195], a[224:239]
  buffer_store_dwordx2 v[40:41], v10, s[36:39], s76 offen nt
  v_mfma_f32_32x32x16_bf16 a[224:239], v[84:87], v[196:199], a[224:239]
  ds_read_b128 a[240:243], v12 offset:1152
  ds_read_b128 a[244:247], v12 offset:1184
  v_mfma_f32_32x32x16_bf16 a[224:239], v[88:91], v[248:251], a[224:239]
  ds_read_b128 a[248:251], v12 offset:1216
  ds_read_b128 a[252:255], v12 offset:1248
  v_mfma_f32_32x32x16_bf16 a[224:239], v[92:95], v[252:255], a[224:239]
  s_waitcnt lgkmcnt(4)
  s_barrier
  s_waitcnt vmcnt(7)
  s_waitcnt lgkmcnt(0)
  v_mfma_f32_32x32x16_bf16 a[240:255], v[96:99], a[0:3], a[240:255]
  ds_read_b128 v[36:39], v0 offset:20480
  ds_read_b128 v[40:43], v0 offset:49152
  ds_read_b64 v[46:47], v14 offset:2560
  v_mfma_f32_32x32x16_bf16 a[240:255], v[100:103], a[4:7], a[240:255]
  s_nop 2
  ds_write_b128 v5, a[224:227] offset:24576
  s_add_u32 s55, s23, 98304
  v_mfma_f32_32x32x16_bf16 a[240:255], v[104:107], a[56:59], a[240:255]
  buffer_load_dwordx4 v[48:51], v13, s[40:43], s55 offen offset:0 sc1
  v_mfma_f32_32x32x16_bf16 a[240:255], v[108:111], a[60:63], a[240:255]
  ds_write_b128 v6, a[228:231] offset:24576
  v_add_f32 v28, v28, v32
  v_mfma_f32_32x32x16_bf16 a[240:255], v[112:115], a[112:115], a[240:255]
  buffer_load_dwordx4 v[52:55], v13, s[40:43], s55 offen offset:1024 sc1
  v_add_f32 v29, v29, v33
  v_add_f32 v30, v30, v34
  v_add_f32 v31, v31, v35
  v_mfma_f32_32x32x16_bf16 a[240:255], v[116:119], a[116:119], a[240:255]
  ds_write_b128 v7, a[232:235] offset:24576
  v_lshlrev_b32 v32, 16, v44
  v_mfma_f32_32x32x16_bf16 a[240:255], v[120:123], a[168:171], a[240:255]
  v_and_b32 v33, s52, v44
  v_lshlrev_b32 v34, 16, v45
  v_and_b32 v35, s52, v45
  v_add_f32 v28, v28, v32
  v_add_f32 v29, v29, v33
  v_add_f32 v30, v30, v34
  v_add_f32 v31, v31, v35
  v_cvt_pk_bf16_f32 v32, v28, v29
  v_mfma_f32_32x32x16_bf16 a[240:255], v[124:127], a[172:175], a[240:255]
  ds_write_b128 v8, a[236:239] offset:24576
  v_cvt_pk_bf16_f32 v33, v30, v31
  v_mfma_f32_32x32x16_bf16 a[240:255], v[128:131], v[144:147], a[240:255]
  buffer_store_dwordx2 v[32:33], v10, s[36:39], s73 offen nt
  v_mfma_f32_32x32x16_bf16 a[240:255], v[132:135], v[148:151], a[240:255]
  ds_read_b128 a[224:227], v12 offset:1152
  ds_read_b128 a[228:231], v12 offset:1184
  v_mfma_f32_32x32x16_bf16 a[240:255], v[136:139], v[200:203], a[240:255]
  ds_read_b128 a[232:235], v12 offset:1216
  ds_read_b128 a[236:239], v12 offset:1248
  v_mfma_f32_32x32x16_bf16 a[240:255], v[140:143], v[204:207], a[240:255]
  buffer_load_dwordx4 v[56:59], v13, s[40:43], s55 offen offset:2048 sc1
  s_waitcnt lgkmcnt(4)
  s_barrier
  s_waitcnt lgkmcnt(0)
  v_mfma_f32_32x32x16_bf16 a[224:239], v[96:99], a[8:11], a[224:239]
  ds_read_b128 v[28:31], v0 offset:8192
  ds_read_b128 v[32:35], v0 offset:36864
  ds_read_b64 v[44:45], v14 offset:1024
  v_mfma_f32_32x32x16_bf16 a[224:239], v[100:103], a[12:15], a[224:239]
  s_nop 2
  ds_write_b128 v1, a[240:243] offset:0
  v_mfma_f32_32x32x16_bf16 a[224:239], v[104:107], a[64:67], a[224:239]
  buffer_load_dwordx4 v[60:63], v13, s[40:43], s55 offen offset:3072 sc1
  v_mfma_f32_32x32x16_bf16 a[224:239], v[108:111], a[68:71], a[224:239]
  ds_write_b128 v2, a[244:247] offset:0
  s_add_u32 s55, s23, 102400
  v_mfma_f32_32x32x16_bf16 a[224:239], v[112:115], a[120:123], a[224:239]
  buffer_load_dwordx4 v[64:67], v13, s[40:43], s55 offen offset:0 sc1
  v_add_f32 v36, v36, v40
  v_add_f32 v37, v37, v41
  v_add_f32 v38, v38, v42
  v_add_f32 v39, v39, v43
  v_mfma_f32_32x32x16_bf16 a[224:239], v[116:119], a[124:127], a[224:239]
  ds_write_b128 v3, a[248:251] offset:0
  v_lshlrev_b32 v40, 16, v46
  v_mfma_f32_32x32x16_bf16 a[224:239], v[120:123], a[176:179], a[224:239]
  v_and_b32 v41, s52, v46
  v_lshlrev_b32 v42, 16, v47
  v_and_b32 v43, s52, v47
  v_add_f32 v36, v36, v40
  v_add_f32 v37, v37, v41
  v_add_f32 v38, v38, v42
  v_add_f32 v39, v39, v43
  v_cvt_pk_bf16_f32 v40, v36, v37
  v_mfma_f32_32x32x16_bf16 a[224:239], v[124:127], a[180:183], a[224:239]
  ds_write_b128 v4, a[252:255] offset:0
  v_cvt_pk_bf16_f32 v41, v38, v39
  v_mfma_f32_32x32x16_bf16 a[224:239], v[128:131], v[152:155], a[224:239]
  buffer_store_dwordx2 v[40:41], v10, s[36:39], s77 offen nt
  v_mfma_f32_32x32x16_bf16 a[224:239], v[132:135], v[156:159], a[224:239]
  ds_read_b128 a[240:243], v12 offset:1152
  ds_read_b128 a[244:247], v12 offset:1184
  v_mfma_f32_32x32x16_bf16 a[224:239], v[136:139], v[208:211], a[224:239]
  ds_read_b128 a[248:251], v12 offset:1216
  ds_read_b128 a[252:255], v12 offset:1248
  v_mfma_f32_32x32x16_bf16 a[224:239], v[140:143], v[212:215], a[224:239]
  buffer_load_dwordx4 v[68:71], v13, s[40:43], s55 offen offset:1024 sc1
  s_waitcnt lgkmcnt(4)
  s_barrier
  s_waitcnt lgkmcnt(0)
  v_mfma_f32_32x32x16_bf16 a[240:255], v[96:99], a[16:19], a[240:255]
  ds_read_b128 v[36:39], v0 offset:24576
  ds_read_b128 v[40:43], v0 offset:53248
  ds_read_b64 v[46:47], v14 offset:3072
  v_mfma_f32_32x32x16_bf16 a[240:255], v[100:103], a[20:23], a[240:255]
  s_nop 2
  ds_write_b128 v1, a[224:227] offset:4096
  v_mfma_f32_32x32x16_bf16 a[240:255], v[104:107], a[72:75], a[240:255]
  buffer_load_dwordx4 v[72:75], v13, s[40:43], s55 offen offset:2048 sc1
  v_mfma_f32_32x32x16_bf16 a[240:255], v[108:111], a[76:79], a[240:255]
  ds_write_b128 v2, a[228:231] offset:4096
  v_add_f32 v28, v28, v32
  v_mfma_f32_32x32x16_bf16 a[240:255], v[112:115], a[128:131], a[240:255]
  buffer_load_dwordx4 v[76:79], v13, s[40:43], s55 offen offset:3072 sc1
  v_add_f32 v29, v29, v33
  v_add_f32 v30, v30, v34
  v_add_f32 v31, v31, v35
  v_mfma_f32_32x32x16_bf16 a[240:255], v[116:119], a[132:135], a[240:255]
  ds_write_b128 v3, a[232:235] offset:4096
  v_lshlrev_b32 v32, 16, v44
  v_mfma_f32_32x32x16_bf16 a[240:255], v[120:123], a[184:187], a[240:255]
  v_and_b32 v33, s52, v44
  v_lshlrev_b32 v34, 16, v45
  v_and_b32 v35, s52, v45
  v_add_f32 v28, v28, v32
  v_add_f32 v29, v29, v33
  v_add_f32 v30, v30, v34
  v_add_f32 v31, v31, v35
  v_cvt_pk_bf16_f32 v32, v28, v29
  v_mfma_f32_32x32x16_bf16 a[240:255], v[124:127], a[188:191], a[240:255]
  ds_write_b128 v4, a[236:239] offset:4096
  v_cvt_pk_bf16_f32 v33, v30, v31
  v_mfma_f32_32x32x16_bf16 a[240:255], v[128:131], v[160:163], a[240:255]
  buffer_store_dwordx2 v[32:33], v10, s[36:39], s74 offen nt
  v_add_u32 v9, 0xffffd480, v12
  v_cndmask_b32 v9, v9, v5, s[64:65]
  v_mfma_f32_32x32x16_bf16 a[240:255], v[132:135], v[164:167], a[240:255]
  ds_read_b128 a[224:227], v9 offset:12288
  v_add_u32 v9, 0xffffd4a0, v12
  v_cndmask_b32 v9, v9, v6, s[64:65]
  ds_read_b128 a[228:231], v9 offset:12288
  v_add_u32 v9, 0xffffd4c0, v12
  v_cndmask_b32 v9, v9, v7, s[64:65]
  v_mfma_f32_32x32x16_bf16 a[240:255], v[136:139], v[216:219], a[240:255]
  ds_read_b128 a[232:235], v9 offset:12288
  v_add_u32 v9, 0xffffd4e0, v12
  v_cndmask_b32 v9, v9, v8, s[64:65]
  ds_read_b128 a[236:239], v9 offset:12288
  s_add_u32 s55, s23, 106496
  v_mfma_f32_32x32x16_bf16 a[240:255], v[140:143], v[220:223], a[240:255]
  buffer_load_dwordx4 v[80:83], v13, s[40:43], s55 offen offset:0 sc1
  s_waitcnt lgkmcnt(4)
  s_barrier
  s_waitcnt lgkmcnt(0)
  v_mfma_f32_32x32x16_bf16 a[224:239], v[96:99], a[24:27], a[224:239]
  ds_read_b128 v[28:31], v0 offset:12288
  ds_read_b128 v[32:35], v0 offset:40960
  ds_read_b64 v[44:45], v14 offset:1536
  v_mfma_f32_32x32x16_bf16 a[224:239], v[100:103], a[28:31], a[224:239]
  s_nop 2
  ds_write_b128 v1, a[240:243] offset:8192
  v_mfma_f32_32x32x16_bf16 a[224:239], v[104:107], a[80:83], a[224:239]
  buffer_load_dwordx4 v[84:87], v13, s[40:43], s55 offen offset:1024 sc1
  v_mfma_f32_32x32x16_bf16 a[224:239], v[108:111], a[84:87], a[224:239]
  ds_write_b128 v2, a[244:247] offset:8192
  v_add_f32 v36, v36, v40
  v_mfma_f32_32x32x16_bf16 a[224:239], v[112:115], a[136:139], a[224:239]
  buffer_load_dwordx4 v[88:91], v13, s[40:43], s55 offen offset:2048 sc1
  v_add_f32 v37, v37, v41
  v_add_f32 v38, v38, v42
  v_add_f32 v39, v39, v43
  v_mfma_f32_32x32x16_bf16 a[224:239], v[116:119], a[140:143], a[224:239]
  ds_write_b128 v3, a[248:251] offset:8192
  v_lshlrev_b32 v40, 16, v46
  v_mfma_f32_32x32x16_bf16 a[224:239], v[120:123], a[192:195], a[224:239]
  v_and_b32 v41, s52, v46
  v_lshlrev_b32 v42, 16, v47
  v_and_b32 v43, s52, v47
  v_add_f32 v36, v36, v40
  v_add_f32 v37, v37, v41
  v_add_f32 v38, v38, v42
  v_add_f32 v39, v39, v43
  v_cvt_pk_bf16_f32 v40, v36, v37
  v_mfma_f32_32x32x16_bf16 a[224:239], v[124:127], a[196:199], a[224:239]
  ds_write_b128 v4, a[252:255] offset:8192
  v_cvt_pk_bf16_f32 v41, v38, v39
  v_mfma_f32_32x32x16_bf16 a[224:239], v[128:131], v[168:171], a[224:239]
  buffer_store_dwordx2 v[40:41], v10, s[36:39], s78 offen nt
  v_mfma_f32_32x32x16_bf16 a[224:239], v[132:135], v[172:175], a[224:239]
  ds_read_b128 a[240:243], v5 offset:16384
  ds_read_b128 a[244:247], v6 offset:16384
  v_mfma_f32_32x32x16_bf16 a[224:239], v[136:139], v[224:227], a[224:239]
  ds_read_b128 a[248:251], v7 offset:16384
  ds_read_b128 a[252:255], v8 offset:16384
  v_mfma_f32_32x32x16_bf16 a[224:239], v[140:143], v[228:231], a[224:239]
  buffer_load_dwordx4 v[92:95], v13, s[40:43], s55 offen offset:3072 sc1
  s_waitcnt lgkmcnt(4)
  s_barrier
  s_waitcnt lgkmcnt(0)
  v_mfma_f32_32x32x16_bf16 a[240:255], v[96:99], a[32:35], a[240:255]
  v_mfma_f32_32x32x16_bf16 a[240:255], v[100:103], a[36:39], a[240:255]
  s_nop 5
  ds_write_b128 v5, a[224:227] offset:12288
  v_mfma_f32_32x32x16_bf16 a[240:255], v[104:107], a[88:91], a[240:255]
  v_mfma_f32_32x32x16_bf16 a[240:255], v[108:111], a[92:95], a[240:255]
  ds_write_b128 v6, a[228:231] offset:12288
  v_add_f32 v28, v28, v32
  v_mfma_f32_32x32x16_bf16 a[240:255], v[112:115], a[144:147], a[240:255]
  v_add_f32 v29, v29, v33
  v_add_f32 v30, v30, v34
  v_add_f32 v31, v31, v35
  v_lshlrev_b32 v32, 16, v44
  v_and_b32 v33, s52, v44
  v_lshlrev_b32 v34, 16, v45
  v_mfma_f32_32x32x16_bf16 a[240:255], v[116:119], a[148:151], a[240:255]
  ds_write_b128 v7, a[232:235] offset:12288
  v_and_b32 v35, s52, v45
  v_mfma_f32_32x32x16_bf16 a[240:255], v[120:123], a[200:203], a[240:255]
  v_add_f32 v28, v28, v32
  v_add_f32 v29, v29, v33
  v_add_f32 v30, v30, v34
  v_add_f32 v31, v31, v35
  v_cvt_pk_bf16_f32 v32, v28, v29
  v_cvt_pk_bf16_f32 v33, v30, v31
  v_mfma_f32_32x32x16_bf16 a[240:255], v[124:127], a[204:207], a[240:255]
  ds_write_b128 v8, a[236:239] offset:12288
  v_mfma_f32_32x32x16_bf16 a[240:255], v[128:131], v[176:179], a[240:255]
  buffer_store_dwordx2 v[32:33], v10, s[36:39], s75 offen nt
  v_add_u32 v10, 64, v10
  v_mfma_f32_32x32x16_bf16 a[240:255], v[132:135], v[180:183], a[240:255]
  ds_read_b128 a[224:227], v5 offset:20480
  ds_read_b128 a[228:231], v6 offset:20480
  v_mfma_f32_32x32x16_bf16 a[240:255], v[136:139], v[232:235], a[240:255]
  ds_read_b128 a[232:235], v7 offset:20480
  ds_read_b128 a[236:239], v8 offset:20480
  v_mfma_f32_32x32x16_bf16 a[240:255], v[140:143], v[236:239], a[240:255]
  s_waitcnt lgkmcnt(4)
  s_barrier
  s_waitcnt vmcnt(18)
  s_waitcnt lgkmcnt(0)
  v_mfma_f32_32x32x16_bf16 a[224:239], v[96:99], a[40:43], a[224:239]
  ds_read_b128 v[36:39], v0 offset:0
  ds_read_b128 v[40:43], v0 offset:28672
  ds_read_b64 v[46:47], v14 offset:4096
  v_mfma_f32_32x32x16_bf16 a[224:239], v[100:103], a[44:47], a[224:239]
  s_nop 2
  ds_write_b128 v5, a[240:243] offset:16384
  v_add_u32 v15, 64, v15
  s_add_u32 m0, s62, 0
  v_mfma_f32_32x32x16_bf16 a[224:239], v[104:107], a[96:99], a[224:239]
  buffer_load_dwordx4 v15, s[24:27], 0 offen offset:0 lds
  v_mfma_f32_32x32x16_bf16 a[224:239], v[108:111], a[100:103], a[224:239]
  ds_write_b128 v6, a[244:247] offset:16384
  s_waitcnt lgkmcnt(3)
  v_add_f32 v36, v36, v40
  v_mfma_f32_32x32x16_bf16 a[224:239], v[112:115], a[152:155], a[224:239]
  buffer_load_dwordx4 v15, s[24:27], s96 offen offset:1024 lds
  v_add_f32 v37, v37, v41
  v_add_f32 v38, v38, v42
  v_add_f32 v39, v39, v43
  s_waitcnt lgkmcnt(2)
  v_lshlrev_b32 v40, 16, v46
  v_and_b32 v41, s52, v46
  v_lshlrev_b32 v42, 16, v47
  v_mfma_f32_32x32x16_bf16 a[224:239], v[116:119], a[156:159], a[224:239]
  ds_write_b128 v7, a[248:251] offset:16384
  v_and_b32 v43, s52, v47
  v_mfma_f32_32x32x16_bf16 a[224:239], v[120:123], a[208:211], a[224:239]
  buffer_load_dwordx4 v15, s[24:27], s98 offen offset:3072 lds
  v_add_f32 v36, v36, v40
  v_add_f32 v37, v37, v41
  v_add_f32 v38, v38, v42
  v_add_f32 v39, v39, v43
  v_cvt_pk_bf16_f32 v40, v36, v37
  v_mfma_f32_32x32x16_bf16 a[224:239], v[124:127], a[212:215], a[224:239]
  ds_write_b128 v8, a[252:255] offset:16384
  v_cvt_pk_bf16_f32 v41, v38, v39
  v_mfma_f32_32x32x16_bf16 a[224:239], v[128:131], v[184:187], a[224:239]
  buffer_store_dwordx2 v[40:41], v10, s[36:39], 0 offen nt
  v_mfma_f32_32x32x16_bf16 a[224:239], v[132:135], v[188:191], a[224:239]
  ds_read_b128 a[240:243], v5 offset:24576
  ds_read_b128 a[244:247], v6 offset:24576
  v_mfma_f32_32x32x16_bf16 a[224:239], v[136:139], v[240:243], a[224:239]
  ds_read_b128 a[248:251], v7 offset:24576
  ds_read_b128 a[252:255], v8 offset:24576
  v_mfma_f32_32x32x16_bf16 a[224:239], v[140:143], v[244:247], a[224:239]
  buffer_load_dwordx4 v15, s[24:27], s97 offen offset:2048 lds
  s_waitcnt lgkmcnt(4)
  s_barrier
  s_waitcnt lgkmcnt(0)
  v_mfma_f32_32x32x16_bf16 a[240:255], v[96:99], a[48:51], a[240:255]
  ds_read_b128 v[28:31], v0 offset:16384
  ds_read_b128 v[32:35], v0 offset:45056
  ds_read_b64 v[44:45], v14 offset:6144
  ds_read_b128 v[36:39], v0 offset:4096
  ds_read_b128 v[40:43], v0 offset:32768
  ds_read_b64 v[46:47], v14 offset:4608
  v_mfma_f32_32x32x16_bf16 a[240:255], v[100:103], a[52:55], a[240:255]
  ds_write_b128 v5, a[224:227] offset:20480
  v_mfma_f32_32x32x16_bf16 a[240:255], v[104:107], a[104:107], a[240:255]
  v_mfma_f32_32x32x16_bf16 a[240:255], v[108:111], a[108:111], a[240:255]
  ds_write_b128 v6, a[228:231] offset:20480
  s_waitcnt lgkmcnt(6)
  v_add_f32 v28, v28, v32
  v_mfma_f32_32x32x16_bf16 a[240:255], v[112:115], a[160:163], a[240:255]
  v_add_f32 v29, v29, v33
  v_add_f32 v30, v30, v34
  v_add_f32 v31, v31, v35
  s_waitcnt lgkmcnt(5)
  v_lshlrev_b32 v32, 16, v44
  v_and_b32 v33, s52, v44
  v_lshlrev_b32 v34, 16, v45
  v_mfma_f32_32x32x16_bf16 a[240:255], v[116:119], a[164:167], a[240:255]
  ds_write_b128 v7, a[232:235] offset:20480
  v_and_b32 v35, s52, v45
  v_mfma_f32_32x32x16_bf16 a[240:255], v[120:123], a[216:219], a[240:255]
  v_add_f32 v28, v28, v32
  v_add_f32 v29, v29, v33
  v_add_f32 v30, v30, v34
  v_add_f32 v31, v31, v35
  v_cvt_pk_bf16_f32 v32, v28, v29
  v_cvt_pk_bf16_f32 v33, v30, v31
  v_mfma_f32_32x32x16_bf16 a[240:255], v[124:127], a[220:223], a[240:255]
  ds_write_b128 v8, a[236:239] offset:20480
  v_mfma_f32_32x32x16_bf16 a[240:255], v[128:131], v[192:195], a[240:255]
  buffer_store_dwordx2 v[32:33], v10, s[36:39], s76 offen nt
  v_mfma_f32_32x32x16_bf16 a[240:255], v[132:135], v[196:199], a[240:255]
  ds_read_b128 a[224:227], v12 offset:1280
  ds_read_b128 a[228:231], v12 offset:1312
  v_mfma_f32_32x32x16_bf16 a[240:255], v[136:139], v[248:251], a[240:255]
  ds_read_b128 a[232:235], v12 offset:1344
  ds_read_b128 a[236:239], v12 offset:1376
  v_mfma_f32_32x32x16_bf16 a[240:255], v[140:143], v[252:255], a[240:255]
  s_waitcnt lgkmcnt(4)
  s_barrier
  s_waitcnt vmcnt(7)
  s_waitcnt lgkmcnt(0)
  v_mfma_f32_32x32x16_bf16 a[224:239], v[48:51], a[0:3], a[224:239]
  ds_read_b128 v[28:31], v0 offset:20480
  ds_read_b128 v[32:35], v0 offset:49152
  ds_read_b64 v[44:45], v14 offset:6656
  v_mfma_f32_32x32x16_bf16 a[224:239], v[52:55], a[4:7], a[224:239]
  s_nop 2
  ds_write_b128 v5, a[240:243] offset:24576
  s_add_u32 s55, s23, 147456
  v_mfma_f32_32x32x16_bf16 a[224:239], v[56:59], a[56:59], a[224:239]
  buffer_load_dwordx4 v[96:99], v13, s[40:43], s55 offen offset:0 sc1
  v_mfma_f32_32x32x16_bf16 a[224:239], v[60:63], a[60:63], a[224:239]
  ds_write_b128 v6, a[244:247] offset:24576
  v_add_f32 v36, v36, v40
  v_mfma_f32_32x32x16_bf16 a[224:239], v[64:67], a[112:115], a[224:239]
  buffer_load_dwordx4 v[100:103], v13, s[40:43], s55 offen offset:1024 sc1
  v_add_f32 v37, v37, v41
  v_add_f32 v38, v38, v42
  v_add_f32 v39, v39, v43
  v_mfma_f32_32x32x16_bf16 a[224:239], v[68:71], a[116:119], a[224:239]
  ds_write_b128 v7, a[248:251] offset:24576
  v_lshlrev_b32 v40, 16, v46
  v_mfma_f32_32x32x16_bf16 a[224:239], v[72:75], a[168:171], a[224:239]
  v_and_b32 v41, s52, v46
  v_lshlrev_b32 v42, 16, v47
  v_and_b32 v43, s52, v47
  v_add_f32 v36, v36, v40
  v_add_f32 v37, v37, v41
  v_add_f32 v38, v38, v42
  v_add_f32 v39, v39, v43
  v_cvt_pk_bf16_f32 v40, v36, v37
  v_mfma_f32_32x32x16_bf16 a[224:239], v[76:79], a[172:175], a[224:239]
  ds_write_b128 v8, a[252:255] offset:24576
  v_cvt_pk_bf16_f32 v41, v38, v39
  v_mfma_f32_32x32x16_bf16 a[224:239], v[80:83], v[144:147], a[224:239]
  buffer_store_dwordx2 v[40:41], v10, s[36:39], s73 offen nt
  v_mfma_f32_32x32x16_bf16 a[224:239], v[84:87], v[148:151], a[224:239]
  ds_read_b128 a[240:243], v12 offset:1280
  ds_read_b128 a[244:247], v12 offset:1312
  v_mfma_f32_32x32x16_bf16 a[224:239], v[88:91], v[200:203], a[224:239]
  ds_read_b128 a[248:251], v12 offset:1344
  ds_read_b128 a[252:255], v12 offset:1376
  v_mfma_f32_32x32x16_bf16 a[224:239], v[92:95], v[204:207], a[224:239]
  buffer_load_dwordx4 v[104:107], v13, s[40:43], s55 offen offset:2048 sc1
  s_waitcnt lgkmcnt(4)
  s_barrier
  s_waitcnt lgkmcnt(0)
  v_mfma_f32_32x32x16_bf16 a[240:255], v[48:51], a[8:11], a[240:255]
  ds_read_b128 v[36:39], v0 offset:8192
  ds_read_b128 v[40:43], v0 offset:36864
  ds_read_b64 v[46:47], v14 offset:5120
  v_mfma_f32_32x32x16_bf16 a[240:255], v[52:55], a[12:15], a[240:255]
  s_nop 2
  ds_write_b128 v1, a[224:227] offset:0
  v_mfma_f32_32x32x16_bf16 a[240:255], v[56:59], a[64:67], a[240:255]
  buffer_load_dwordx4 v[108:111], v13, s[40:43], s55 offen offset:3072 sc1
  v_mfma_f32_32x32x16_bf16 a[240:255], v[60:63], a[68:71], a[240:255]
  ds_write_b128 v2, a[228:231] offset:0
  s_add_u32 s55, s23, 151552
  v_mfma_f32_32x32x16_bf16 a[240:255], v[64:67], a[120:123], a[240:255]
  buffer_load_dwordx4 v[112:115], v13, s[40:43], s55 offen offset:0 sc1
  v_add_f32 v28, v28, v32
  v_add_f32 v29, v29, v33
  v_add_f32 v30, v30, v34
  v_add_f32 v31, v31, v35
  v_mfma_f32_32x32x16_bf16 a[240:255], v[68:71], a[124:127], a[240:255]
  ds_write_b128 v3, a[232:235] offset:0
  v_lshlrev_b32 v32, 16, v44
  v_mfma_f32_32x32x16_bf16 a[240:255], v[72:75], a[176:179], a[240:255]
  v_and_b32 v33, s52, v44
  v_lshlrev_b32 v34, 16, v45
  v_and_b32 v35, s52, v45
  v_add_f32 v28, v28, v32
  v_add_f32 v29, v29, v33
  v_add_f32 v30, v30, v34
  v_add_f32 v31, v31, v35
  v_cvt_pk_bf16_f32 v32, v28, v29
  v_mfma_f32_32x32x16_bf16 a[240:255], v[76:79], a[180:183], a[240:255]
  ds_write_b128 v4, a[236:239] offset:0
  v_cvt_pk_bf16_f32 v33, v30, v31
  v_mfma_f32_32x32x16_bf16 a[240:255], v[80:83], v[152:155], a[240:255]
  buffer_store_dwordx2 v[32:33], v10, s[36:39], s77 offen nt
  v_mfma_f32_32x32x16_bf16 a[240:255], v[84:87], v[156:159], a[240:255]
  ds_read_b128 a[224:227], v12 offset:1280
  ds_read_b128 a[228:231], v12 offset:1312
  v_mfma_f32_32x32x16_bf16 a[240:255], v[88:91], v[208:211], a[240:255]
  ds_read_b128 a[232:235], v12 offset:1344
  ds_read_b128 a[236:239], v12 offset:1376
  v_mfma_f32_32x32x16_bf16 a[240:255], v[92:95], v[212:215], a[240:255]
  buffer_load_dwordx4 v[116:119], v13, s[40:43], s55 offen offset:1024 sc1
  s_waitcnt lgkmcnt(4)
  s_barrier
  s_waitcnt lgkmcnt(0)
  v_mfma_f32_32x32x16_bf16 a[224:239], v[48:51], a[16:19], a[224:239]
  ds_read_b128 v[28:31], v0 offset:24576
  ds_read_b128 v[32:35], v0 offset:53248
  ds_read_b64 v[44:45], v14 offset:7168
  v_mfma_f32_32x32x16_bf16 a[224:239], v[52:55], a[20:23], a[224:239]
  s_nop 2
  ds_write_b128 v1, a[240:243] offset:4096
  v_mfma_f32_32x32x16_bf16 a[224:239], v[56:59], a[72:75], a[224:239]
  buffer_load_dwordx4 v[120:123], v13, s[40:43], s55 offen offset:2048 sc1
  v_mfma_f32_32x32x16_bf16 a[224:239], v[60:63], a[76:79], a[224:239]
  ds_write_b128 v2, a[244:247] offset:4096
  v_add_f32 v36, v36, v40
  v_mfma_f32_32x32x16_bf16 a[224:239], v[64:67], a[128:131], a[224:239]
  buffer_load_dwordx4 v[124:127], v13, s[40:43], s55 offen offset:3072 sc1
  v_add_f32 v37, v37, v41
  v_add_f32 v38, v38, v42
  v_add_f32 v39, v39, v43
  v_mfma_f32_32x32x16_bf16 a[224:239], v[68:71], a[132:135], a[224:239]
  ds_write_b128 v3, a[248:251] offset:4096
  v_lshlrev_b32 v40, 16, v46
  v_mfma_f32_32x32x16_bf16 a[224:239], v[72:75], a[184:187], a[224:239]
  v_and_b32 v41, s52, v46
  v_lshlrev_b32 v42, 16, v47
  v_and_b32 v43, s52, v47
  v_add_f32 v36, v36, v40
  v_add_f32 v37, v37, v41
  v_add_f32 v38, v38, v42
  v_add_f32 v39, v39, v43
  v_cvt_pk_bf16_f32 v40, v36, v37
  v_mfma_f32_32x32x16_bf16 a[224:239], v[76:79], a[188:191], a[224:239]
  ds_write_b128 v4, a[252:255] offset:4096
  v_cvt_pk_bf16_f32 v41, v38, v39
  v_mfma_f32_32x32x16_bf16 a[224:239], v[80:83], v[160:163], a[224:239]
  buffer_store_dwordx2 v[40:41], v10, s[36:39], s74 offen nt
  v_add_u32 v9, 0xffffd500, v12
  v_cndmask_b32 v9, v9, v5, s[64:65]
  v_mfma_f32_32x32x16_bf16 a[224:239], v[84:87], v[164:167], a[224:239]
  ds_read_b128 a[240:243], v9 offset:12288
  v_add_u32 v9, 0xffffd520, v12
  v_cndmask_b32 v9, v9, v6, s[64:65]
  ds_read_b128 a[244:247], v9 offset:12288
  v_add_u32 v9, 0xffffd540, v12
  v_cndmask_b32 v9, v9, v7, s[64:65]
  v_mfma_f32_32x32x16_bf16 a[224:239], v[88:91], v[216:219], a[224:239]
  ds_read_b128 a[248:251], v9 offset:12288
  v_add_u32 v9, 0xffffd560, v12
  v_cndmask_b32 v9, v9, v8, s[64:65]
  ds_read_b128 a[252:255], v9 offset:12288
  s_add_u32 s55, s23, 155648
  v_mfma_f32_32x32x16_bf16 a[224:239], v[92:95], v[220:223], a[224:239]
  buffer_load_dwordx4 v[128:131], v13, s[40:43], s55 offen offset:0 sc1
  s_waitcnt lgkmcnt(4)
  s_barrier
  s_waitcnt lgkmcnt(0)
  v_mfma_f32_32x32x16_bf16 a[240:255], v[48:51], a[24:27], a[240:255]
  ds_read_b128 v[36:39], v0 offset:12288
  ds_read_b128 v[40:43], v0 offset:40960
  ds_read_b64 v[46:47], v14 offset:5632
  v_mfma_f32_32x32x16_bf16 a[240:255], v[52:55], a[28:31], a[240:255]
  s_nop 2
  ds_write_b128 v1, a[224:227] offset:8192
  v_mfma_f32_32x32x16_bf16 a[240:255], v[56:59], a[80:83], a[240:255]
  buffer_load_dwordx4 v[132:135], v13, s[40:43], s55 offen offset:1024 sc1
  v_mfma_f32_32x32x16_bf16 a[240:255], v[60:63], a[84:87], a[240:255]
  ds_write_b128 v2, a[228:231] offset:8192
  v_add_f32 v28, v28, v32
  v_mfma_f32_32x32x16_bf16 a[240:255], v[64:67], a[136:139], a[240:255]
  buffer_load_dwordx4 v[136:139], v13, s[40:43], s55 offen offset:2048 sc1
  v_add_f32 v29, v29, v33
  v_add_f32 v30, v30, v34
  v_add_f32 v31, v31, v35
  v_mfma_f32_32x32x16_bf16 a[240:255], v[68:71], a[140:143], a[240:255]
  ds_write_b128 v3, a[232:235] offset:8192
  v_lshlrev_b32 v32, 16, v44
  v_mfma_f32_32x32x16_bf16 a[240:255], v[72:75], a[192:195], a[240:255]
  v_and_b32 v33, s52, v44
  v_lshlrev_b32 v34, 16, v45
  v_and_b32 v35, s52, v45
  v_add_f32 v28, v28, v32
  v_add_f32 v29, v29, v33
  v_add_f32 v30, v30, v34
  v_add_f32 v31, v31, v35
  v_cvt_pk_bf16_f32 v32, v28, v29
  v_mfma_f32_32x32x16_bf16 a[240:255], v[76:79], a[196:199], a[240:255]
  ds_write_b128 v4, a[236:239] offset:8192
  v_cvt_pk_bf16_f32 v33, v30, v31
  v_mfma_f32_32x32x16_bf16 a[240:255], v[80:83], v[168:171], a[240:255]
  buffer_store_dwordx2 v[32:33], v10, s[36:39], s78 offen nt
  v_mfma_f32_32x32x16_bf16 a[240:255], v[84:87], v[172:175], a[240:255]
  ds_read_b128 a[224:227], v5 offset:16384
  ds_read_b128 a[228:231], v6 offset:16384
  v_mfma_f32_32x32x16_bf16 a[240:255], v[88:91], v[224:227], a[240:255]
  ds_read_b128 a[232:235], v7 offset:16384
  ds_read_b128 a[236:239], v8 offset:16384
  v_mfma_f32_32x32x16_bf16 a[240:255], v[92:95], v[228:231], a[240:255]
  buffer_load_dwordx4 v[140:143], v13, s[40:43], s55 offen offset:3072 sc1
  s_waitcnt lgkmcnt(4)
  s_barrier
  s_waitcnt lgkmcnt(0)
  v_mfma_f32_32x32x16_bf16 a[224:239], v[48:51], a[32:35], a[224:239]
  v_mfma_f32_32x32x16_bf16 a[224:239], v[52:55], a[36:39], a[224:239]
  s_nop 5
  ds_write_b128 v5, a[240:243] offset:12288
  v_mfma_f32_32x32x16_bf16 a[224:239], v[56:59], a[88:91], a[224:239]
  v_mfma_f32_32x32x16_bf16 a[224:239], v[60:63], a[92:95], a[224:239]
  ds_write_b128 v6, a[244:247] offset:12288
  v_add_f32 v36, v36, v40
  v_mfma_f32_32x32x16_bf16 a[224:239], v[64:67], a[144:147], a[224:239]
  v_add_f32 v37, v37, v41
  v_add_f32 v38, v38, v42
  v_add_f32 v39, v39, v43
  v_lshlrev_b32 v40, 16, v46
  v_and_b32 v41, s52, v46
  v_lshlrev_b32 v42, 16, v47
  v_mfma_f32_32x32x16_bf16 a[224:239], v[68:71], a[148:151], a[224:239]
  ds_write_b128 v7, a[248:251] offset:12288
  v_and_b32 v43, s52, v47
  v_mfma_f32_32x32x16_bf16 a[224:239], v[72:75], a[200:203], a[224:239]
  v_add_f32 v36, v36, v40
  v_add_f32 v37, v37, v41
  v_add_f32 v38, v38, v42
  v_add_f32 v39, v39, v43
  v_cvt_pk_bf16_f32 v40, v36, v37
  v_cvt_pk_bf16_f32 v41, v38, v39
  v_mfma_f32_32x32x16_bf16 a[224:239], v[76:79], a[204:207], a[224:239]
  ds_write_b128 v8, a[252:255] offset:12288
  v_mfma_f32_32x32x16_bf16 a[224:239], v[80:83], v[176:179], a[224:239]
  buffer_store_dwordx2 v[40:41], v10, s[36:39], s75 offen nt
  v_add_u32 v10, 64, v10
  v_mfma_f32_32x32x16_bf16 a[224:239], v[84:87], v[180:183], a[224:239]
  ds_read_b128 a[240:243], v5 offset:20480
  ds_read_b128 a[244:247], v6 offset:20480
  v_mfma_f32_32x32x16_bf16 a[224:239], v[88:91], v[232:235], a[224:239]
  ds_read_b128 a[248:251], v7 offset:20480
  ds_read_b128 a[252:255], v8 offset:20480
  v_mfma_f32_32x32x16_bf16 a[224:239], v[92:95], v[236:239], a[224:239]
  s_waitcnt lgkmcnt(4)
  s_barrier
  s_waitcnt vmcnt(18)
  s_waitcnt lgkmcnt(0)
  v_mfma_f32_32x32x16_bf16 a[240:255], v[48:51], a[40:43], a[240:255]
  ds_read_b128 v[28:31], v0 offset:0
  ds_read_b128 v[32:35], v0 offset:28672
  ds_read_b64 v[44:45], v14 offset:0
  v_mfma_f32_32x32x16_bf16 a[240:255], v[52:55], a[44:47], a[240:255]
  s_nop 2
  ds_write_b128 v5, a[224:227] offset:16384
  v_add_u32 v15, 64, v15
  s_add_u32 m0, s62, 4096
  v_mfma_f32_32x32x16_bf16 a[240:255], v[56:59], a[96:99], a[240:255]
  buffer_load_dwordx4 v15, s[24:27], 0 offen offset:0 lds
  v_mfma_f32_32x32x16_bf16 a[240:255], v[60:63], a[100:103], a[240:255]
  ds_write_b128 v6, a[228:231] offset:16384
  s_waitcnt lgkmcnt(3)
  v_add_f32 v28, v28, v32
  v_mfma_f32_32x32x16_bf16 a[240:255], v[64:67], a[152:155], a[240:255]
  buffer_load_dwordx4 v15, s[24:27], s96 offen offset:1024 lds
  v_add_f32 v29, v29, v33
  v_add_f32 v30, v30, v34
  v_add_f32 v31, v31, v35
  s_waitcnt lgkmcnt(2)
  v_lshlrev_b32 v32, 16, v44
  v_and_b32 v33, s52, v44
  v_lshlrev_b32 v34, 16, v45
  v_mfma_f32_32x32x16_bf16 a[240:255], v[68:71], a[156:159], a[240:255]
  ds_write_b128 v7, a[232:235] offset:16384
  v_and_b32 v35, s52, v45
  v_mfma_f32_32x32x16_bf16 a[240:255], v[72:75], a[208:211], a[240:255]
  buffer_load_dwordx4 v15, s[24:27], s98 offen offset:3072 lds
  v_add_f32 v28, v28, v32
  v_add_f32 v29, v29, v33
  v_add_f32 v30, v30, v34
  v_add_f32 v31, v31, v35
  v_cvt_pk_bf16_f32 v32, v28, v29
  v_mfma_f32_32x32x16_bf16 a[240:255], v[76:79], a[212:215], a[240:255]
  ds_write_b128 v8, a[236:239] offset:16384
  v_cvt_pk_bf16_f32 v33, v30, v31
  v_mfma_f32_32x32x16_bf16 a[240:255], v[80:83], v[184:187], a[240:255]
  buffer_store_dwordx2 v[32:33], v10, s[36:39], 0 offen nt
  v_mfma_f32_32x32x16_bf16 a[240:255], v[84:87], v[188:191], a[240:255]
  ds_read_b128 a[224:227], v5 offset:24576
  ds_read_b128 a[228:231], v6 offset:24576
  v_mfma_f32_32x32x16_bf16 a[240:255], v[88:91], v[240:243], a[240:255]
  ds_read_b128 a[232:235], v7 offset:24576
  ds_read_b128 a[236:239], v8 offset:24576
  v_mfma_f32_32x32x16_bf16 a[240:255], v[92:95], v[244:247], a[240:255]
  buffer_load_dwordx4 v15, s[24:27], s97 offen offset:2048 lds
  s_waitcnt lgkmcnt(4)
  s_barrier
  s_waitcnt lgkmcnt(0)
  v_mfma_f32_32x32x16_bf16 a[224:239], v[48:51], a[48:51], a[224:239]
  ds_read_b128 v[36:39], v0 offset:16384
  ds_read_b128 v[40:43], v0 offset:45056
  ds_read_b64 v[46:47], v14 offset:2048
  ds_read_b128 v[28:31], v0 offset:4096
  ds_read_b128 v[32:35], v0 offset:32768
  ds_read_b64 v[44:45], v14 offset:512
  v_mfma_f32_32x32x16_bf16 a[224:239], v[52:55], a[52:55], a[224:239]
  ds_write_b128 v5, a[240:243] offset:20480
  v_mfma_f32_32x32x16_bf16 a[224:239], v[56:59], a[104:107], a[224:239]
  v_mfma_f32_32x32x16_bf16 a[224:239], v[60:63], a[108:111], a[224:239]
  ds_write_b128 v6, a[244:247] offset:20480
  s_waitcnt lgkmcnt(6)
  v_add_f32 v36, v36, v40
  v_mfma_f32_32x32x16_bf16 a[224:239], v[64:67], a[160:163], a[224:239]
  v_add_f32 v37, v37, v41
  v_add_f32 v38, v38, v42
  v_add_f32 v39, v39, v43
  s_waitcnt lgkmcnt(5)
  v_lshlrev_b32 v40, 16, v46
  v_and_b32 v41, s52, v46
  v_lshlrev_b32 v42, 16, v47
  v_mfma_f32_32x32x16_bf16 a[224:239], v[68:71], a[164:167], a[224:239]
  ds_write_b128 v7, a[248:251] offset:20480
  v_and_b32 v43, s52, v47
  v_mfma_f32_32x32x16_bf16 a[224:239], v[72:75], a[216:219], a[224:239]
  v_add_f32 v36, v36, v40
  v_add_f32 v37, v37, v41
  v_add_f32 v38, v38, v42
  v_add_f32 v39, v39, v43
  v_cvt_pk_bf16_f32 v40, v36, v37
  v_cvt_pk_bf16_f32 v41, v38, v39
  v_mfma_f32_32x32x16_bf16 a[224:239], v[76:79], a[220:223], a[224:239]
  ds_write_b128 v8, a[252:255] offset:20480
  v_mfma_f32_32x32x16_bf16 a[224:239], v[80:83], v[192:195], a[224:239]
  buffer_store_dwordx2 v[40:41], v10, s[36:39], s76 offen nt
  v_mfma_f32_32x32x16_bf16 a[224:239], v[84:87], v[196:199], a[224:239]
  ds_read_b128 a[240:243], v12 offset:1408
  ds_read_b128 a[244:247], v12 offset:1440
  v_mfma_f32_32x32x16_bf16 a[224:239], v[88:91], v[248:251], a[224:239]
  ds_read_b128 a[248:251], v12 offset:1472
  ds_read_b128 a[252:255], v12 offset:1504
  v_mfma_f32_32x32x16_bf16 a[224:239], v[92:95], v[252:255], a[224:239]
  s_waitcnt lgkmcnt(4)
  s_barrier
  s_waitcnt vmcnt(7)
  s_waitcnt lgkmcnt(0)
  v_mfma_f32_32x32x16_bf16 a[240:255], v[96:99], a[0:3], a[240:255]
  ds_read_b128 v[36:39], v0 offset:20480
  ds_read_b128 v[40:43], v0 offset:49152
  ds_read_b64 v[46:47], v14 offset:2560
  v_mfma_f32_32x32x16_bf16 a[240:255], v[100:103], a[4:7], a[240:255]
  s_nop 2
  ds_write_b128 v5, a[224:227] offset:24576
  v_mfma_f32_32x32x16_bf16 a[240:255], v[104:107], a[56:59], a[240:255]
  v_mfma_f32_32x32x16_bf16 a[240:255], v[108:111], a[60:63], a[240:255]
  ds_write_b128 v6, a[228:231] offset:24576
  v_add_f32 v28, v28, v32
  v_mfma_f32_32x32x16_bf16 a[240:255], v[112:115], a[112:115], a[240:255]
  v_add_f32 v29, v29, v33
  v_add_f32 v30, v30, v34
  v_add_f32 v31, v31, v35
  v_lshlrev_b32 v32, 16, v44
  v_and_b32 v33, s52, v44
  v_lshlrev_b32 v34, 16, v45
  v_mfma_f32_32x32x16_bf16 a[240:255], v[116:119], a[116:119], a[240:255]
  ds_write_b128 v7, a[232:235] offset:24576
  v_and_b32 v35, s52, v45
  v_mfma_f32_32x32x16_bf16 a[240:255], v[120:123], a[168:171], a[240:255]
  v_add_f32 v28, v28, v32
  v_add_f32 v29, v29, v33
  v_add_f32 v30, v30, v34
  v_add_f32 v31, v31, v35
  v_cvt_pk_bf16_f32 v32, v28, v29
  v_cvt_pk_bf16_f32 v33, v30, v31
  v_mfma_f32_32x32x16_bf16 a[240:255], v[124:127], a[172:175], a[240:255]
  ds_write_b128 v8, a[236:239] offset:24576
  v_mfma_f32_32x32x16_bf16 a[240:255], v[128:131], v[144:147], a[240:255]
  buffer_store_dwordx2 v[32:33], v10, s[36:39], s73 offen nt
  v_mfma_f32_32x32x16_bf16 a[240:255], v[132:135], v[148:151], a[240:255]
  ds_read_b128 a[224:227], v12 offset:1408
  ds_read_b128 a[228:231], v12 offset:1440
  v_mfma_f32_32x32x16_bf16 a[240:255], v[136:139], v[200:203], a[240:255]
  ds_read_b128 a[232:235], v12 offset:1472
  ds_read_b128 a[236:239], v12 offset:1504
  v_mfma_f32_32x32x16_bf16 a[240:255], v[140:143], v[204:207], a[240:255]
  s_waitcnt lgkmcnt(4)
  s_barrier
  s_waitcnt lgkmcnt(0)
  v_mfma_f32_32x32x16_bf16 a[224:239], v[96:99], a[8:11], a[224:239]
  ds_read_b128 v[28:31], v0 offset:8192
  ds_read_b128 v[32:35], v0 offset:36864
  ds_read_b64 v[44:45], v14 offset:1024
  v_mfma_f32_32x32x16_bf16 a[224:239], v[100:103], a[12:15], a[224:239]
  s_nop 3
  ds_write_b128 v1, a[240:243] offset:0
  v_mfma_f32_32x32x16_bf16 a[224:239], v[104:107], a[64:67], a[224:239]
  v_mfma_f32_32x32x16_bf16 a[224:239], v[108:111], a[68:71], a[224:239]
  ds_write_b128 v2, a[244:247] offset:0
  v_add_f32 v36, v36, v40
  v_mfma_f32_32x32x16_bf16 a[224:239], v[112:115], a[120:123], a[224:239]
  v_add_f32 v37, v37, v41
  v_add_f32 v38, v38, v42
  v_add_f32 v39, v39, v43
  v_lshlrev_b32 v40, 16, v46
  v_and_b32 v41, s52, v46
  v_lshlrev_b32 v42, 16, v47
  v_mfma_f32_32x32x16_bf16 a[224:239], v[116:119], a[124:127], a[224:239]
  ds_write_b128 v3, a[248:251] offset:0
  v_and_b32 v43, s52, v47
  v_mfma_f32_32x32x16_bf16 a[224:239], v[120:123], a[176:179], a[224:239]
  v_add_f32 v36, v36, v40
  v_add_f32 v37, v37, v41
  v_add_f32 v38, v38, v42
  v_add_f32 v39, v39, v43
  v_cvt_pk_bf16_f32 v40, v36, v37
  v_cvt_pk_bf16_f32 v41, v38, v39
  v_mfma_f32_32x32x16_bf16 a[224:239], v[124:127], a[180:183], a[224:239]
  ds_write_b128 v4, a[252:255] offset:0
  v_mfma_f32_32x32x16_bf16 a[224:239], v[128:131], v[152:155], a[224:239]
  buffer_store_dwordx2 v[40:41], v10, s[36:39], s77 offen nt
  v_mfma_f32_32x32x16_bf16 a[224:239], v[132:135], v[156:159], a[224:239]
  ds_read_b128 a[240:243], v12 offset:1408
  ds_read_b128 a[244:247], v12 offset:1440
  v_mfma_f32_32x32x16_bf16 a[224:239], v[136:139], v[208:211], a[224:239]
  ds_read_b128 a[248:251], v12 offset:1472
  ds_read_b128 a[252:255], v12 offset:1504
  v_mfma_f32_32x32x16_bf16 a[224:239], v[140:143], v[212:215], a[224:239]
  s_waitcnt lgkmcnt(4)
  s_barrier
  s_waitcnt lgkmcnt(0)
  v_mfma_f32_32x32x16_bf16 a[240:255], v[96:99], a[16:19], a[240:255]
  ds_read_b128 v[36:39], v0 offset:24576
  ds_read_b128 v[40:43], v0 offset:53248
  ds_read_b64 v[46:47], v14 offset:3072
  v_mfma_f32_32x32x16_bf16 a[240:255], v[100:103], a[20:23], a[240:255]
  s_nop 3
  ds_write_b128 v1, a[224:227] offset:4096
  v_mfma_f32_32x32x16_bf16 a[240:255], v[104:107], a[72:75], a[240:255]
  v_mfma_f32_32x32x16_bf16 a[240:255], v[108:111], a[76:79], a[240:255]
  ds_write_b128 v2, a[228:231] offset:4096
  v_add_f32 v28, v28, v32
  v_mfma_f32_32x32x16_bf16 a[240:255], v[112:115], a[128:131], a[240:255]
  v_add_f32 v29, v29, v33
  v_add_f32 v30, v30, v34
  v_add_f32 v31, v31, v35
  v_lshlrev_b32 v32, 16, v44
  v_and_b32 v33, s52, v44
  v_lshlrev_b32 v34, 16, v45
  v_mfma_f32_32x32x16_bf16 a[240:255], v[116:119], a[132:135], a[240:255]
  ds_write_b128 v3, a[232:235] offset:4096
  v_and_b32 v35, s52, v45
  v_mfma_f32_32x32x16_bf16 a[240:255], v[120:123], a[184:187], a[240:255]
  v_add_f32 v28, v28, v32
  v_add_f32 v29, v29, v33
  v_add_f32 v30, v30, v34
  v_add_f32 v31, v31, v35
  v_cvt_pk_bf16_f32 v32, v28, v29
  v_cvt_pk_bf16_f32 v33, v30, v31
  v_mfma_f32_32x32x16_bf16 a[240:255], v[124:127], a[188:191], a[240:255]
  ds_write_b128 v4, a[236:239] offset:4096
  v_mfma_f32_32x32x16_bf16 a[240:255], v[128:131], v[160:163], a[240:255]
  buffer_store_dwordx2 v[32:33], v10, s[36:39], s74 offen nt
  v_add_u32 v9, 0xffffd580, v12
  v_cndmask_b32 v9, v9, v5, s[64:65]
  v_mfma_f32_32x32x16_bf16 a[240:255], v[132:135], v[164:167], a[240:255]
  ds_read_b128 a[224:227], v9 offset:12288
  v_add_u32 v9, 0xffffd5a0, v12
  v_cndmask_b32 v9, v9, v6, s[64:65]
  ds_read_b128 a[228:231], v9 offset:12288
  v_add_u32 v9, 0xffffd5c0, v12
  v_cndmask_b32 v9, v9, v7, s[64:65]
  v_mfma_f32_32x32x16_bf16 a[240:255], v[136:139], v[216:219], a[240:255]
  ds_read_b128 a[232:235], v9 offset:12288
  v_add_u32 v9, 0xffffd5e0, v12
  v_cndmask_b32 v9, v9, v8, s[64:65]
  ds_read_b128 a[236:239], v9 offset:12288
  v_mfma_f32_32x32x16_bf16 a[240:255], v[140:143], v[220:223], a[240:255]
  s_waitcnt lgkmcnt(4)
  s_barrier
  s_waitcnt lgkmcnt(0)
  v_mfma_f32_32x32x16_bf16 a[224:239], v[96:99], a[24:27], a[224:239]
  ds_read_b128 v[28:31], v0 offset:12288
  ds_read_b128 v[32:35], v0 offset:40960
  ds_read_b64 v[44:45], v14 offset:1536
  v_mfma_f32_32x32x16_bf16 a[224:239], v[100:103], a[28:31], a[224:239]
  s_nop 3
  ds_write_b128 v1, a[240:243] offset:8192
  v_mfma_f32_32x32x16_bf16 a[224:239], v[104:107], a[80:83], a[224:239]
  v_mfma_f32_32x32x16_bf16 a[224:239], v[108:111], a[84:87], a[224:239]
  ds_write_b128 v2, a[244:247] offset:8192
  v_add_f32 v36, v36, v40
  v_mfma_f32_32x32x16_bf16 a[224:239], v[112:115], a[136:139], a[224:239]
  v_add_f32 v37, v37, v41
  v_add_f32 v38, v38, v42
  v_add_f32 v39, v39, v43
  v_lshlrev_b32 v40, 16, v46
  v_and_b32 v41, s52, v46
  v_lshlrev_b32 v42, 16, v47
  v_mfma_f32_32x32x16_bf16 a[224:239], v[116:119], a[140:143], a[224:239]
  ds_write_b128 v3, a[248:251] offset:8192
  v_and_b32 v43, s52, v47
  v_mfma_f32_32x32x16_bf16 a[224:239], v[120:123], a[192:195], a[224:239]
  v_add_f32 v36, v36, v40
  v_add_f32 v37, v37, v41
  v_add_f32 v38, v38, v42
  v_add_f32 v39, v39, v43
  v_cvt_pk_bf16_f32 v40, v36, v37
  v_cvt_pk_bf16_f32 v41, v38, v39
  v_mfma_f32_32x32x16_bf16 a[224:239], v[124:127], a[196:199], a[224:239]
  ds_write_b128 v4, a[252:255] offset:8192
  v_mfma_f32_32x32x16_bf16 a[224:239], v[128:131], v[168:171], a[224:239]
  buffer_store_dwordx2 v[40:41], v10, s[36:39], s78 offen nt
  v_mfma_f32_32x32x16_bf16 a[224:239], v[132:135], v[172:175], a[224:239]
  ds_read_b128 a[240:243], v5 offset:16384
  ds_read_b128 a[244:247], v6 offset:16384
  v_mfma_f32_32x32x16_bf16 a[224:239], v[136:139], v[224:227], a[224:239]
  ds_read_b128 a[248:251], v7 offset:16384
  ds_read_b128 a[252:255], v8 offset:16384
  v_mfma_f32_32x32x16_bf16 a[224:239], v[140:143], v[228:231], a[224:239]
  s_waitcnt lgkmcnt(4)
  s_barrier
  s_waitcnt lgkmcnt(0)
  v_mfma_f32_32x32x16_bf16 a[240:255], v[96:99], a[32:35], a[240:255]
  v_mfma_f32_32x32x16_bf16 a[240:255], v[100:103], a[36:39], a[240:255]
  s_nop 6
  ds_write_b128 v5, a[224:227] offset:12288
  v_mfma_f32_32x32x16_bf16 a[240:255], v[104:107], a[88:91], a[240:255]
  v_mfma_f32_32x32x16_bf16 a[240:255], v[108:111], a[92:95], a[240:255]
  ds_write_b128 v6, a[228:231] offset:12288
  v_add_f32 v28, v28, v32
  v_mfma_f32_32x32x16_bf16 a[240:255], v[112:115], a[144:147], a[240:255]
  v_add_f32 v29, v29, v33
  v_add_f32 v30, v30, v34
  v_add_f32 v31, v31, v35
  v_lshlrev_b32 v32, 16, v44
  v_and_b32 v33, s52, v44
  v_lshlrev_b32 v34, 16, v45
  v_mfma_f32_32x32x16_bf16 a[240:255], v[116:119], a[148:151], a[240:255]
  ds_write_b128 v7, a[232:235] offset:12288
  v_and_b32 v35, s52, v45
  v_mfma_f32_32x32x16_bf16 a[240:255], v[120:123], a[200:203], a[240:255]
  v_add_f32 v28, v28, v32
  v_add_f32 v29, v29, v33
  v_add_f32 v30, v30, v34
  v_add_f32 v31, v31, v35
  v_cvt_pk_bf16_f32 v32, v28, v29
  v_cvt_pk_bf16_f32 v33, v30, v31
  v_mfma_f32_32x32x16_bf16 a[240:255], v[124:127], a[204:207], a[240:255]
  ds_write_b128 v8, a[236:239] offset:12288
  v_mfma_f32_32x32x16_bf16 a[240:255], v[128:131], v[176:179], a[240:255]
  buffer_store_dwordx2 v[32:33], v10, s[36:39], s75 offen nt
  v_add_u32 v10, 64, v10
  v_mfma_f32_32x32x16_bf16 a[240:255], v[132:135], v[180:183], a[240:255]
  ds_read_b128 a[224:227], v5 offset:20480
  ds_read_b128 a[228:231], v6 offset:20480
  v_mfma_f32_32x32x16_bf16 a[240:255], v[136:139], v[232:235], a[240:255]
  ds_read_b128 a[232:235], v7 offset:20480
  ds_read_b128 a[236:239], v8 offset:20480
  v_mfma_f32_32x32x16_bf16 a[240:255], v[140:143], v[236:239], a[240:255]
  s_waitcnt lgkmcnt(4)
  s_barrier
  s_waitcnt vmcnt(6)
  s_waitcnt lgkmcnt(0)
  v_mfma_f32_32x32x16_bf16 a[224:239], v[96:99], a[40:43], a[224:239]
  ds_read_b128 v[36:39], v0 offset:0
  ds_read_b128 v[40:43], v0 offset:28672
  ds_read_b64 v[46:47], v14 offset:4096
  v_mfma_f32_32x32x16_bf16 a[224:239], v[100:103], a[44:47], a[224:239]
  s_nop 2
  ds_write_b128 v5, a[240:243] offset:16384
  v_mfma_f32_32x32x16_bf16 a[224:239], v[104:107], a[96:99], a[224:239]
  v_mfma_f32_32x32x16_bf16 a[224:239], v[108:111], a[100:103], a[224:239]
  ds_write_b128 v6, a[244:247] offset:16384
  s_waitcnt lgkmcnt(3)
  v_add_f32 v36, v36, v40
  v_mfma_f32_32x32x16_bf16 a[224:239], v[112:115], a[152:155], a[224:239]
  v_add_f32 v37, v37, v41
  v_add_f32 v38, v38, v42
  v_add_f32 v39, v39, v43
  s_waitcnt lgkmcnt(2)
  v_lshlrev_b32 v40, 16, v46
  v_and_b32 v41, s52, v46
  v_lshlrev_b32 v42, 16, v47
  v_mfma_f32_32x32x16_bf16 a[224:239], v[116:119], a[156:159], a[224:239]
  ds_write_b128 v7, a[248:251] offset:16384
  v_and_b32 v43, s52, v47
  v_mfma_f32_32x32x16_bf16 a[224:239], v[120:123], a[208:211], a[224:239]
  v_add_f32 v36, v36, v40
  v_add_f32 v37, v37, v41
  v_add_f32 v38, v38, v42
  v_add_f32 v39, v39, v43
  v_cvt_pk_bf16_f32 v40, v36, v37
  v_cvt_pk_bf16_f32 v41, v38, v39
  v_mfma_f32_32x32x16_bf16 a[224:239], v[124:127], a[212:215], a[224:239]
  ds_write_b128 v8, a[252:255] offset:16384
  v_mfma_f32_32x32x16_bf16 a[224:239], v[128:131], v[184:187], a[224:239]
  buffer_store_dwordx2 v[40:41], v10, s[36:39], 0 offen nt
  v_mfma_f32_32x32x16_bf16 a[224:239], v[132:135], v[188:191], a[224:239]
  ds_read_b128 a[240:243], v5 offset:24576
  ds_read_b128 a[244:247], v6 offset:24576
  v_mfma_f32_32x32x16_bf16 a[224:239], v[136:139], v[240:243], a[224:239]
  ds_read_b128 a[248:251], v7 offset:24576
  ds_read_b128 a[252:255], v8 offset:24576
  v_mfma_f32_32x32x16_bf16 a[224:239], v[140:143], v[244:247], a[224:239]
  s_waitcnt lgkmcnt(4)
  s_barrier
  s_waitcnt lgkmcnt(0)
  v_mfma_f32_32x32x16_bf16 a[240:255], v[96:99], a[48:51], a[240:255]
  ds_read_b128 v[28:31], v0 offset:16384
  ds_read_b128 v[32:35], v0 offset:45056
  ds_read_b64 v[44:45], v14 offset:6144
  ds_read_b128 v[36:39], v0 offset:4096
  ds_read_b128 v[40:43], v0 offset:32768
  ds_read_b64 v[46:47], v14 offset:4608
  v_mfma_f32_32x32x16_bf16 a[240:255], v[100:103], a[52:55], a[240:255]
  s_nop 0
  ds_write_b128 v5, a[224:227] offset:20480
  v_mfma_f32_32x32x16_bf16 a[240:255], v[104:107], a[104:107], a[240:255]
  v_mfma_f32_32x32x16_bf16 a[240:255], v[108:111], a[108:111], a[240:255]
  ds_write_b128 v6, a[228:231] offset:20480
  s_waitcnt lgkmcnt(6)
  v_add_f32 v28, v28, v32
  v_mfma_f32_32x32x16_bf16 a[240:255], v[112:115], a[160:163], a[240:255]
  v_add_f32 v29, v29, v33
  v_add_f32 v30, v30, v34
  v_add_f32 v31, v31, v35
  s_waitcnt lgkmcnt(5)
  v_lshlrev_b32 v32, 16, v44
  v_and_b32 v33, s52, v44
  v_lshlrev_b32 v34, 16, v45
  v_mfma_f32_32x32x16_bf16 a[240:255], v[116:119], a[164:167], a[240:255]
  ds_write_b128 v7, a[232:235] offset:20480
  v_and_b32 v35, s52, v45
  v_mfma_f32_32x32x16_bf16 a[240:255], v[120:123], a[216:219], a[240:255]
  v_add_f32 v28, v28, v32
  v_add_f32 v29, v29, v33
  v_add_f32 v30, v30, v34
  v_add_f32 v31, v31, v35
  v_cvt_pk_bf16_f32 v32, v28, v29
  v_cvt_pk_bf16_f32 v33, v30, v31
  v_mfma_f32_32x32x16_bf16 a[240:255], v[124:127], a[220:223], a[240:255]
  ds_write_b128 v8, a[236:239] offset:20480
  v_mfma_f32_32x32x16_bf16 a[240:255], v[128:131], v[192:195], a[240:255]
  buffer_store_dwordx2 v[32:33], v10, s[36:39], s76 offen nt
  v_mfma_f32_32x32x16_bf16 a[240:255], v[132:135], v[196:199], a[240:255]
  v_mfma_f32_32x32x16_bf16 a[240:255], v[136:139], v[248:251], a[240:255]
  v_mfma_f32_32x32x16_bf16 a[240:255], v[140:143], v[252:255], a[240:255]
  s_waitcnt lgkmcnt(0)
  s_barrier
  s_nop 9
  ds_write_b128 v5, a[240:243] offset:24576
  ds_write_b128 v6, a[244:247] offset:24576
  ds_write_b128 v7, a[248:251] offset:24576
  ds_write_b128 v8, a[252:255] offset:24576
  ds_read_b128 v[48:51], v0 offset:20480
  ds_read_b128 v[52:55], v0 offset:49152
  ds_read_b64 v[56:57], v14 offset:6656
  ds_read_b128 v[60:63], v0 offset:8192
  ds_read_b128 v[64:67], v0 offset:36864
  ds_read_b64 v[68:69], v14 offset:5120
  s_waitcnt lgkmcnt(6)
  s_barrier
  ds_read_b128 v[72:75], v0 offset:24576
  ds_read_b128 v[76:79], v0 offset:53248
  ds_read_b64 v[80:81], v14 offset:7168
  ds_read_b128 v[84:87], v0 offset:12288
  ds_read_b128 v[88:91], v0 offset:40960
  ds_read_b64 v[92:93], v14 offset:5632
  v_add_f32 v36, v36, v40
  v_add_f32 v37, v37, v41
  v_add_f32 v38, v38, v42
  v_add_f32 v39, v39, v43
  v_lshlrev_b32 v40, 16, v46
  v_and_b32 v41, s52, v46
  v_lshlrev_b32 v42, 16, v47
  v_and_b32 v43, s52, v47
  v_add_f32 v36, v36, v40
  v_add_f32 v37, v37, v41
  v_add_f32 v38, v38, v42
  v_add_f32 v39, v39, v43
  v_cvt_pk_bf16_f32 v40, v36, v37
  v_cvt_pk_bf16_f32 v41, v38, v39
  buffer_store_dwordx2 v[40:41], v10, s[36:39], s73 offen nt
  s_waitcnt lgkmcnt(10)
  v_add_f32 v48, v48, v52
  v_add_f32 v49, v49, v53
  v_add_f32 v50, v50, v54
  v_add_f32 v51, v51, v55
  s_waitcnt lgkmcnt(9)
  v_lshlrev_b32 v52, 16, v56
  v_and_b32 v53, s52, v56
  v_lshlrev_b32 v54, 16, v57
  v_and_b32 v55, s52, v57
  v_add_f32 v48, v48, v52
  v_add_f32 v49, v49, v53
  v_add_f32 v50, v50, v54
  v_add_f32 v51, v51, v55
  v_cvt_pk_bf16_f32 v52, v48, v49
  v_cvt_pk_bf16_f32 v53, v50, v51
  buffer_store_dwordx2 v[52:53], v10, s[36:39], s77 offen nt
  s_waitcnt lgkmcnt(7)
  v_add_f32 v60, v60, v64
  v_add_f32 v61, v61, v65
  v_add_f32 v62, v62, v66
  v_add_f32 v63, v63, v67
  s_waitcnt lgkmcnt(6)
  v_lshlrev_b32 v64, 16, v68
  v_and_b32 v65, s52, v68
  v_lshlrev_b32 v66, 16, v69
  v_and_b32 v67, s52, v69
  v_add_f32 v60, v60, v64
  v_add_f32 v61, v61, v65
  v_add_f32 v62, v62, v66
  v_add_f32 v63, v63, v67
  v_cvt_pk_bf16_f32 v64, v60, v61
  v_cvt_pk_bf16_f32 v65, v62, v63
  buffer_store_dwordx2 v[64:65], v10, s[36:39], s74 offen nt
  s_waitcnt lgkmcnt(4)
  v_add_f32 v72, v72, v76
  s_waitcnt lgkmcnt(1)
  v_add_f32 v84, v84, v88
  v_add_f32 v73, v73, v77
  v_add_f32 v85, v85, v89
  v_add_f32 v74, v74, v78
  v_add_f32 v86, v86, v90
  v_add_f32 v75, v75, v79
  v_add_f32 v87, v87, v91
  v_lshlrev_b32 v76, 16, v80
  s_waitcnt lgkmcnt(0)
  v_lshlrev_b32 v88, 16, v92
  v_and_b32 v77, s52, v80
  v_and_b32 v89, s52, v92
  v_lshlrev_b32 v78, 16, v81
  v_lshlrev_b32 v90, 16, v93
  v_and_b32 v79, s52, v81
  v_and_b32 v91, s52, v93
  v_add_f32 v72, v72, v76
  v_add_f32 v84, v84, v88
  v_add_f32 v73, v73, v77
  v_add_f32 v85, v85, v89
  v_add_f32 v74, v74, v78
  v_add_f32 v86, v86, v90
  v_add_f32 v75, v75, v79
  v_add_f32 v87, v87, v91
  v_cvt_pk_bf16_f32 v76, v72, v73
  v_cvt_pk_bf16_f32 v88, v84, v85
  v_cvt_pk_bf16_f32 v77, v74, v75
  v_cvt_pk_bf16_f32 v89, v86, v87
  buffer_store_dwordx2 v[76:77], v10, s[36:39], s78 offen nt
  buffer_store_dwordx2 v[88:89], v10, s[36:39], s75 offen nt
L_end:
  s_endpgm

.section .rodata,"a"
.p2align 6
.amdhsa_kernel standalone__modern_conv_block_slak__vision_kernel
  .amdhsa_next_free_vgpr 512
  .amdhsa_next_free_sgpr 102
  .amdhsa_accum_offset 256
  .amdhsa_group_segment_fixed_size 0
  .amdhsa_kernarg_size 72
  .amdhsa_user_sgpr_count 2
  .amdhsa_user_sgpr_kernarg_segment_ptr 1
  .amdhsa_system_sgpr_workgroup_id_x 1
  .amdhsa_float_denorm_mode_32 3
.end_amdhsa_kernel
```
